```python
import torch

def _softmax(x, axis=-1):
    return torch.softmax(x, dim=axis)

def _gelu(x):
    return torch.nn.functional.gelu(x, approximate='tanh')

def _silu(x):
    return torch.nn.functional.silu(x)

def _sigmoid(x):
    return torch.sigmoid(x)

def _layernorm(x, axis=-1, eps=1e-05):
    m = x.mean(dim=axis, keepdim=True)
    v = x.var(dim=axis, keepdim=True, unbiased=False)
    return (x - m) / torch.sqrt(v + eps)

def _scatter_add(tgt, idx, src, axis=0):
    return tgt.clone().index_add_(axis, idx, src)

def _segment_sum(src, seg, n):
    out = torch.zeros((n,) + src.shape[1:], dtype=src.dtype)
    return out.index_add_(0, seg, src)

def _pad(x, pw):
    flat = tuple((v for pair in reversed(pw) for v in pair))
    return torch.nn.functional.pad(x, flat)
kernel_name = 'adaLN_cond__mha_block_cached__geglu_ffn__prompt'

def setup_inputs():

    _w = lambda a: (lambda t: t.to(torch.bfloat16) if t.is_floating_point() else t)(torch.as_tensor(a))

    def _A_setup():
        B, Sq, D = (1, 2048, 512)
        H, Sk, Dh = (32, 2048, 128)
        return {'x': _w((lambda *s: torch.randn(*s, dtype=torch.bfloat16) * 0.1)(B, Sq, D)), 'k_cache': _w((lambda *s: torch.randn(*s, dtype=torch.bfloat16) * 0.8)(B, H, Sk, Dh)), 'v_cache': _w((lambda *s: torch.randn(*s, dtype=torch.bfloat16) * 1.6)(B, H, Sk, Dh)), 'wq': _w((lambda *s: torch.randn(*s, dtype=torch.bfloat16) * 0.8)(D, H * Dh) * D ** (-0.5)), 'wo': _w((lambda *s: torch.randn(*s, dtype=torch.bfloat16) * 1.6)(H * Dh, D) * (H * Dh) ** (-0.5))}
    _A_in = _A_setup()

    def _B_setup():
        B, S, D, F = (1, 2048, 512, 1792)
        return {'x': _w((lambda *s: torch.randn(*s, dtype=torch.bfloat16) * 0.1)(B, S, D)), 'w_gate': _w((lambda *s: torch.randn(*s, dtype=torch.bfloat16) * 0.1)(D, F)), 'w_up': _w((lambda *s: torch.randn(*s, dtype=torch.bfloat16) * 0.1)(D, F)), 'w_down': _w((lambda *s: torch.randn(*s, dtype=torch.bfloat16) * 0.1)(F, D))}
    _B_in = _B_setup()
    return {'A_x': _A_in['x'], 'A_k_cache': _A_in['k_cache'], 'A_v_cache': _A_in['v_cache'], 'A_wq': _A_in['wq'], 'A_wo': _A_in['wo'], 'B_x': _B_in['x'], 'B_w_gate': _B_in['w_gate'], 'B_w_up': _B_in['w_up'], 'B_w_down': _B_in['w_down'], 'c': _w((lambda *s: torch.randn(*s, dtype=torch.bfloat16) * 0.8)(1, 512) * 8.0), 'w_mod': _w((lambda *s: torch.randn(*s, dtype=torch.bfloat16) * 0.8)(512, 6 * 512) * 512 ** (-0.5) * 8.0)}

def reference(A_x, A_k_cache, A_v_cache, A_wq, A_wo, B_x, B_w_gate, B_w_up, B_w_down, c, w_mod):

    def _A_ref(x, k_cache, v_cache, wq, wo):
        B, Sq, D = x.shape
        H, Dh = (32, 128)
        q = (lambda x, *d: x.permute(*d))((x @ wq).reshape(B, Sq, H, Dh), 0, 2, 1, 3)
        scores = torch.einsum('bhqd,bhkd->bhqk', q, k_cache) * Dh ** (-0.5)
        p = _softmax(scores, axis=-1)
        o = torch.einsum('bhqk,bhkd->bhqd', p, v_cache)
        return (lambda x, *d: x.permute(*d))(o, 0, 2, 1, 3).reshape(B, Sq, H * Dh) @ wo

    def _B_ref(x, w_gate, w_up, w_down):
        return _gelu(x @ w_gate) * (x @ w_up) @ w_down
    x = A_x
    mod = (_silu(c) @ w_mod).reshape(c.shape[0], 6, 1, -1)
    sa, ca, ga, sb, cb, gb = (mod[:, 0].clone(), mod[:, 1].clone(), mod[:, 2].clone(), mod[:, 3].clone(), mod[:, 4].clone(), mod[:, 5].clone())
    h = _layernorm(x, axis=-1) * (1 + ca) + sa
    x = x + ga * _A_ref(h, A_k_cache, A_v_cache, A_wq, A_wo)
    h = _layernorm(x, axis=-1) * (1 + cb) + sb
    x = x + gb * _B_ref(h, B_w_gate, B_w_up, B_w_down)
    return x
```

```asm
; @launch kernel=pre_kernel grid=(256,1,1) block=(512,1,1) lds=16640
; @launch kernel=attn_kernel grid=(256,1,1) block=(256,1,1) lds=131328
; @launch kernel=wo_kernel grid=(256,1,1) block=(256,1,1) lds=131328
; @launch kernel=ln2_kernel grid=(256,1,1) block=(256,1,1) lds=2304
; @launch kernel=ffn1_kernel grid=(256,1,1) block=(256,1,1) lds=114944
; @launch kernel=down_kernel grid=(256,1,1) block=(256,1,1) lds=131328
.amdgcn_target "amdgcn-amd-amdhsa--gfx950"
.text
.globl pre_kernel
.p2align 8
.type pre_kernel,@function
pre_kernel:
s_cmp_ge_u32 s2, 256
s_cbranch_scc1 pre_kernel_done
s_getpc_b64 s[60:61]
cpf_pre:
s_add_u32 s60, s60, pre_kernel-cpf_pre
s_addc_u32 s61, s61, (pre_kernel-cpf_pre)>>31
s_lshr_b32 s62, s2, 3
s_mul_i32 s62, s62, 8192
v_lshrrev_b32 v168, 6, v0
v_mul_u32_u24 v168, 0, v168
v_lshl_add_u32 v168, v0, 4, v168
v_add_u32 v168, s62, v168
v_min_u32 v169, code_end-pre_kernel-16, v168
global_load_dwordx4 v[172:175], v169, s[60:61]
s_load_dwordx2 s[4:5], s[0:1], 0
s_load_dwordx2 s[66:67], s[0:1], 104
s_load_dwordx4 s[68:71], s[0:1], 72
s_load_dwordx4 s[44:47], s[0:1], 8
s_load_dwordx2 s[48:49], s[0:1], 24
v_lshrrev_b32 v2, 6, v0
v_and_b32 v1, 63, v0
s_lshr_b32 s31, s2, 3
v_readfirstlane_b32 s36, v2
s_and_b32 s28, s2, 1
s_lshl_b32 s28, s28, 3
s_and_b32 s30, s31, 7
s_add_u32 s28, s28, s30
s_bfe_u32 s29, s2, 0x20001
s_lshl_b32 s30, s29, 2
s_lshr_b32 s37, s31, 3
s_add_u32 s37, s37, s30
v_and_b32 v3, 3, v0
v_lshrrev_b32 v4, 2, v0
s_movk_i32 s3, 6144
v_mul_lo_u32 v5, v4, s3
v_lshl_add_u32 v5, v3, 4, v5
v_lshlrev_b32 v6, 1, v4
v_and_b32 v7, 7, v1
v_lshrrev_b32 v8, 3, v1
v_lshl_add_u32 v9, v2, 4, v8
v_lshlrev_b32 v10, 10, v9
v_lshl_add_u32 v10, v7, 4, v10
s_lshl_b32 s30, s28, 17
s_add_u32 s32, s30, 8192
s_lshl_b32 s72, s37, 6
s_add_u32 s73, s72, 786432
s_add_u32 s74, s73, 786432
s_add_u32 s75, s74, 786432
s_waitcnt lgkmcnt(0)
s_mov_b32 s8, s4
s_and_b32 s9, s5, 0xffff
s_mov_b32 s10, 2097152
s_mov_b32 s11, 0x00020000
s_mov_b32 s52, s68
s_and_b32 s53, s69, 0xffff
s_mov_b32 s54, 1024
s_mov_b32 s55, 0x00020000
s_mov_b32 s56, s70
s_and_b32 s57, s71, 0xffff
s_mov_b32 s58, 3145728
s_mov_b32 s59, 0x00020000
s_add_u32 s12, s66, 0
s_addc_u32 s13, s67, 0
s_and_b32 s13, s13, 0xffff
s_mov_b32 s14, 6144
s_mov_b32 s15, 0x00020000
s_add_u32 s16, s66, 1048576
s_addc_u32 s17, s67, 0
s_and_b32 s17, s17, 0xffff
s_mov_b32 s18, 2097152
s_mov_b32 s19, 0x00020000
buffer_load_ushort v12, v6, s[52:55], 0 offen offset:0
buffer_load_ushort v13, v6, s[52:55], 0 offen offset:256
buffer_load_ushort v14, v6, s[52:55], 0 offen offset:512
buffer_load_ushort v15, v6, s[52:55], 0 offen offset:768
buffer_load_dwordx4 v[16:19], v5, s[56:59], s72 offen offset:0
buffer_load_dwordx4 v[20:23], v5, s[56:59], s73 offen offset:0
buffer_load_dwordx4 v[24:27], v5, s[56:59], s74 offen offset:0
buffer_load_dwordx4 v[28:31], v5, s[56:59], s75 offen offset:0
buffer_load_dwordx4 v[32:35], v5, s[56:59], s72 offen offset:1024
buffer_load_dwordx4 v[36:39], v5, s[56:59], s73 offen offset:1024
buffer_load_dwordx4 v[40:43], v5, s[56:59], s74 offen offset:1024
buffer_load_dwordx4 v[44:47], v5, s[56:59], s75 offen offset:1024
buffer_load_dwordx4 v[64:67], v10, s[8:11], s30 offen offset:0
buffer_load_dwordx4 v[68:71], v10, s[8:11], s30 offen offset:128
buffer_load_dwordx4 v[72:75], v10, s[8:11], s30 offen offset:256
buffer_load_dwordx4 v[76:79], v10, s[8:11], s30 offen offset:384
buffer_load_dwordx4 v[80:83], v10, s[8:11], s30 offen offset:512
buffer_load_dwordx4 v[84:87], v10, s[8:11], s30 offen offset:640
buffer_load_dwordx4 v[88:91], v10, s[8:11], s30 offen offset:768
buffer_load_dwordx4 v[92:95], v10, s[8:11], s30 offen offset:896
buffer_load_dwordx4 v[96:99], v10, s[8:11], s32 offen offset:0
buffer_load_dwordx4 v[100:103], v10, s[8:11], s32 offen offset:128
buffer_load_dwordx4 v[104:107], v10, s[8:11], s32 offen offset:256
buffer_load_dwordx4 v[108:111], v10, s[8:11], s32 offen offset:384
buffer_load_dwordx4 v[112:115], v10, s[8:11], s32 offen offset:512
buffer_load_dwordx4 v[116:119], v10, s[8:11], s32 offen offset:640
buffer_load_dwordx4 v[120:123], v10, s[8:11], s32 offen offset:768
buffer_load_dwordx4 v[124:127], v10, s[8:11], s32 offen offset:896
s_and_b32 s33, s2, 7
s_lshl_b32 s33, s33, 5
s_add_u32 s33, s33, s31
s_lshl_b32 s38, s33, 4
s_add_u32 s38, s38, 2048
v_mul_lo_u32 v11, v0, s3
v_lshlrev_b32 v52, 1, v0
buffer_load_ushort v53, v52, s[52:55], 0 offen
buffer_load_dwordx4 v[48:51], v11, s[56:59], s38 offen
s_mov_b32 s20, s48
s_and_b32 s21, s49, 0xffff
s_mov_b32 s22, 4194304
s_mov_b32 s23, 0x00020000
s_mov_b32 s24, s44
s_and_b32 s25, s45, 0xffff
s_mov_b32 s26, 0
s_mov_b32 s27, 0x00020000
s_mov_b32 s40, s46
s_and_b32 s41, s47, 0xffff
s_mov_b32 s42, 0
s_mov_b32 s43, 0x00020000
v_lshlrev_b32 v170, 4, v1
s_lshl_b32 s34, s31, 4
s_lshl_b32 s35, s36, 1
s_add_u32 s34, s34, s35
s_lshl_b32 s34, s34, 13
s_lshl_b32 s35, s29, 11
s_add_u32 s34, s34, s35
buffer_load_dwordx4 v[172:175], v170, s[20:23], s34 offen offset:0
buffer_load_dwordx4 v[172:175], v170, s[20:23], s34 offen offset:1024
s_add_u32 s34, s34, 8192
buffer_load_dwordx4 v[172:175], v170, s[20:23], s34 offen offset:0
buffer_load_dwordx4 v[172:175], v170, s[20:23], s34 offen offset:1024
s_add_u32 s34, s34, 8192
s_lshl_b32 s34, s29, 3
s_lshr_b32 s35, s31, 2
s_add_u32 s34, s34, s35
s_lshl_b32 s34, s34, 19
s_and_b32 s35, s31, 3
s_lshl_b32 s35, s35, 3
s_add_u32 s35, s35, s36
s_lshl_b32 s35, s35, 10
s_add_u32 s34, s34, s35
buffer_load_dwordx4 v[172:175], v170, s[24:27], s34 offen
buffer_load_dwordx4 v[172:175], v170, s[40:43], s34 offen
s_waitcnt vmcnt(32)
v_lshlrev_b32 v12, 16, v12
v_lshlrev_b32 v13, 16, v13
v_lshlrev_b32 v14, 16, v14
v_lshlrev_b32 v15, 16, v15
v_mul_f32 v128, 0xbfb8aa3b, v12
v_mul_f32 v129, 0xbfb8aa3b, v13
v_mul_f32 v130, 0xbfb8aa3b, v14
v_mul_f32 v131, 0xbfb8aa3b, v15
v_exp_f32 v128, v128
v_exp_f32 v129, v129
v_exp_f32 v130, v130
v_exp_f32 v131, v131
v_add_f32 v128, 1.0, v128
v_add_f32 v129, 1.0, v129
v_add_f32 v130, 1.0, v130
v_add_f32 v131, 1.0, v131
v_rcp_f32 v128, v128
v_rcp_f32 v129, v129
v_rcp_f32 v130, v130
v_rcp_f32 v131, v131
v_mul_f32 v128, v12, v128
v_mul_f32 v129, v13, v129
v_mul_f32 v130, v14, v130
v_mul_f32 v131, v15, v131
v_cvt_pk_bf16_f32 v128, v128, v128
v_cvt_pk_bf16_f32 v129, v129, v129
v_cvt_pk_bf16_f32 v130, v130, v130
v_cvt_pk_bf16_f32 v131, v131, v131
v_lshlrev_b32 v128, 16, v128
v_lshlrev_b32 v129, 16, v129
v_lshlrev_b32 v130, 16, v130
v_lshlrev_b32 v131, 16, v131
v_lshrrev_b32 v142, 4, v0
v_mul_u32_u24 v142, 384, v142
v_lshl_add_u32 v142, v3, 5, v142
s_waitcnt vmcnt(24)
v_lshlrev_b32 v132, 16, v16
v_and_b32 v133, 0xffff0000, v16
v_mul_f32 v144, v132, v128
v_mul_f32 v145, v133, v128
v_lshlrev_b32 v132, 16, v17
v_and_b32 v133, 0xffff0000, v17
v_mul_f32 v146, v132, v128
v_mul_f32 v147, v133, v128
v_lshlrev_b32 v132, 16, v18
v_and_b32 v133, 0xffff0000, v18
v_mul_f32 v148, v132, v128
v_mul_f32 v149, v133, v128
v_lshlrev_b32 v132, 16, v19
v_and_b32 v133, 0xffff0000, v19
v_mul_f32 v150, v132, v128
v_mul_f32 v151, v133, v128
v_lshlrev_b32 v132, 16, v20
v_and_b32 v133, 0xffff0000, v20
v_fmac_f32 v144, v132, v129
v_fmac_f32 v145, v133, v129
v_lshlrev_b32 v132, 16, v21
v_and_b32 v133, 0xffff0000, v21
v_fmac_f32 v146, v132, v129
v_fmac_f32 v147, v133, v129
v_lshlrev_b32 v132, 16, v22
v_and_b32 v133, 0xffff0000, v22
v_fmac_f32 v148, v132, v129
v_fmac_f32 v149, v133, v129
v_lshlrev_b32 v132, 16, v23
v_and_b32 v133, 0xffff0000, v23
v_fmac_f32 v150, v132, v129
v_fmac_f32 v151, v133, v129
v_lshlrev_b32 v132, 16, v24
v_and_b32 v133, 0xffff0000, v24
v_fmac_f32 v144, v132, v130
v_fmac_f32 v145, v133, v130
v_lshlrev_b32 v132, 16, v25
v_and_b32 v133, 0xffff0000, v25
v_fmac_f32 v146, v132, v130
v_fmac_f32 v147, v133, v130
v_lshlrev_b32 v132, 16, v26
v_and_b32 v133, 0xffff0000, v26
v_fmac_f32 v148, v132, v130
v_fmac_f32 v149, v133, v130
v_lshlrev_b32 v132, 16, v27
v_and_b32 v133, 0xffff0000, v27
v_fmac_f32 v150, v132, v130
v_fmac_f32 v151, v133, v130
v_lshlrev_b32 v132, 16, v28
v_and_b32 v133, 0xffff0000, v28
v_fmac_f32 v144, v132, v131
v_fmac_f32 v145, v133, v131
v_lshlrev_b32 v132, 16, v29
v_and_b32 v133, 0xffff0000, v29
v_fmac_f32 v146, v132, v131
v_fmac_f32 v147, v133, v131
v_lshlrev_b32 v132, 16, v30
v_and_b32 v133, 0xffff0000, v30
v_fmac_f32 v148, v132, v131
v_fmac_f32 v149, v133, v131
v_lshlrev_b32 v132, 16, v31
v_and_b32 v133, 0xffff0000, v31
v_fmac_f32 v150, v132, v131
v_fmac_f32 v151, v133, v131
s_nop 1
v_add_f32_dpp v134, v144, v144 row_ror:4 row_mask:0xf bank_mask:0xf
v_add_f32_dpp v135, v145, v145 row_ror:4 row_mask:0xf bank_mask:0xf
v_add_f32_dpp v136, v146, v146 row_ror:4 row_mask:0xf bank_mask:0xf
v_add_f32_dpp v137, v147, v147 row_ror:4 row_mask:0xf bank_mask:0xf
v_add_f32_dpp v138, v148, v148 row_ror:4 row_mask:0xf bank_mask:0xf
v_add_f32_dpp v139, v149, v149 row_ror:4 row_mask:0xf bank_mask:0xf
v_add_f32_dpp v140, v150, v150 row_ror:4 row_mask:0xf bank_mask:0xf
v_add_f32_dpp v141, v151, v151 row_ror:4 row_mask:0xf bank_mask:0xf
s_nop 1
v_add_f32_dpp v144, v134, v134 row_ror:8 row_mask:0xf bank_mask:0xf
v_add_f32_dpp v145, v135, v135 row_ror:8 row_mask:0xf bank_mask:0xf
v_add_f32_dpp v146, v136, v136 row_ror:8 row_mask:0xf bank_mask:0xf
v_add_f32_dpp v147, v137, v137 row_ror:8 row_mask:0xf bank_mask:0xf
v_add_f32_dpp v148, v138, v138 row_ror:8 row_mask:0xf bank_mask:0xf
v_add_f32_dpp v149, v139, v139 row_ror:8 row_mask:0xf bank_mask:0xf
v_add_f32_dpp v150, v140, v140 row_ror:8 row_mask:0xf bank_mask:0xf
v_add_f32_dpp v151, v141, v141 row_ror:8 row_mask:0xf bank_mask:0xf
v_lshlrev_b32 v132, 16, v32
v_and_b32 v133, 0xffff0000, v32
v_mul_f32 v152, v132, v128
v_mul_f32 v153, v133, v128
v_lshlrev_b32 v132, 16, v33
v_and_b32 v133, 0xffff0000, v33
v_mul_f32 v154, v132, v128
v_mul_f32 v155, v133, v128
v_lshlrev_b32 v132, 16, v34
v_and_b32 v133, 0xffff0000, v34
v_mul_f32 v156, v132, v128
v_mul_f32 v157, v133, v128
v_lshlrev_b32 v132, 16, v35
v_and_b32 v133, 0xffff0000, v35
v_mul_f32 v158, v132, v128
v_mul_f32 v159, v133, v128
v_lshlrev_b32 v132, 16, v36
v_and_b32 v133, 0xffff0000, v36
v_fmac_f32 v152, v132, v129
v_fmac_f32 v153, v133, v129
v_lshlrev_b32 v132, 16, v37
v_and_b32 v133, 0xffff0000, v37
v_fmac_f32 v154, v132, v129
v_fmac_f32 v155, v133, v129
v_lshlrev_b32 v132, 16, v38
v_and_b32 v133, 0xffff0000, v38
v_fmac_f32 v156, v132, v129
v_fmac_f32 v157, v133, v129
v_lshlrev_b32 v132, 16, v39
v_and_b32 v133, 0xffff0000, v39
v_fmac_f32 v158, v132, v129
v_fmac_f32 v159, v133, v129
v_lshlrev_b32 v132, 16, v40
v_and_b32 v133, 0xffff0000, v40
v_fmac_f32 v152, v132, v130
v_fmac_f32 v153, v133, v130
v_lshlrev_b32 v132, 16, v41
v_and_b32 v133, 0xffff0000, v41
v_fmac_f32 v154, v132, v130
v_fmac_f32 v155, v133, v130
v_lshlrev_b32 v132, 16, v42
v_and_b32 v133, 0xffff0000, v42
v_fmac_f32 v156, v132, v130
v_fmac_f32 v157, v133, v130
v_lshlrev_b32 v132, 16, v43
v_and_b32 v133, 0xffff0000, v43
v_fmac_f32 v158, v132, v130
v_fmac_f32 v159, v133, v130
v_lshlrev_b32 v132, 16, v44
v_and_b32 v133, 0xffff0000, v44
v_fmac_f32 v152, v132, v131
v_fmac_f32 v153, v133, v131
v_lshlrev_b32 v132, 16, v45
v_and_b32 v133, 0xffff0000, v45
v_fmac_f32 v154, v132, v131
v_fmac_f32 v155, v133, v131
v_lshlrev_b32 v132, 16, v46
v_and_b32 v133, 0xffff0000, v46
v_fmac_f32 v156, v132, v131
v_fmac_f32 v157, v133, v131
v_lshlrev_b32 v132, 16, v47
v_and_b32 v133, 0xffff0000, v47
v_fmac_f32 v158, v132, v131
v_fmac_f32 v159, v133, v131
s_nop 1
v_add_f32_dpp v134, v152, v152 row_ror:4 row_mask:0xf bank_mask:0xf
v_add_f32_dpp v135, v153, v153 row_ror:4 row_mask:0xf bank_mask:0xf
v_add_f32_dpp v136, v154, v154 row_ror:4 row_mask:0xf bank_mask:0xf
v_add_f32_dpp v137, v155, v155 row_ror:4 row_mask:0xf bank_mask:0xf
v_add_f32_dpp v138, v156, v156 row_ror:4 row_mask:0xf bank_mask:0xf
v_add_f32_dpp v139, v157, v157 row_ror:4 row_mask:0xf bank_mask:0xf
v_add_f32_dpp v140, v158, v158 row_ror:4 row_mask:0xf bank_mask:0xf
v_add_f32_dpp v141, v159, v159 row_ror:4 row_mask:0xf bank_mask:0xf
s_nop 1
v_add_f32_dpp v152, v134, v134 row_ror:8 row_mask:0xf bank_mask:0xf
v_add_f32_dpp v153, v135, v135 row_ror:8 row_mask:0xf bank_mask:0xf
v_add_f32_dpp v154, v136, v136 row_ror:8 row_mask:0xf bank_mask:0xf
v_add_f32_dpp v155, v137, v137 row_ror:8 row_mask:0xf bank_mask:0xf
v_add_f32_dpp v156, v138, v138 row_ror:8 row_mask:0xf bank_mask:0xf
v_add_f32_dpp v157, v139, v139 row_ror:8 row_mask:0xf bank_mask:0xf
v_add_f32_dpp v158, v140, v140 row_ror:8 row_mask:0xf bank_mask:0xf
v_add_f32_dpp v159, v141, v141 row_ror:8 row_mask:0xf bank_mask:0xf
ds_write_b128 v142, v[144:147] offset:2048
ds_write_b128 v142, v[148:151] offset:2064
ds_write_b128 v142, v[152:155] offset:2176
ds_write_b128 v142, v[156:159] offset:2192
v_mov_b32 v143, 0x3f803f80
s_waitcnt vmcnt(8)
v_mov_b32 v160, 0
v_mov_b32 v161, 0
v_dot2c_f32_bf16 v160, v64, v143
v_dot2c_f32_bf16 v161, v64, v64
v_dot2c_f32_bf16 v160, v65, v143
v_dot2c_f32_bf16 v161, v65, v65
v_dot2c_f32_bf16 v160, v66, v143
v_dot2c_f32_bf16 v161, v66, v66
v_dot2c_f32_bf16 v160, v67, v143
v_dot2c_f32_bf16 v161, v67, v67
v_dot2c_f32_bf16 v160, v68, v143
v_dot2c_f32_bf16 v161, v68, v68
v_dot2c_f32_bf16 v160, v69, v143
v_dot2c_f32_bf16 v161, v69, v69
v_dot2c_f32_bf16 v160, v70, v143
v_dot2c_f32_bf16 v161, v70, v70
v_dot2c_f32_bf16 v160, v71, v143
v_dot2c_f32_bf16 v161, v71, v71
v_dot2c_f32_bf16 v160, v72, v143
v_dot2c_f32_bf16 v161, v72, v72
v_dot2c_f32_bf16 v160, v73, v143
v_dot2c_f32_bf16 v161, v73, v73
v_dot2c_f32_bf16 v160, v74, v143
v_dot2c_f32_bf16 v161, v74, v74
v_dot2c_f32_bf16 v160, v75, v143
v_dot2c_f32_bf16 v161, v75, v75
v_dot2c_f32_bf16 v160, v76, v143
v_dot2c_f32_bf16 v161, v76, v76
v_dot2c_f32_bf16 v160, v77, v143
v_dot2c_f32_bf16 v161, v77, v77
v_dot2c_f32_bf16 v160, v78, v143
v_dot2c_f32_bf16 v161, v78, v78
v_dot2c_f32_bf16 v160, v79, v143
v_dot2c_f32_bf16 v161, v79, v79
v_dot2c_f32_bf16 v160, v80, v143
v_dot2c_f32_bf16 v161, v80, v80
v_dot2c_f32_bf16 v160, v81, v143
v_dot2c_f32_bf16 v161, v81, v81
v_dot2c_f32_bf16 v160, v82, v143
v_dot2c_f32_bf16 v161, v82, v82
v_dot2c_f32_bf16 v160, v83, v143
v_dot2c_f32_bf16 v161, v83, v83
v_dot2c_f32_bf16 v160, v84, v143
v_dot2c_f32_bf16 v161, v84, v84
v_dot2c_f32_bf16 v160, v85, v143
v_dot2c_f32_bf16 v161, v85, v85
v_dot2c_f32_bf16 v160, v86, v143
v_dot2c_f32_bf16 v161, v86, v86
v_dot2c_f32_bf16 v160, v87, v143
v_dot2c_f32_bf16 v161, v87, v87
v_dot2c_f32_bf16 v160, v88, v143
v_dot2c_f32_bf16 v161, v88, v88
v_dot2c_f32_bf16 v160, v89, v143
v_dot2c_f32_bf16 v161, v89, v89
v_dot2c_f32_bf16 v160, v90, v143
v_dot2c_f32_bf16 v161, v90, v90
v_dot2c_f32_bf16 v160, v91, v143
v_dot2c_f32_bf16 v161, v91, v91
v_dot2c_f32_bf16 v160, v92, v143
v_dot2c_f32_bf16 v161, v92, v92
v_dot2c_f32_bf16 v160, v93, v143
v_dot2c_f32_bf16 v161, v93, v93
v_dot2c_f32_bf16 v160, v94, v143
v_dot2c_f32_bf16 v161, v94, v94
v_dot2c_f32_bf16 v160, v95, v143
v_dot2c_f32_bf16 v161, v95, v95
v_mov_b32 v162, 0
v_mov_b32 v163, 0
v_dot2c_f32_bf16 v162, v96, v143
v_dot2c_f32_bf16 v163, v96, v96
v_dot2c_f32_bf16 v162, v97, v143
v_dot2c_f32_bf16 v163, v97, v97
v_dot2c_f32_bf16 v162, v98, v143
v_dot2c_f32_bf16 v163, v98, v98
v_dot2c_f32_bf16 v162, v99, v143
v_dot2c_f32_bf16 v163, v99, v99
v_dot2c_f32_bf16 v162, v100, v143
v_dot2c_f32_bf16 v163, v100, v100
v_dot2c_f32_bf16 v162, v101, v143
v_dot2c_f32_bf16 v163, v101, v101
v_dot2c_f32_bf16 v162, v102, v143
v_dot2c_f32_bf16 v163, v102, v102
v_dot2c_f32_bf16 v162, v103, v143
v_dot2c_f32_bf16 v163, v103, v103
v_dot2c_f32_bf16 v162, v104, v143
v_dot2c_f32_bf16 v163, v104, v104
v_dot2c_f32_bf16 v162, v105, v143
v_dot2c_f32_bf16 v163, v105, v105
v_dot2c_f32_bf16 v162, v106, v143
v_dot2c_f32_bf16 v163, v106, v106
v_dot2c_f32_bf16 v162, v107, v143
v_dot2c_f32_bf16 v163, v107, v107
v_dot2c_f32_bf16 v162, v108, v143
v_dot2c_f32_bf16 v163, v108, v108
v_dot2c_f32_bf16 v162, v109, v143
v_dot2c_f32_bf16 v163, v109, v109
v_dot2c_f32_bf16 v162, v110, v143
v_dot2c_f32_bf16 v163, v110, v110
v_dot2c_f32_bf16 v162, v111, v143
v_dot2c_f32_bf16 v163, v111, v111
v_dot2c_f32_bf16 v162, v112, v143
v_dot2c_f32_bf16 v163, v112, v112
v_dot2c_f32_bf16 v162, v113, v143
v_dot2c_f32_bf16 v163, v113, v113
v_dot2c_f32_bf16 v162, v114, v143
v_dot2c_f32_bf16 v163, v114, v114
v_dot2c_f32_bf16 v162, v115, v143
v_dot2c_f32_bf16 v163, v115, v115
v_dot2c_f32_bf16 v162, v116, v143
v_dot2c_f32_bf16 v163, v116, v116
v_dot2c_f32_bf16 v162, v117, v143
v_dot2c_f32_bf16 v163, v117, v117
v_dot2c_f32_bf16 v162, v118, v143
v_dot2c_f32_bf16 v163, v118, v118
v_dot2c_f32_bf16 v162, v119, v143
v_dot2c_f32_bf16 v163, v119, v119
v_dot2c_f32_bf16 v162, v120, v143
v_dot2c_f32_bf16 v163, v120, v120
v_dot2c_f32_bf16 v162, v121, v143
v_dot2c_f32_bf16 v163, v121, v121
v_dot2c_f32_bf16 v162, v122, v143
v_dot2c_f32_bf16 v163, v122, v122
v_dot2c_f32_bf16 v162, v123, v143
v_dot2c_f32_bf16 v163, v123, v123
v_dot2c_f32_bf16 v162, v124, v143
v_dot2c_f32_bf16 v163, v124, v124
v_dot2c_f32_bf16 v162, v125, v143
v_dot2c_f32_bf16 v163, v125, v125
v_dot2c_f32_bf16 v162, v126, v143
v_dot2c_f32_bf16 v163, v126, v126
v_dot2c_f32_bf16 v162, v127, v143
v_dot2c_f32_bf16 v163, v127, v127
s_nop 3
v_add_f32_dpp v164, v160, v160 quad_perm:[1,0,3,2] row_mask:0xf bank_mask:0xf
v_add_f32_dpp v165, v161, v161 quad_perm:[1,0,3,2] row_mask:0xf bank_mask:0xf
v_add_f32_dpp v166, v162, v162 quad_perm:[1,0,3,2] row_mask:0xf bank_mask:0xf
v_add_f32_dpp v167, v163, v163 quad_perm:[1,0,3,2] row_mask:0xf bank_mask:0xf
s_nop 1
v_add_f32_dpp v160, v164, v164 quad_perm:[2,3,0,1] row_mask:0xf bank_mask:0xf
v_add_f32_dpp v161, v165, v165 quad_perm:[2,3,0,1] row_mask:0xf bank_mask:0xf
v_add_f32_dpp v162, v166, v166 quad_perm:[2,3,0,1] row_mask:0xf bank_mask:0xf
v_add_f32_dpp v163, v167, v167 quad_perm:[2,3,0,1] row_mask:0xf bank_mask:0xf
s_nop 1
v_add_f32_dpp v164, v160, v160 row_half_mirror row_mask:0xf bank_mask:0xf
v_add_f32_dpp v165, v161, v161 row_half_mirror row_mask:0xf bank_mask:0xf
v_add_f32_dpp v166, v162, v162 row_half_mirror row_mask:0xf bank_mask:0xf
v_add_f32_dpp v167, v163, v163 row_half_mirror row_mask:0xf bank_mask:0xf
v_mul_f32 v164, 0x3b000000, v164
v_mul_f32 v165, 0x3b000000, v165
v_fma_f32 v165, -v164, v164, v165
v_max_f32 v165, 0, v165
v_cvt_pk_bf16_f32 v168, v164, v165
v_lshlrev_b32 v164, 16, v168
v_and_b32 v165, 0xffff0000, v168
v_add_f32 v165, 0x3727c5ac, v165
v_cvt_pk_bf16_f32 v165, v165, v165
v_lshlrev_b32 v165, 16, v165
v_sqrt_f32 v165, v165
s_nop 0
v_cvt_pk_bf16_f32 v165, v165, v165
v_lshlrev_b32 v165, 16, v165
v_rcp_f32 v165, v165
v_mul_f32 v166, 0x3b000000, v166
v_mul_f32 v167, 0x3b000000, v167
v_fma_f32 v167, -v166, v166, v167
v_max_f32 v167, 0, v167
v_cvt_pk_bf16_f32 v168, v166, v167
v_lshlrev_b32 v166, 16, v168
v_and_b32 v167, 0xffff0000, v168
v_add_f32 v167, 0x3727c5ac, v167
v_cvt_pk_bf16_f32 v167, v167, v167
v_lshlrev_b32 v167, 16, v167
v_sqrt_f32 v167, v167
s_nop 0
v_cvt_pk_bf16_f32 v167, v167, v167
v_lshlrev_b32 v167, 16, v167
v_rcp_f32 v167, v167
v_lshlrev_b32 v169, 3, v9
s_nop 0
ds_write_b64 v169, v[164:165]
ds_write_b64 v169, v[166:167] offset:64
s_waitcnt vmcnt(6)
v_lshlrev_b32 v53, 16, v53
v_mul_f32 v54, 0xbfb8aa3b, v53
v_exp_f32 v54, v54
s_nop 0
v_add_f32 v54, 1.0, v54
v_rcp_f32 v54, v54
s_nop 0
v_mul_f32 v54, v53, v54
v_cvt_pk_bf16_f32 v54, v54, v54
v_lshlrev_b32 v54, 16, v54
v_lshlrev_b32 v132, 16, v48
v_and_b32 v133, 0xffff0000, v48
v_mul_f32 v144, v132, v54
v_mul_f32 v145, v133, v54
v_lshlrev_b32 v132, 16, v49
v_and_b32 v133, 0xffff0000, v49
v_mul_f32 v146, v132, v54
v_mul_f32 v147, v133, v54
v_lshlrev_b32 v132, 16, v50
v_and_b32 v133, 0xffff0000, v50
v_mul_f32 v148, v132, v54
v_mul_f32 v149, v133, v54
v_lshlrev_b32 v132, 16, v51
v_and_b32 v133, 0xffff0000, v51
v_mul_f32 v150, v132, v54
v_mul_f32 v151, v133, v54
s_nop 1
v_add_f32_dpp v134, v144, v144 row_ror:1 row_mask:0xf bank_mask:0xf
v_add_f32_dpp v135, v145, v145 row_ror:1 row_mask:0xf bank_mask:0xf
v_add_f32_dpp v136, v146, v146 row_ror:1 row_mask:0xf bank_mask:0xf
v_add_f32_dpp v137, v147, v147 row_ror:1 row_mask:0xf bank_mask:0xf
v_add_f32_dpp v138, v148, v148 row_ror:1 row_mask:0xf bank_mask:0xf
v_add_f32_dpp v139, v149, v149 row_ror:1 row_mask:0xf bank_mask:0xf
v_add_f32_dpp v140, v150, v150 row_ror:1 row_mask:0xf bank_mask:0xf
v_add_f32_dpp v141, v151, v151 row_ror:1 row_mask:0xf bank_mask:0xf
s_nop 1
v_add_f32_dpp v144, v134, v134 row_ror:2 row_mask:0xf bank_mask:0xf
v_add_f32_dpp v145, v135, v135 row_ror:2 row_mask:0xf bank_mask:0xf
v_add_f32_dpp v146, v136, v136 row_ror:2 row_mask:0xf bank_mask:0xf
v_add_f32_dpp v147, v137, v137 row_ror:2 row_mask:0xf bank_mask:0xf
v_add_f32_dpp v148, v138, v138 row_ror:2 row_mask:0xf bank_mask:0xf
v_add_f32_dpp v149, v139, v139 row_ror:2 row_mask:0xf bank_mask:0xf
v_add_f32_dpp v150, v140, v140 row_ror:2 row_mask:0xf bank_mask:0xf
v_add_f32_dpp v151, v141, v141 row_ror:2 row_mask:0xf bank_mask:0xf
s_nop 1
v_add_f32_dpp v134, v144, v144 row_ror:4 row_mask:0xf bank_mask:0xf
v_add_f32_dpp v135, v145, v145 row_ror:4 row_mask:0xf bank_mask:0xf
v_add_f32_dpp v136, v146, v146 row_ror:4 row_mask:0xf bank_mask:0xf
v_add_f32_dpp v137, v147, v147 row_ror:4 row_mask:0xf bank_mask:0xf
v_add_f32_dpp v138, v148, v148 row_ror:4 row_mask:0xf bank_mask:0xf
v_add_f32_dpp v139, v149, v149 row_ror:4 row_mask:0xf bank_mask:0xf
v_add_f32_dpp v140, v150, v150 row_ror:4 row_mask:0xf bank_mask:0xf
v_add_f32_dpp v141, v151, v151 row_ror:4 row_mask:0xf bank_mask:0xf
s_nop 1
v_add_f32_dpp v144, v134, v134 row_ror:8 row_mask:0xf bank_mask:0xf
v_add_f32_dpp v145, v135, v135 row_ror:8 row_mask:0xf bank_mask:0xf
v_add_f32_dpp v146, v136, v136 row_ror:8 row_mask:0xf bank_mask:0xf
v_add_f32_dpp v147, v137, v137 row_ror:8 row_mask:0xf bank_mask:0xf
v_add_f32_dpp v148, v138, v138 row_ror:8 row_mask:0xf bank_mask:0xf
v_add_f32_dpp v149, v139, v139 row_ror:8 row_mask:0xf bank_mask:0xf
v_add_f32_dpp v150, v140, v140 row_ror:8 row_mask:0xf bank_mask:0xf
v_add_f32_dpp v151, v141, v141 row_ror:8 row_mask:0xf bank_mask:0xf
v_lshrrev_b32 v55, 4, v0
v_mul_u32_u24 v55, 384, v55
ds_write_b128 v55, v[144:147] offset:2304
ds_write_b128 v55, v[148:151] offset:2320
v_and_b32 v12, 31, v1
v_lshrrev_b32 v13, 5, v1
v_lshrrev_b32 v14, 1, v2
v_lshl_add_u32 v14, v14, 5, v12
v_and_b32 v15, 1, v2
v_lshlrev_b32 v16, 5, v15
v_lshl_add_u32 v16, v13, 4, v16
v_lshl_add_u32 v17, v14, 10, v16
s_add_u32 s33, s30, s72
buffer_load_dwordx4 v[20:23], v17, s[8:11], s33 offen
s_waitcnt lgkmcnt(0)
s_barrier
v_and_b32 v24, 127, v0
v_min_u32 v24, 71, v24
v_lshrrev_b32 v25, 7, v0
v_mul_u32_u24 v26, 3072, v25
v_lshl_add_u32 v26, v24, 2, v26
ds_read_b32 v28, v26 offset:2048
ds_read_b32 v29, v26 offset:2432
ds_read_b32 v30, v26 offset:2816
ds_read_b32 v31, v26 offset:3200
ds_read_b32 v32, v26 offset:3584
ds_read_b32 v33, v26 offset:3968
ds_read_b32 v34, v26 offset:4352
ds_read_b32 v35, v26 offset:4736
v_lshlrev_b32 v27, 3, v14
ds_read_b64 v[40:41], v27
s_waitcnt lgkmcnt(1)
v_add_f32 v28, v28, v29
v_add_f32 v28, v28, v30
v_add_f32 v28, v28, v31
v_add_f32 v28, v28, v32
v_add_f32 v28, v28, v33
v_add_f32 v28, v28, v34
v_add_f32 v28, v28, v35
v_lshlrev_b32 v26, 9, v25
v_lshl_add_u32 v26, v24, 2, v26
ds_write_b32 v26, v28 offset:14336
s_waitcnt lgkmcnt(0)
s_barrier
v_lshlrev_b32 v26, 1, v16
ds_read_b128 v[64:67], v26 offset:14336
ds_read_b128 v[68:71], v26 offset:14352
ds_read_b128 v[72:75], v26 offset:14848
ds_read_b128 v[76:79], v26 offset:14864
ds_read_b128 v[80:83], v26 offset:15360
ds_read_b128 v[84:87], v26 offset:15376
ds_read_b128 v[88:91], v26 offset:15872
ds_read_b128 v[92:95], v26 offset:15888
ds_read_b128 v[96:99], v26 offset:14464
ds_read_b128 v[100:103], v26 offset:14480
ds_read_b128 v[104:107], v26 offset:14976
ds_read_b128 v[108:111], v26 offset:14992
ds_read_b128 v[112:115], v26 offset:15488
ds_read_b128 v[116:119], v26 offset:15504
ds_read_b128 v[120:123], v26 offset:16000
ds_read_b128 v[124:127], v26 offset:16016
s_cmp_lg_u32 s36, 0
s_cbranch_scc1 pre_kernel_no3c
v_and_b32 v42, 3, v0
v_lshlrev_b32 v43, 3, v42
ds_read_b64 v[44:45], v43 offset:14592
ds_read_b64 v[46:47], v43 offset:15104
ds_read_b64 v[48:49], v43 offset:15616
ds_read_b64 v[50:51], v43 offset:16128
s_waitcnt lgkmcnt(0)
v_add_f32 v44, v44, v46
v_add_f32 v45, v45, v47
v_add_f32 v44, v44, v48
v_add_f32 v45, v45, v49
v_add_f32 v44, v44, v50
v_add_f32 v45, v45, v51
v_cvt_pk_bf16_f32 v44, v44, v45
v_lshlrev_b32 v43, 2, v42
buffer_store_dword v44, v43, s[12:15], s38 offen
pre_kernel_no3c:
s_waitcnt lgkmcnt(0)
v_add_f32 v64, v64, v72
v_add_f32 v80, v80, v88
v_add_f32 v65, v65, v73
v_add_f32 v81, v81, v89
v_add_f32 v66, v66, v74
v_add_f32 v82, v82, v90
v_add_f32 v67, v67, v75
v_add_f32 v83, v83, v91
v_add_f32 v68, v68, v76
v_add_f32 v84, v84, v92
v_add_f32 v69, v69, v77
v_add_f32 v85, v85, v93
v_add_f32 v70, v70, v78
v_add_f32 v86, v86, v94
v_add_f32 v71, v71, v79
v_add_f32 v87, v87, v95
v_add_f32 v64, v64, v80
v_add_f32 v65, v65, v81
v_add_f32 v66, v66, v82
v_add_f32 v67, v67, v83
v_add_f32 v68, v68, v84
v_add_f32 v69, v69, v85
v_add_f32 v70, v70, v86
v_add_f32 v71, v71, v87
v_add_f32 v96, v96, v104
v_add_f32 v112, v112, v120
v_add_f32 v97, v97, v105
v_add_f32 v113, v113, v121
v_add_f32 v98, v98, v106
v_add_f32 v114, v114, v122
v_add_f32 v99, v99, v107
v_add_f32 v115, v115, v123
v_add_f32 v100, v100, v108
v_add_f32 v116, v116, v124
v_add_f32 v101, v101, v109
v_add_f32 v117, v117, v125
v_add_f32 v102, v102, v110
v_add_f32 v118, v118, v126
v_add_f32 v103, v103, v111
v_add_f32 v119, v119, v127
v_add_f32 v96, v96, v112
v_add_f32 v97, v97, v113
v_add_f32 v98, v98, v114
v_add_f32 v99, v99, v115
v_add_f32 v100, v100, v116
v_add_f32 v101, v101, v117
v_add_f32 v102, v102, v118
v_add_f32 v103, v103, v119
v_cvt_pk_bf16_f32 v50, v64, v65
v_lshlrev_b32 v64, 16, v50
v_and_b32 v65, 0xffff0000, v50
v_cvt_pk_bf16_f32 v50, v96, v97
v_lshlrev_b32 v96, 16, v50
v_and_b32 v97, 0xffff0000, v50
v_add_f32 v96, 1.0, v96
v_add_f32 v97, 1.0, v97
v_cvt_pk_bf16_f32 v50, v96, v97
v_lshlrev_b32 v96, 16, v50
v_and_b32 v97, 0xffff0000, v50
v_cvt_pk_bf16_f32 v50, v66, v67
v_lshlrev_b32 v66, 16, v50
v_and_b32 v67, 0xffff0000, v50
v_cvt_pk_bf16_f32 v50, v98, v99
v_lshlrev_b32 v98, 16, v50
v_and_b32 v99, 0xffff0000, v50
v_add_f32 v98, 1.0, v98
v_add_f32 v99, 1.0, v99
v_cvt_pk_bf16_f32 v50, v98, v99
v_lshlrev_b32 v98, 16, v50
v_and_b32 v99, 0xffff0000, v50
v_cvt_pk_bf16_f32 v50, v68, v69
v_lshlrev_b32 v68, 16, v50
v_and_b32 v69, 0xffff0000, v50
v_cvt_pk_bf16_f32 v50, v100, v101
v_lshlrev_b32 v100, 16, v50
v_and_b32 v101, 0xffff0000, v50
v_add_f32 v100, 1.0, v100
v_add_f32 v101, 1.0, v101
v_cvt_pk_bf16_f32 v50, v100, v101
v_lshlrev_b32 v100, 16, v50
v_and_b32 v101, 0xffff0000, v50
v_cvt_pk_bf16_f32 v50, v70, v71
v_lshlrev_b32 v70, 16, v50
v_and_b32 v71, 0xffff0000, v50
v_cvt_pk_bf16_f32 v50, v102, v103
v_lshlrev_b32 v102, 16, v50
v_and_b32 v103, 0xffff0000, v50
v_add_f32 v102, 1.0, v102
v_add_f32 v103, 1.0, v103
v_cvt_pk_bf16_f32 v50, v102, v103
v_lshlrev_b32 v102, 16, v50
v_and_b32 v103, 0xffff0000, v50
s_waitcnt vmcnt(1)
s_waitcnt vmcnt(0)
v_lshlrev_b32 v52, 16, v20
v_and_b32 v53, 0xffff0000, v20
v_sub_f32 v52, v52, v40
v_sub_f32 v53, v53, v40
v_cvt_pk_bf16_f32 v50, v52, v53
v_lshlrev_b32 v52, 16, v50
v_and_b32 v53, 0xffff0000, v50
v_mul_f32 v52, v52, v41
v_mul_f32 v53, v53, v41
v_cvt_pk_bf16_f32 v50, v52, v53
v_lshlrev_b32 v52, 16, v50
v_and_b32 v53, 0xffff0000, v50
v_mul_f32 v52, v52, v96
v_mul_f32 v53, v53, v97
v_cvt_pk_bf16_f32 v50, v52, v53
v_lshlrev_b32 v52, 16, v50
v_and_b32 v53, 0xffff0000, v50
v_add_f32 v52, v52, v64
v_add_f32 v53, v53, v65
v_cvt_pk_bf16_f32 v60, v52, v53
v_lshlrev_b32 v54, 16, v21
v_and_b32 v55, 0xffff0000, v21
v_sub_f32 v54, v54, v40
v_sub_f32 v55, v55, v40
v_cvt_pk_bf16_f32 v50, v54, v55
v_lshlrev_b32 v54, 16, v50
v_and_b32 v55, 0xffff0000, v50
v_mul_f32 v54, v54, v41
v_mul_f32 v55, v55, v41
v_cvt_pk_bf16_f32 v50, v54, v55
v_lshlrev_b32 v54, 16, v50
v_and_b32 v55, 0xffff0000, v50
v_mul_f32 v54, v54, v98
v_mul_f32 v55, v55, v99
v_cvt_pk_bf16_f32 v50, v54, v55
v_lshlrev_b32 v54, 16, v50
v_and_b32 v55, 0xffff0000, v50
v_add_f32 v54, v54, v66
v_add_f32 v55, v55, v67
v_cvt_pk_bf16_f32 v61, v54, v55
v_lshlrev_b32 v56, 16, v22
v_and_b32 v57, 0xffff0000, v22
v_sub_f32 v56, v56, v40
v_sub_f32 v57, v57, v40
v_cvt_pk_bf16_f32 v50, v56, v57
v_lshlrev_b32 v56, 16, v50
v_and_b32 v57, 0xffff0000, v50
v_mul_f32 v56, v56, v41
v_mul_f32 v57, v57, v41
v_cvt_pk_bf16_f32 v50, v56, v57
v_lshlrev_b32 v56, 16, v50
v_and_b32 v57, 0xffff0000, v50
v_mul_f32 v56, v56, v100
v_mul_f32 v57, v57, v101
v_cvt_pk_bf16_f32 v50, v56, v57
v_lshlrev_b32 v56, 16, v50
v_and_b32 v57, 0xffff0000, v50
v_add_f32 v56, v56, v68
v_add_f32 v57, v57, v69
v_cvt_pk_bf16_f32 v62, v56, v57
v_lshlrev_b32 v58, 16, v23
v_and_b32 v59, 0xffff0000, v23
v_sub_f32 v58, v58, v40
v_sub_f32 v59, v59, v40
v_cvt_pk_bf16_f32 v50, v58, v59
v_lshlrev_b32 v58, 16, v50
v_and_b32 v59, 0xffff0000, v50
v_mul_f32 v58, v58, v41
v_mul_f32 v59, v59, v41
v_cvt_pk_bf16_f32 v50, v58, v59
v_lshlrev_b32 v58, 16, v50
v_and_b32 v59, 0xffff0000, v50
v_mul_f32 v58, v58, v102
v_mul_f32 v59, v59, v103
v_cvt_pk_bf16_f32 v50, v58, v59
v_lshlrev_b32 v58, 16, v50
v_and_b32 v59, 0xffff0000, v50
v_add_f32 v58, v58, v70
v_add_f32 v59, v59, v71
v_cvt_pk_bf16_f32 v63, v58, v59
v_lshrrev_b32 v24, 1, v2
v_lshlrev_b32 v24, 15, v24
v_lshl_add_u32 v24, v15, 10, v24
v_lshl_add_u32 v24, v1, 4, v24
s_lshl_b32 s34, s28, 17
s_lshl_b32 s35, s37, 11
s_add_u32 s34, s34, s35
buffer_store_dwordx4 v[60:63], v24, s[16:19], s34 offen
pre_kernel_done:
s_endpgm
.globl attn_kernel
.p2align 8
.type attn_kernel,@function
attn_kernel:
s_cmp_ge_u32 s2, 256
s_cbranch_scc1 attn_kernel_done
s_load_dwordx2 s[52:53], s[0:1], 24
s_load_dwordx2 s[54:55], s[0:1], 104
s_load_dwordx4 s[48:51], s[0:1], 8
s_load_dwordx2 s[80:81], s[0:1], 32
s_load_dwordx4 s[84:87], s[0:1], 48
s_load_dwordx2 s[82:83], s[0:1], 64
v_lshrrev_b32 v1, 6, v0
v_and_b32 v2, 63, v0
v_readfirstlane_b32 s28, v1
s_bfe_u32 s38, s2, 0x20001
s_lshr_b32 s39, s2, 3
s_lshl_b32 s29, s38, 3
s_and_b32 s38, s39, 7
s_add_u32 s29, s29, s38
s_lshr_b32 s30, s39, 3
s_and_b32 s38, s2, 1
s_lshl_b32 s38, s38, 2
s_add_u32 s30, s30, s38
s_lshl_b32 s35, s28, 12
v_lshrrev_b32 v3, 4, v2
v_and_b32 v4, 15, v2
v_lshlrev_b32 v186, 4, v2
s_lshl_b32 s38, s28, 3
v_add_u32 v10, s38, v3
v_lshlrev_b32 v11, 2, v3
v_xor_b32 v11, v11, v4
v_lshlrev_b32 v12, 13, v10
v_lshl_add_u32 v185, v11, 4, v12
s_lshl_b32 s38, s29, 8
v_add_u32 v185, s38, v185
s_lshl_b32 s38, s30, 3
s_lshl_b32 s39, s28, 1
s_add_u32 s44, s38, s39
s_lshl_b32 s42, s44, 15
s_add_u32 s43, s42, 32768
s_waitcnt lgkmcnt(0)
s_mov_b32 s16, s52
s_and_b32 s17, s53, 0xffff
s_mov_b32 s18, 4194304
s_mov_b32 s19, 0x00020000
s_add_u32 s20, s54, 1048576
s_addc_u32 s21, s55, 0
s_and_b32 s21, s21, 0xffff
s_mov_b32 s22, 2097152
s_mov_b32 s23, 0x00020000
s_add_u32 m0, s35, 0
s_mov_b32 s38, 0
buffer_load_dwordx4 v185, s[16:19], s38 offen lds
s_add_u32 m0, s35, 1024
s_mov_b32 s38, 32768
buffer_load_dwordx4 v185, s[16:19], s38 offen lds
s_add_u32 m0, s35, 2048
s_mov_b32 s38, 262144
buffer_load_dwordx4 v185, s[16:19], s38 offen lds
s_add_u32 m0, s35, 3072
s_mov_b32 s38, 294912
buffer_load_dwordx4 v185, s[16:19], s38 offen lds
buffer_load_dwordx4 a[0:3], v186, s[20:23], s42 offen offset:0
buffer_load_dwordx4 a[4:7], v186, s[20:23], s43 offen offset:0
buffer_load_dwordx4 a[8:11], v186, s[20:23], s42 offen offset:1024
buffer_load_dwordx4 a[12:15], v186, s[20:23], s43 offen offset:1024
buffer_load_dwordx4 a[16:19], v186, s[20:23], s42 offen offset:2048
buffer_load_dwordx4 a[20:23], v186, s[20:23], s43 offen offset:2048
buffer_load_dwordx4 a[24:27], v186, s[20:23], s42 offen offset:3072
buffer_load_dwordx4 a[28:31], v186, s[20:23], s43 offen offset:3072
s_add_u32 s42, s42, 4096
s_add_u32 s43, s43, 4096
s_add_u32 m0, s35, 16384
s_mov_b32 s38, 524288
buffer_load_dwordx4 v185, s[16:19], s38 offen lds
s_add_u32 m0, s35, 17408
s_mov_b32 s38, 557056
buffer_load_dwordx4 v185, s[16:19], s38 offen lds
s_add_u32 m0, s35, 18432
s_mov_b32 s38, 786432
buffer_load_dwordx4 v185, s[16:19], s38 offen lds
s_add_u32 m0, s35, 19456
s_mov_b32 s38, 819200
buffer_load_dwordx4 v185, s[16:19], s38 offen lds
v_lshrrev_b32 v5, 5, v2
v_and_b32 v6, 31, v2
v_and_b32 v7, 1, v3
v_lshrrev_b32 v8, 2, v4
v_and_b32 v9, 3, v2
v_lshlrev_b32 v12, 8, v10
v_lshl_add_u32 v184, v11, 4, v12
v_and_b32 v11, 15, v10
v_xor_b32 v11, v11, v4
v_lshl_add_u32 v182, v11, 4, v12
v_add_u32 v11, 4, v10
v_and_b32 v11, 15, v11
v_xor_b32 v11, v11, v4
v_lshl_add_u32 v183, v11, 4, v12
v_and_b32 v10, 15, v6
v_lshrrev_b32 v12, 3, v6
v_lshlrev_b32 v12, 12, v12
v_and_b32 v13, 7, v6
v_lshl_add_u32 v12, v13, 8, v12
v_add_u32 v11, 0, v5
v_xor_b32 v11, v11, v10
v_lshl_add_u32 v16, v11, 4, v12
v_add_u32 v210, 0x10000, v16
v_add_u32 v11, 2, v5
v_xor_b32 v11, v11, v10
v_lshl_add_u32 v17, v11, 4, v12
v_add_u32 v211, 0x10000, v17
v_add_u32 v11, 4, v5
v_xor_b32 v11, v11, v10
v_lshl_add_u32 v18, v11, 4, v12
v_add_u32 v212, 0x10000, v18
v_add_u32 v11, 6, v5
v_xor_b32 v11, v11, v10
v_lshl_add_u32 v19, v11, 4, v12
v_add_u32 v213, 0x10000, v19
v_add_u32 v11, 8, v5
v_xor_b32 v11, v11, v10
v_lshl_add_u32 v20, v11, 4, v12
v_add_u32 v214, 0x10000, v20
v_add_u32 v11, 10, v5
v_xor_b32 v11, v11, v10
v_lshl_add_u32 v21, v11, 4, v12
v_add_u32 v215, 0x10000, v21
v_add_u32 v11, 12, v5
v_xor_b32 v11, v11, v10
v_lshl_add_u32 v22, v11, 4, v12
v_add_u32 v216, 0x10000, v22
v_add_u32 v11, 14, v5
v_xor_b32 v11, v11, v10
v_lshl_add_u32 v23, v11, 4, v12
v_add_u32 v217, 0x10000, v23
v_lshl_add_u32 v10, v5, 2, v8
v_lshlrev_b32 v10, 8, v10
v_lshl_add_u32 v10, v7, 5, v10
v_lshl_add_u32 v13, v9, 3, v10
v_add_u32 v13, 2048, v13
v_xor_b32 v11, 0, v8
v_lshl_add_u32 v24, v11, 6, v13
v_add_u32 v218, 0x10000, v24
v_xor_b32 v11, 1, v8
v_lshl_add_u32 v25, v11, 6, v13
v_add_u32 v219, 0x10000, v25
v_xor_b32 v11, 2, v8
v_lshl_add_u32 v26, v11, 6, v13
v_add_u32 v220, 0x10000, v26
v_xor_b32 v11, 3, v8
v_lshl_add_u32 v27, v11, 6, v13
v_add_u32 v221, 0x10000, v27
v_lshlrev_b32 v10, 12, v5
v_lshl_add_u32 v10, v8, 8, v10
v_lshl_add_u32 v10, v7, 5, v10
v_and_b32 v11, 1, v9
v_lshlrev_b32 v11, 1, v11
v_lshrrev_b32 v12, 1, v9
v_or_b32 v11, v11, v12
v_lshl_add_u32 v13, v11, 3, v10
v_xor_b32 v11, 0, v8
v_lshl_add_u32 v28, v11, 6, v13
v_add_u32 v200, 0x10000, v28
v_xor_b32 v11, 1, v8
v_lshl_add_u32 v29, v11, 6, v13
v_add_u32 v201, 0x10000, v29
v_xor_b32 v11, 2, v8
v_lshl_add_u32 v30, v11, 6, v13
v_add_u32 v202, 0x10000, v30
v_xor_b32 v11, 3, v8
v_lshl_add_u32 v31, v11, 6, v13
v_add_u32 v203, 0x10000, v31
v_mov_b32 v180, 0x67800000
v_mov_b32 v160, 0
v_mov_b32 v161, 0
s_lshl_b32 s38, s29, 19
s_add_u32 s8, s48, s38
s_addc_u32 s9, s49, 0
s_and_b32 s9, s9, 0xffff
s_mov_b32 s10, 524288
s_mov_b32 s11, 0x00020000
s_sub_u32 s50, s50, 10240
s_subb_u32 s51, s51, 0
s_add_u32 s12, s50, s38
s_addc_u32 s13, s51, 0
s_and_b32 s13, s13, 0xffff
s_mov_b32 s14, 534528
s_mov_b32 s15, 0x00020000
s_add_u32 s24, s54, 4194304
s_addc_u32 s25, s55, 0
s_and_b32 s25, s25, 0xffff
s_mov_b32 s26, 16777216
s_mov_b32 s27, 0x00020000
s_lshl_b32 s44, s44, 18
s_lshl_b32 s39, s29, 13
s_add_u32 s44, s44, s39
s_add_u32 s45, s44, 4096
s_add_u32 s46, s44, 262144
s_add_u32 s47, s46, 4096
s_mov_b32 s4, s80
s_and_b32 s5, s81, 0xffff
s_mov_b32 s6, 4194304
s_mov_b32 s7, 0x00020000
s_mov_b32 s48, s84
s_and_b32 s49, s85, 0xffff
s_mov_b32 s50, 1835008
s_mov_b32 s51, 0x00020000
s_mov_b32 s52, s86
s_and_b32 s53, s87, 0xffff
s_mov_b32 s54, 1835008
s_mov_b32 s55, 0x00020000
s_mov_b32 s60, s82
s_and_b32 s61, s83, 0xffff
s_mov_b32 s62, 1835008
s_mov_b32 s63, 0x00020000
s_lshl_b32 s57, s2, 12
s_bfe_u32 s38, s2, 0x20001
s_lshl_b32 s38, s38, 20
s_lshr_b32 s39, s2, 3
s_lshl_b32 s39, s39, 15
s_add_u32 s38, s38, s39
s_lshl_b32 s39, s28, 13
s_add_u32 s58, s38, s39
s_add_u32 s59, s58, 4096
v_lshlrev_b32 v208, 4, v0
s_waitcnt vmcnt(12)
s_barrier
ds_read_b64_tr_b16 a[192:193], v28 offset:0
ds_read_b64_tr_b16 a[194:195], v28 offset:1024
ds_read_b64_tr_b16 a[196:197], v29 offset:0
ds_read_b64_tr_b16 a[198:199], v29 offset:1024
ds_read_b64_tr_b16 a[200:201], v30 offset:0
ds_read_b64_tr_b16 a[202:203], v30 offset:1024
ds_read_b64_tr_b16 a[204:205], v31 offset:0
ds_read_b64_tr_b16 a[206:207], v31 offset:1024
s_waitcnt vmcnt(10)
s_waitcnt lgkmcnt(0)
v_mfma_f32_32x32x16_bf16 v[32:47], a[192:195], a[0:3], 0
ds_read_b64_tr_b16 a[208:209], v28 offset:8192
buffer_load_dwordx4 a[32:35], v186, s[20:23], s42 offen offset:0
ds_read_b64_tr_b16 a[210:211], v28 offset:9216
v_mfma_f32_32x32x16_bf16 v[48:63], a[192:195], a[4:7], 0
buffer_load_dwordx4 a[36:39], v186, s[20:23], s43 offen offset:0
ds_read_b64_tr_b16 a[212:213], v29 offset:8192
v_mfma_f32_32x32x16_bf16 v[64:79], a[196:199], a[0:3], 0
buffer_load_dwordx4 a[40:43], v186, s[20:23], s42 offen offset:1024
ds_read_b64_tr_b16 a[214:215], v29 offset:9216
v_mfma_f32_32x32x16_bf16 v[80:95], a[196:199], a[4:7], 0
ds_read_b64_tr_b16 a[216:217], v30 offset:8192
buffer_load_dwordx4 a[44:47], v186, s[20:23], s43 offen offset:1024
ds_read_b64_tr_b16 a[218:219], v30 offset:9216
v_mfma_f32_32x32x16_bf16 v[96:111], a[200:203], a[0:3], 0
buffer_load_dwordx4 a[48:51], v186, s[20:23], s42 offen offset:2048
ds_read_b64_tr_b16 a[220:221], v31 offset:8192
v_mfma_f32_32x32x16_bf16 v[112:127], a[200:203], a[4:7], 0
ds_read_b64_tr_b16 a[222:223], v31 offset:9216
buffer_load_dwordx4 a[52:55], v186, s[20:23], s43 offen offset:2048
v_mfma_f32_32x32x16_bf16 v[128:143], a[204:207], a[0:3], 0
buffer_load_dwordx4 a[56:59], v186, s[20:23], s42 offen offset:3072
v_mfma_f32_32x32x16_bf16 v[144:159], a[204:207], a[4:7], 0
buffer_load_dwordx4 a[60:63], v186, s[20:23], s43 offen offset:3072
s_add_u32 s42, s42, 4096
s_add_u32 s43, s43, 4096
s_waitcnt vmcnt(16)
s_waitcnt lgkmcnt(0)
v_mfma_f32_32x32x16_bf16 v[32:47], a[208:211], a[8:11], v[32:47]
ds_read_b64_tr_b16 a[192:193], v28 offset:2048
s_add_u32 m0, s35, 32768
s_mov_b32 s38, 1048576
ds_read_b64_tr_b16 a[194:195], v28 offset:3072
v_mfma_f32_32x32x16_bf16 v[48:63], a[208:211], a[12:15], v[48:63]
buffer_load_dwordx4 v185, s[16:19], s38 offen lds
ds_read_b64_tr_b16 a[196:197], v29 offset:2048
v_mfma_f32_32x32x16_bf16 v[64:79], a[212:215], a[8:11], v[64:79]
ds_read_b64_tr_b16 a[198:199], v29 offset:3072
s_add_u32 m0, s35, 33792
s_mov_b32 s38, 1081344
v_mfma_f32_32x32x16_bf16 v[80:95], a[212:215], a[12:15], v[80:95]
ds_read_b64_tr_b16 a[200:201], v30 offset:2048
buffer_load_dwordx4 v185, s[16:19], s38 offen lds
ds_read_b64_tr_b16 a[202:203], v30 offset:3072
v_mfma_f32_32x32x16_bf16 v[96:111], a[216:219], a[8:11], v[96:111]
ds_read_b64_tr_b16 a[204:205], v31 offset:2048
s_add_u32 m0, s35, 34816
v_mfma_f32_32x32x16_bf16 v[112:127], a[216:219], a[12:15], v[112:127]
ds_read_b64_tr_b16 a[206:207], v31 offset:3072
s_mov_b32 s38, 1310720
buffer_load_dwordx4 v185, s[16:19], s38 offen lds
v_mfma_f32_32x32x16_bf16 v[128:143], a[220:223], a[8:11], v[128:143]
v_mfma_f32_32x32x16_bf16 v[144:159], a[220:223], a[12:15], v[144:159]
s_add_u32 m0, s35, 35840
s_mov_b32 s38, 1343488
s_waitcnt vmcnt(17)
s_waitcnt lgkmcnt(0)
v_mfma_f32_32x32x16_bf16 v[32:47], a[192:195], a[16:19], v[32:47]
ds_read_b64_tr_b16 a[208:209], v28 offset:10240
buffer_load_dwordx4 v185, s[16:19], s38 offen lds
ds_read_b64_tr_b16 a[210:211], v28 offset:11264
v_mfma_f32_32x32x16_bf16 v[48:63], a[192:195], a[20:23], v[48:63]
buffer_load_dwordx4 a[64:67], v186, s[20:23], s42 offen offset:0
ds_read_b64_tr_b16 a[212:213], v29 offset:10240
v_mfma_f32_32x32x16_bf16 v[64:79], a[196:199], a[16:19], v[64:79]
buffer_load_dwordx4 a[68:71], v186, s[20:23], s43 offen offset:0
ds_read_b64_tr_b16 a[214:215], v29 offset:11264
v_mfma_f32_32x32x16_bf16 v[80:95], a[196:199], a[20:23], v[80:95]
buffer_load_dwordx4 a[72:75], v186, s[20:23], s42 offen offset:1024
ds_read_b64_tr_b16 a[216:217], v30 offset:10240
ds_read_b64_tr_b16 a[218:219], v30 offset:11264
v_mfma_f32_32x32x16_bf16 v[96:111], a[200:203], a[16:19], v[96:111]
buffer_load_dwordx4 a[76:79], v186, s[20:23], s43 offen offset:1024
ds_read_b64_tr_b16 a[220:221], v31 offset:10240
v_mfma_f32_32x32x16_bf16 v[112:127], a[200:203], a[20:23], v[112:127]
ds_read_b64_tr_b16 a[222:223], v31 offset:11264
buffer_load_dwordx4 a[80:83], v186, s[20:23], s42 offen offset:2048
v_mfma_f32_32x32x16_bf16 v[128:143], a[204:207], a[16:19], v[128:143]
buffer_load_dwordx4 a[84:87], v186, s[20:23], s43 offen offset:2048
v_mfma_f32_32x32x16_bf16 v[144:159], a[204:207], a[20:23], v[144:159]
buffer_load_dwordx4 a[88:91], v186, s[20:23], s42 offen offset:3072
buffer_load_dwordx4 a[92:95], v186, s[20:23], s43 offen offset:3072
s_add_u32 s42, s42, 4096
s_add_u32 s43, s43, 4096
s_waitcnt vmcnt(24)
s_waitcnt lgkmcnt(0)
s_waitcnt vmcnt(20)
s_barrier
v_mfma_f32_32x32x16_bf16 v[32:47], a[208:211], a[24:27], v[32:47]
ds_read_b64_tr_b16 a[192:193], v28 offset:16384
ds_read_b64_tr_b16 a[194:195], v28 offset:17408
v_mfma_f32_32x32x16_bf16 v[48:63], a[208:211], a[28:31], v[48:63]
ds_read_b64_tr_b16 a[196:197], v29 offset:16384
v_mfma_f32_32x32x16_bf16 v[64:79], a[212:215], a[24:27], v[64:79]
ds_read_b64_tr_b16 a[198:199], v29 offset:17408
v_mfma_f32_32x32x16_bf16 v[80:95], a[212:215], a[28:31], v[80:95]
ds_read_b64_tr_b16 a[200:201], v30 offset:16384
ds_read_b64_tr_b16 a[202:203], v30 offset:17408
v_mfma_f32_32x32x16_bf16 v[96:111], a[216:219], a[24:27], v[96:111]
ds_read_b64_tr_b16 a[204:205], v31 offset:16384
v_mfma_f32_32x32x16_bf16 v[112:127], a[216:219], a[28:31], v[112:127]
ds_read_b64_tr_b16 a[206:207], v31 offset:17408
v_mfma_f32_32x32x16_bf16 v[128:143], a[220:223], a[24:27], v[128:143]
v_mfma_f32_32x32x16_bf16 v[144:159], a[220:223], a[28:31], v[144:159]
s_waitcnt vmcnt(18)
s_waitcnt lgkmcnt(0)
v_mfma_f32_32x32x16_bf16 v[32:47], a[192:195], a[32:35], v[32:47]
ds_read_b64_tr_b16 a[208:209], v28 offset:24576
s_add_u32 m0, s35, 49152
s_mov_b32 s38, 1572864
ds_read_b64_tr_b16 a[210:211], v28 offset:25600
v_mfma_f32_32x32x16_bf16 v[48:63], a[192:195], a[36:39], v[48:63]
buffer_load_dwordx4 v185, s[16:19], s38 offen lds
ds_read_b64_tr_b16 a[212:213], v29 offset:24576
v_mfma_f32_32x32x16_bf16 v[64:79], a[196:199], a[32:35], v[64:79]
ds_read_b64_tr_b16 a[214:215], v29 offset:25600
v_mfma_f32_32x32x16_bf16 v[80:95], a[196:199], a[36:39], v[80:95]
ds_read_b64_tr_b16 a[216:217], v30 offset:24576
ds_read_b64_tr_b16 a[218:219], v30 offset:25600
s_add_u32 m0, s35, 50176
v_mfma_f32_32x32x16_bf16 v[96:111], a[200:203], a[32:35], v[96:111]
s_mov_b32 s38, 1605632
ds_read_b64_tr_b16 a[220:221], v31 offset:24576
buffer_load_dwordx4 v185, s[16:19], s38 offen lds
v_mfma_f32_32x32x16_bf16 v[112:127], a[200:203], a[36:39], v[112:127]
ds_read_b64_tr_b16 a[222:223], v31 offset:25600
v_mfma_f32_32x32x16_bf16 v[128:143], a[204:207], a[32:35], v[128:143]
v_mfma_f32_32x32x16_bf16 v[144:159], a[204:207], a[36:39], v[144:159]
s_add_u32 m0, s35, 51200
s_waitcnt vmcnt(18)
s_waitcnt lgkmcnt(0)
v_mfma_f32_32x32x16_bf16 v[32:47], a[208:211], a[40:43], v[32:47]
ds_read_b64_tr_b16 a[192:193], v28 offset:18432
s_mov_b32 s38, 1835008
buffer_load_dwordx4 v185, s[16:19], s38 offen lds
v_mfma_f32_32x32x16_bf16 v[48:63], a[208:211], a[44:47], v[48:63]
ds_read_b64_tr_b16 a[194:195], v28 offset:19456
ds_read_b64_tr_b16 a[196:197], v29 offset:18432
v_mfma_f32_32x32x16_bf16 v[64:79], a[212:215], a[40:43], v[64:79]
ds_read_b64_tr_b16 a[198:199], v29 offset:19456
s_add_u32 m0, s35, 52224
s_mov_b32 s38, 1867776
v_mfma_f32_32x32x16_bf16 v[80:95], a[212:215], a[44:47], v[80:95]
ds_read_b64_tr_b16 a[200:201], v30 offset:18432
buffer_load_dwordx4 v185, s[16:19], s38 offen lds
ds_read_b64_tr_b16 a[202:203], v30 offset:19456
v_mfma_f32_32x32x16_bf16 v[96:111], a[216:219], a[40:43], v[96:111]
ds_read_b64_tr_b16 a[204:205], v31 offset:18432
buffer_load_dwordx4 a[96:99], v186, s[20:23], s42 offen offset:0
v_mfma_f32_32x32x16_bf16 v[112:127], a[216:219], a[44:47], v[112:127]
ds_read_b64_tr_b16 a[206:207], v31 offset:19456
v_mfma_f32_32x32x16_bf16 v[128:143], a[220:223], a[40:43], v[128:143]
buffer_load_dwordx4 a[100:103], v186, s[20:23], s43 offen offset:0
v_mfma_f32_32x32x16_bf16 v[144:159], a[220:223], a[44:47], v[144:159]
s_waitcnt vmcnt(20)
s_waitcnt lgkmcnt(0)
v_mfma_f32_32x32x16_bf16 v[32:47], a[192:195], a[48:51], v[32:47]
ds_read_b64_tr_b16 a[208:209], v28 offset:26624
buffer_load_dwordx4 a[104:107], v186, s[20:23], s42 offen offset:1024
ds_read_b64_tr_b16 a[210:211], v28 offset:27648
v_mfma_f32_32x32x16_bf16 v[48:63], a[192:195], a[52:55], v[48:63]
buffer_load_dwordx4 a[108:111], v186, s[20:23], s43 offen offset:1024
ds_read_b64_tr_b16 a[212:213], v29 offset:26624
v_mfma_f32_32x32x16_bf16 v[64:79], a[196:199], a[48:51], v[64:79]
ds_read_b64_tr_b16 a[214:215], v29 offset:27648
buffer_load_dwordx4 a[112:115], v186, s[20:23], s42 offen offset:2048
v_mfma_f32_32x32x16_bf16 v[80:95], a[196:199], a[52:55], v[80:95]
ds_read_b64_tr_b16 a[216:217], v30 offset:26624
ds_read_b64_tr_b16 a[218:219], v30 offset:27648
buffer_load_dwordx4 a[116:119], v186, s[20:23], s43 offen offset:2048
v_mfma_f32_32x32x16_bf16 v[96:111], a[200:203], a[48:51], v[96:111]
ds_read_b64_tr_b16 a[220:221], v31 offset:26624
buffer_load_dwordx4 a[120:123], v186, s[20:23], s42 offen offset:3072
v_mfma_f32_32x32x16_bf16 v[112:127], a[200:203], a[52:55], v[112:127]
ds_read_b64_tr_b16 a[222:223], v31 offset:27648
v_mfma_f32_32x32x16_bf16 v[128:143], a[204:207], a[48:51], v[128:143]
buffer_load_dwordx4 a[124:127], v186, s[20:23], s43 offen offset:3072
v_mfma_f32_32x32x16_bf16 v[144:159], a[204:207], a[52:55], v[144:159]
s_add_u32 s42, s42, 4096
s_add_u32 s43, s43, 4096
s_waitcnt vmcnt(24)
s_waitcnt lgkmcnt(0)
s_waitcnt vmcnt(20)
s_barrier
v_mfma_f32_32x32x16_bf16 v[32:47], a[208:211], a[56:59], v[32:47]
ds_read_b64_tr_b16 a[192:193], v28 offset:32768
ds_read_b64_tr_b16 a[194:195], v28 offset:33792
v_mfma_f32_32x32x16_bf16 v[48:63], a[208:211], a[60:63], v[48:63]
ds_read_b64_tr_b16 a[196:197], v29 offset:32768
v_mfma_f32_32x32x16_bf16 v[64:79], a[212:215], a[56:59], v[64:79]
ds_read_b64_tr_b16 a[198:199], v29 offset:33792
v_mfma_f32_32x32x16_bf16 v[80:95], a[212:215], a[60:63], v[80:95]
ds_read_b64_tr_b16 a[200:201], v30 offset:32768
ds_read_b64_tr_b16 a[202:203], v30 offset:33792
v_mfma_f32_32x32x16_bf16 v[96:111], a[216:219], a[56:59], v[96:111]
ds_read_b64_tr_b16 a[204:205], v31 offset:32768
v_mfma_f32_32x32x16_bf16 v[112:127], a[216:219], a[60:63], v[112:127]
ds_read_b64_tr_b16 a[206:207], v31 offset:33792
v_mfma_f32_32x32x16_bf16 v[128:143], a[220:223], a[56:59], v[128:143]
v_mfma_f32_32x32x16_bf16 v[144:159], a[220:223], a[60:63], v[144:159]
s_waitcnt vmcnt(18)
s_waitcnt lgkmcnt(0)
v_mfma_f32_32x32x16_bf16 v[32:47], a[192:195], a[64:67], v[32:47]
ds_read_b64_tr_b16 a[208:209], v28 offset:40960
s_add_u32 m0, s35, 65536
s_mov_b32 s38, 2097152
ds_read_b64_tr_b16 a[210:211], v28 offset:41984
v_mfma_f32_32x32x16_bf16 v[48:63], a[192:195], a[68:71], v[48:63]
buffer_load_dwordx4 v185, s[16:19], s38 offen lds
ds_read_b64_tr_b16 a[212:213], v29 offset:40960
v_mfma_f32_32x32x16_bf16 v[64:79], a[196:199], a[64:67], v[64:79]
ds_read_b64_tr_b16 a[214:215], v29 offset:41984
v_mfma_f32_32x32x16_bf16 v[80:95], a[196:199], a[68:71], v[80:95]
ds_read_b64_tr_b16 a[216:217], v30 offset:40960
ds_read_b64_tr_b16 a[218:219], v30 offset:41984
s_add_u32 m0, s35, 66560
v_mfma_f32_32x32x16_bf16 v[96:111], a[200:203], a[64:67], v[96:111]
s_mov_b32 s38, 2129920
ds_read_b64_tr_b16 a[220:221], v31 offset:40960
buffer_load_dwordx4 v185, s[16:19], s38 offen lds
v_mfma_f32_32x32x16_bf16 v[112:127], a[200:203], a[68:71], v[112:127]
ds_read_b64_tr_b16 a[222:223], v31 offset:41984
v_mfma_f32_32x32x16_bf16 v[128:143], a[204:207], a[64:67], v[128:143]
v_mfma_f32_32x32x16_bf16 v[144:159], a[204:207], a[68:71], v[144:159]
s_add_u32 m0, s35, 67584
s_waitcnt vmcnt(18)
s_waitcnt lgkmcnt(0)
v_mfma_f32_32x32x16_bf16 v[32:47], a[208:211], a[72:75], v[32:47]
ds_read_b64_tr_b16 a[192:193], v28 offset:34816
s_mov_b32 s38, 2359296
buffer_load_dwordx4 v185, s[16:19], s38 offen lds
v_mfma_f32_32x32x16_bf16 v[48:63], a[208:211], a[76:79], v[48:63]
ds_read_b64_tr_b16 a[194:195], v28 offset:35840
ds_read_b64_tr_b16 a[196:197], v29 offset:34816
v_mfma_f32_32x32x16_bf16 v[64:79], a[212:215], a[72:75], v[64:79]
ds_read_b64_tr_b16 a[198:199], v29 offset:35840
s_add_u32 m0, s35, 68608
s_mov_b32 s38, 2392064
v_mfma_f32_32x32x16_bf16 v[80:95], a[212:215], a[76:79], v[80:95]
ds_read_b64_tr_b16 a[200:201], v30 offset:34816
buffer_load_dwordx4 v185, s[16:19], s38 offen lds
ds_read_b64_tr_b16 a[202:203], v30 offset:35840
v_mfma_f32_32x32x16_bf16 v[96:111], a[216:219], a[72:75], v[96:111]
ds_read_b64_tr_b16 a[204:205], v31 offset:34816
buffer_load_dwordx4 a[0:3], v186, s[20:23], s42 offen offset:0
v_mfma_f32_32x32x16_bf16 v[112:127], a[216:219], a[76:79], v[112:127]
ds_read_b64_tr_b16 a[206:207], v31 offset:35840
v_mfma_f32_32x32x16_bf16 v[128:143], a[220:223], a[72:75], v[128:143]
buffer_load_dwordx4 a[4:7], v186, s[20:23], s43 offen offset:0
v_mfma_f32_32x32x16_bf16 v[144:159], a[220:223], a[76:79], v[144:159]
s_waitcnt vmcnt(20)
s_waitcnt lgkmcnt(0)
v_mfma_f32_32x32x16_bf16 v[32:47], a[192:195], a[80:83], v[32:47]
ds_read_b64_tr_b16 a[208:209], v28 offset:43008
buffer_load_dwordx4 a[8:11], v186, s[20:23], s42 offen offset:1024
ds_read_b64_tr_b16 a[210:211], v28 offset:44032
v_mfma_f32_32x32x16_bf16 v[48:63], a[192:195], a[84:87], v[48:63]
buffer_load_dwordx4 a[12:15], v186, s[20:23], s43 offen offset:1024
ds_read_b64_tr_b16 a[212:213], v29 offset:43008
v_mfma_f32_32x32x16_bf16 v[64:79], a[196:199], a[80:83], v[64:79]
ds_read_b64_tr_b16 a[214:215], v29 offset:44032
buffer_load_dwordx4 a[16:19], v186, s[20:23], s42 offen offset:2048
v_mfma_f32_32x32x16_bf16 v[80:95], a[196:199], a[84:87], v[80:95]
ds_read_b64_tr_b16 a[216:217], v30 offset:43008
ds_read_b64_tr_b16 a[218:219], v30 offset:44032
buffer_load_dwordx4 a[20:23], v186, s[20:23], s43 offen offset:2048
v_mfma_f32_32x32x16_bf16 v[96:111], a[200:203], a[80:83], v[96:111]
ds_read_b64_tr_b16 a[220:221], v31 offset:43008
buffer_load_dwordx4 a[24:27], v186, s[20:23], s42 offen offset:3072
v_mfma_f32_32x32x16_bf16 v[112:127], a[200:203], a[84:87], v[112:127]
ds_read_b64_tr_b16 a[222:223], v31 offset:44032
v_mfma_f32_32x32x16_bf16 v[128:143], a[204:207], a[80:83], v[128:143]
buffer_load_dwordx4 a[28:31], v186, s[20:23], s43 offen offset:3072
v_mfma_f32_32x32x16_bf16 v[144:159], a[204:207], a[84:87], v[144:159]
s_add_u32 s42, s42, 4096
s_add_u32 s43, s43, 4096
s_waitcnt vmcnt(24)
s_waitcnt lgkmcnt(0)
s_waitcnt vmcnt(20)
s_barrier
v_mfma_f32_32x32x16_bf16 v[32:47], a[208:211], a[88:91], v[32:47]
ds_read_b64_tr_b16 a[192:193], v28 offset:49152
ds_read_b64_tr_b16 a[194:195], v28 offset:50176
v_mfma_f32_32x32x16_bf16 v[48:63], a[208:211], a[92:95], v[48:63]
ds_read_b64_tr_b16 a[196:197], v29 offset:49152
v_mfma_f32_32x32x16_bf16 v[64:79], a[212:215], a[88:91], v[64:79]
ds_read_b64_tr_b16 a[198:199], v29 offset:50176
v_mfma_f32_32x32x16_bf16 v[80:95], a[212:215], a[92:95], v[80:95]
ds_read_b64_tr_b16 a[200:201], v30 offset:49152
ds_read_b64_tr_b16 a[202:203], v30 offset:50176
v_mfma_f32_32x32x16_bf16 v[96:111], a[216:219], a[88:91], v[96:111]
ds_read_b64_tr_b16 a[204:205], v31 offset:49152
v_mfma_f32_32x32x16_bf16 v[112:127], a[216:219], a[92:95], v[112:127]
ds_read_b64_tr_b16 a[206:207], v31 offset:50176
v_mfma_f32_32x32x16_bf16 v[128:143], a[220:223], a[88:91], v[128:143]
v_mfma_f32_32x32x16_bf16 v[144:159], a[220:223], a[92:95], v[144:159]
s_waitcnt vmcnt(18)
s_waitcnt lgkmcnt(0)
v_mfma_f32_32x32x16_bf16 v[32:47], a[192:195], a[96:99], v[32:47]
ds_read_b64_tr_b16 a[208:209], v28 offset:57344
s_add_u32 m0, s35, 81920
s_mov_b32 s38, 2621440
ds_read_b64_tr_b16 a[210:211], v28 offset:58368
v_mfma_f32_32x32x16_bf16 v[48:63], a[192:195], a[100:103], v[48:63]
buffer_load_dwordx4 v185, s[16:19], s38 offen lds
ds_read_b64_tr_b16 a[212:213], v29 offset:57344
v_mfma_f32_32x32x16_bf16 v[64:79], a[196:199], a[96:99], v[64:79]
ds_read_b64_tr_b16 a[214:215], v29 offset:58368
v_mfma_f32_32x32x16_bf16 v[80:95], a[196:199], a[100:103], v[80:95]
ds_read_b64_tr_b16 a[216:217], v30 offset:57344
ds_read_b64_tr_b16 a[218:219], v30 offset:58368
s_add_u32 m0, s35, 82944
v_mfma_f32_32x32x16_bf16 v[96:111], a[200:203], a[96:99], v[96:111]
s_mov_b32 s38, 2654208
ds_read_b64_tr_b16 a[220:221], v31 offset:57344
buffer_load_dwordx4 v185, s[16:19], s38 offen lds
v_mfma_f32_32x32x16_bf16 v[112:127], a[200:203], a[100:103], v[112:127]
ds_read_b64_tr_b16 a[222:223], v31 offset:58368
v_mfma_f32_32x32x16_bf16 v[128:143], a[204:207], a[96:99], v[128:143]
v_mfma_f32_32x32x16_bf16 v[144:159], a[204:207], a[100:103], v[144:159]
s_add_u32 m0, s35, 83968
s_waitcnt vmcnt(18)
s_waitcnt lgkmcnt(0)
v_mfma_f32_32x32x16_bf16 v[32:47], a[208:211], a[104:107], v[32:47]
ds_read_b64_tr_b16 a[192:193], v28 offset:51200
s_mov_b32 s38, 2883584
buffer_load_dwordx4 v185, s[16:19], s38 offen lds
v_mfma_f32_32x32x16_bf16 v[48:63], a[208:211], a[108:111], v[48:63]
ds_read_b64_tr_b16 a[194:195], v28 offset:52224
ds_read_b64_tr_b16 a[196:197], v29 offset:51200
v_mfma_f32_32x32x16_bf16 v[64:79], a[212:215], a[104:107], v[64:79]
ds_read_b64_tr_b16 a[198:199], v29 offset:52224
s_add_u32 m0, s35, 84992
s_mov_b32 s38, 2916352
v_mfma_f32_32x32x16_bf16 v[80:95], a[212:215], a[108:111], v[80:95]
ds_read_b64_tr_b16 a[200:201], v30 offset:51200
buffer_load_dwordx4 v185, s[16:19], s38 offen lds
ds_read_b64_tr_b16 a[202:203], v30 offset:52224
v_mfma_f32_32x32x16_bf16 v[96:111], a[216:219], a[104:107], v[96:111]
ds_read_b64_tr_b16 a[204:205], v31 offset:51200
buffer_load_dwordx4 a[32:35], v186, s[20:23], s42 offen offset:0
v_mfma_f32_32x32x16_bf16 v[112:127], a[216:219], a[108:111], v[112:127]
ds_read_b64_tr_b16 a[206:207], v31 offset:52224
v_mfma_f32_32x32x16_bf16 v[128:143], a[220:223], a[104:107], v[128:143]
buffer_load_dwordx4 a[36:39], v186, s[20:23], s43 offen offset:0
v_mfma_f32_32x32x16_bf16 v[144:159], a[220:223], a[108:111], v[144:159]
s_waitcnt vmcnt(20)
s_waitcnt lgkmcnt(0)
v_mfma_f32_32x32x16_bf16 v[32:47], a[192:195], a[112:115], v[32:47]
ds_read_b64_tr_b16 a[208:209], v28 offset:59392
buffer_load_dwordx4 a[40:43], v186, s[20:23], s42 offen offset:1024
ds_read_b64_tr_b16 a[210:211], v28 offset:60416
v_mfma_f32_32x32x16_bf16 v[48:63], a[192:195], a[116:119], v[48:63]
buffer_load_dwordx4 a[44:47], v186, s[20:23], s43 offen offset:1024
ds_read_b64_tr_b16 a[212:213], v29 offset:59392
v_mfma_f32_32x32x16_bf16 v[64:79], a[196:199], a[112:115], v[64:79]
ds_read_b64_tr_b16 a[214:215], v29 offset:60416
buffer_load_dwordx4 a[48:51], v186, s[20:23], s42 offen offset:2048
v_mfma_f32_32x32x16_bf16 v[80:95], a[196:199], a[116:119], v[80:95]
ds_read_b64_tr_b16 a[216:217], v30 offset:59392
ds_read_b64_tr_b16 a[218:219], v30 offset:60416
buffer_load_dwordx4 a[52:55], v186, s[20:23], s43 offen offset:2048
v_mfma_f32_32x32x16_bf16 v[96:111], a[200:203], a[112:115], v[96:111]
ds_read_b64_tr_b16 a[220:221], v31 offset:59392
buffer_load_dwordx4 a[56:59], v186, s[20:23], s42 offen offset:3072
v_mfma_f32_32x32x16_bf16 v[112:127], a[200:203], a[116:119], v[112:127]
ds_read_b64_tr_b16 a[222:223], v31 offset:60416
v_mfma_f32_32x32x16_bf16 v[128:143], a[204:207], a[112:115], v[128:143]
buffer_load_dwordx4 a[60:63], v186, s[20:23], s43 offen offset:3072
v_mfma_f32_32x32x16_bf16 v[144:159], a[204:207], a[116:119], v[144:159]
s_add_u32 s42, s42, 4096
s_add_u32 s43, s43, 4096
s_waitcnt vmcnt(24)
s_waitcnt lgkmcnt(0)
s_waitcnt vmcnt(20)
s_barrier
v_mfma_f32_32x32x16_bf16 v[32:47], a[208:211], a[120:123], v[32:47]
ds_read_b64_tr_b16 a[192:193], v200 offset:0
ds_read_b64_tr_b16 a[194:195], v200 offset:1024
v_mfma_f32_32x32x16_bf16 v[48:63], a[208:211], a[124:127], v[48:63]
ds_read_b64_tr_b16 a[196:197], v201 offset:0
v_mfma_f32_32x32x16_bf16 v[64:79], a[212:215], a[120:123], v[64:79]
ds_read_b64_tr_b16 a[198:199], v201 offset:1024
v_mfma_f32_32x32x16_bf16 v[80:95], a[212:215], a[124:127], v[80:95]
ds_read_b64_tr_b16 a[200:201], v202 offset:0
ds_read_b64_tr_b16 a[202:203], v202 offset:1024
v_mfma_f32_32x32x16_bf16 v[96:111], a[216:219], a[120:123], v[96:111]
ds_read_b64_tr_b16 a[204:205], v203 offset:0
v_mfma_f32_32x32x16_bf16 v[112:127], a[216:219], a[124:127], v[112:127]
ds_read_b64_tr_b16 a[206:207], v203 offset:1024
v_mfma_f32_32x32x16_bf16 v[128:143], a[220:223], a[120:123], v[128:143]
v_mfma_f32_32x32x16_bf16 v[144:159], a[220:223], a[124:127], v[144:159]
s_waitcnt vmcnt(18)
s_waitcnt lgkmcnt(0)
v_mfma_f32_32x32x16_bf16 v[32:47], a[192:195], a[0:3], v[32:47]
ds_read_b64_tr_b16 a[208:209], v200 offset:8192
s_add_u32 m0, s35, 98304
s_mov_b32 s38, 3145728
ds_read_b64_tr_b16 a[210:211], v200 offset:9216
v_mfma_f32_32x32x16_bf16 v[48:63], a[192:195], a[4:7], v[48:63]
buffer_load_dwordx4 v185, s[16:19], s38 offen lds
ds_read_b64_tr_b16 a[212:213], v201 offset:8192
v_mfma_f32_32x32x16_bf16 v[64:79], a[196:199], a[0:3], v[64:79]
ds_read_b64_tr_b16 a[214:215], v201 offset:9216
v_mfma_f32_32x32x16_bf16 v[80:95], a[196:199], a[4:7], v[80:95]
ds_read_b64_tr_b16 a[216:217], v202 offset:8192
ds_read_b64_tr_b16 a[218:219], v202 offset:9216
s_add_u32 m0, s35, 99328
v_mfma_f32_32x32x16_bf16 v[96:111], a[200:203], a[0:3], v[96:111]
s_mov_b32 s38, 3178496
ds_read_b64_tr_b16 a[220:221], v203 offset:8192
buffer_load_dwordx4 v185, s[16:19], s38 offen lds
v_mfma_f32_32x32x16_bf16 v[112:127], a[200:203], a[4:7], v[112:127]
ds_read_b64_tr_b16 a[222:223], v203 offset:9216
v_mfma_f32_32x32x16_bf16 v[128:143], a[204:207], a[0:3], v[128:143]
v_mfma_f32_32x32x16_bf16 v[144:159], a[204:207], a[4:7], v[144:159]
s_add_u32 m0, s35, 100352
s_waitcnt vmcnt(18)
s_waitcnt lgkmcnt(0)
v_mfma_f32_32x32x16_bf16 v[32:47], a[208:211], a[8:11], v[32:47]
ds_read_b64_tr_b16 a[192:193], v200 offset:2048
s_mov_b32 s38, 3407872
buffer_load_dwordx4 v185, s[16:19], s38 offen lds
v_mfma_f32_32x32x16_bf16 v[48:63], a[208:211], a[12:15], v[48:63]
ds_read_b64_tr_b16 a[194:195], v200 offset:3072
ds_read_b64_tr_b16 a[196:197], v201 offset:2048
v_mfma_f32_32x32x16_bf16 v[64:79], a[212:215], a[8:11], v[64:79]
ds_read_b64_tr_b16 a[198:199], v201 offset:3072
s_add_u32 m0, s35, 101376
s_mov_b32 s38, 3440640
v_mfma_f32_32x32x16_bf16 v[80:95], a[212:215], a[12:15], v[80:95]
ds_read_b64_tr_b16 a[200:201], v202 offset:2048
buffer_load_dwordx4 v185, s[16:19], s38 offen lds
ds_read_b64_tr_b16 a[202:203], v202 offset:3072
v_mfma_f32_32x32x16_bf16 v[96:111], a[216:219], a[8:11], v[96:111]
ds_read_b64_tr_b16 a[204:205], v203 offset:2048
buffer_load_dwordx4 a[64:67], v186, s[20:23], s42 offen offset:0
v_mfma_f32_32x32x16_bf16 v[112:127], a[216:219], a[12:15], v[112:127]
ds_read_b64_tr_b16 a[206:207], v203 offset:3072
v_mfma_f32_32x32x16_bf16 v[128:143], a[220:223], a[8:11], v[128:143]
buffer_load_dwordx4 a[68:71], v186, s[20:23], s43 offen offset:0
v_mfma_f32_32x32x16_bf16 v[144:159], a[220:223], a[12:15], v[144:159]
s_waitcnt vmcnt(20)
s_waitcnt lgkmcnt(0)
v_mfma_f32_32x32x16_bf16 v[32:47], a[192:195], a[16:19], v[32:47]
ds_read_b64_tr_b16 a[208:209], v200 offset:10240
buffer_load_dwordx4 a[72:75], v186, s[20:23], s42 offen offset:1024
ds_read_b64_tr_b16 a[210:211], v200 offset:11264
v_mfma_f32_32x32x16_bf16 v[48:63], a[192:195], a[20:23], v[48:63]
buffer_load_dwordx4 a[76:79], v186, s[20:23], s43 offen offset:1024
ds_read_b64_tr_b16 a[212:213], v201 offset:10240
v_mfma_f32_32x32x16_bf16 v[64:79], a[196:199], a[16:19], v[64:79]
ds_read_b64_tr_b16 a[214:215], v201 offset:11264
buffer_load_dwordx4 a[80:83], v186, s[20:23], s42 offen offset:2048
v_mfma_f32_32x32x16_bf16 v[80:95], a[196:199], a[20:23], v[80:95]
ds_read_b64_tr_b16 a[216:217], v202 offset:10240
ds_read_b64_tr_b16 a[218:219], v202 offset:11264
buffer_load_dwordx4 a[84:87], v186, s[20:23], s43 offen offset:2048
v_mfma_f32_32x32x16_bf16 v[96:111], a[200:203], a[16:19], v[96:111]
ds_read_b64_tr_b16 a[220:221], v203 offset:10240
buffer_load_dwordx4 a[88:91], v186, s[20:23], s42 offen offset:3072
v_mfma_f32_32x32x16_bf16 v[112:127], a[200:203], a[20:23], v[112:127]
ds_read_b64_tr_b16 a[222:223], v203 offset:11264
v_mfma_f32_32x32x16_bf16 v[128:143], a[204:207], a[16:19], v[128:143]
buffer_load_dwordx4 a[92:95], v186, s[20:23], s43 offen offset:3072
v_mfma_f32_32x32x16_bf16 v[144:159], a[204:207], a[20:23], v[144:159]
s_add_u32 s42, s42, 4096
s_add_u32 s43, s43, 4096
s_waitcnt vmcnt(24)
s_waitcnt lgkmcnt(0)
s_waitcnt vmcnt(20)
s_barrier
v_mfma_f32_32x32x16_bf16 v[32:47], a[208:211], a[24:27], v[32:47]
ds_read_b64_tr_b16 a[192:193], v200 offset:16384
s_add_u32 m0, s35, 0
s_mov_b32 s38, 0
ds_read_b64_tr_b16 a[194:195], v200 offset:17408
v_mfma_f32_32x32x16_bf16 v[48:63], a[208:211], a[28:31], v[48:63]
buffer_load_dwordx4 v182, s[8:11], s38 offen lds
ds_read_b64_tr_b16 a[196:197], v201 offset:16384
v_mfma_f32_32x32x16_bf16 v[64:79], a[212:215], a[24:27], v[64:79]
buffer_load_dwordx4 v183, s[8:11], s38 offen offset:1024 lds
ds_read_b64_tr_b16 a[198:199], v201 offset:17408
s_add_u32 m0, s35, 16384
v_mfma_f32_32x32x16_bf16 v[80:95], a[212:215], a[28:31], v[80:95]
ds_read_b64_tr_b16 a[200:201], v202 offset:16384
s_mov_b32 s38, 8192
buffer_load_dwordx4 v182, s[8:11], s38 offen lds
v_mfma_f32_32x32x16_bf16 v[96:111], a[216:219], a[24:27], v[96:111]
ds_read_b64_tr_b16 a[202:203], v202 offset:17408
ds_read_b64_tr_b16 a[204:205], v203 offset:16384
buffer_load_dwordx4 v183, s[8:11], s38 offen offset:1024 lds
v_mfma_f32_32x32x16_bf16 v[112:127], a[216:219], a[28:31], v[112:127]
ds_read_b64_tr_b16 a[206:207], v203 offset:17408
buffer_load_dwordx4 v184, s[12:15], s38 offen offset:2048 lds
v_mfma_f32_32x32x16_bf16 v[128:143], a[220:223], a[24:27], v[128:143]
buffer_load_dwordx4 v184, s[12:15], s38 offen offset:3072 lds
v_mfma_f32_32x32x16_bf16 v[144:159], a[220:223], a[28:31], v[144:159]
s_waitcnt vmcnt(24)
s_waitcnt lgkmcnt(0)
v_mfma_f32_32x32x16_bf16 v[32:47], a[192:195], a[32:35], v[32:47]
ds_read_b64_tr_b16 a[208:209], v200 offset:24576
s_add_u32 m0, s35, 114688
s_mov_b32 s38, 3670016
ds_read_b64_tr_b16 a[210:211], v200 offset:25600
v_mfma_f32_32x32x16_bf16 v[48:63], a[192:195], a[36:39], v[48:63]
buffer_load_dwordx4 v185, s[16:19], s38 offen lds
ds_read_b64_tr_b16 a[212:213], v201 offset:24576
v_mfma_f32_32x32x16_bf16 v[64:79], a[196:199], a[32:35], v[64:79]
ds_read_b64_tr_b16 a[214:215], v201 offset:25600
v_mfma_f32_32x32x16_bf16 v[80:95], a[196:199], a[36:39], v[80:95]
ds_read_b64_tr_b16 a[216:217], v202 offset:24576
ds_read_b64_tr_b16 a[218:219], v202 offset:25600
s_add_u32 m0, s35, 115712
v_mfma_f32_32x32x16_bf16 v[96:111], a[200:203], a[32:35], v[96:111]
s_mov_b32 s38, 3702784
ds_read_b64_tr_b16 a[220:221], v203 offset:24576
buffer_load_dwordx4 v185, s[16:19], s38 offen lds
v_mfma_f32_32x32x16_bf16 v[112:127], a[200:203], a[36:39], v[112:127]
ds_read_b64_tr_b16 a[222:223], v203 offset:25600
v_mfma_f32_32x32x16_bf16 v[128:143], a[204:207], a[32:35], v[128:143]
v_mfma_f32_32x32x16_bf16 v[144:159], a[204:207], a[36:39], v[144:159]
s_add_u32 m0, s35, 116736
s_waitcnt vmcnt(24)
s_waitcnt lgkmcnt(0)
v_mfma_f32_32x32x16_bf16 v[32:47], a[208:211], a[40:43], v[32:47]
ds_read_b64_tr_b16 a[192:193], v200 offset:18432
s_mov_b32 s38, 3932160
buffer_load_dwordx4 v185, s[16:19], s38 offen lds
v_mfma_f32_32x32x16_bf16 v[48:63], a[208:211], a[44:47], v[48:63]
ds_read_b64_tr_b16 a[194:195], v200 offset:19456
ds_read_b64_tr_b16 a[196:197], v201 offset:18432
v_mfma_f32_32x32x16_bf16 v[64:79], a[212:215], a[40:43], v[64:79]
ds_read_b64_tr_b16 a[198:199], v201 offset:19456
s_add_u32 m0, s35, 117760
s_mov_b32 s38, 3964928
v_mfma_f32_32x32x16_bf16 v[80:95], a[212:215], a[44:47], v[80:95]
ds_read_b64_tr_b16 a[200:201], v202 offset:18432
buffer_load_dwordx4 v185, s[16:19], s38 offen lds
ds_read_b64_tr_b16 a[202:203], v202 offset:19456
v_mfma_f32_32x32x16_bf16 v[96:111], a[216:219], a[40:43], v[96:111]
ds_read_b64_tr_b16 a[204:205], v203 offset:18432
buffer_load_dwordx4 a[96:99], v186, s[20:23], s42 offen offset:0
v_mfma_f32_32x32x16_bf16 v[112:127], a[216:219], a[44:47], v[112:127]
ds_read_b64_tr_b16 a[206:207], v203 offset:19456
v_mfma_f32_32x32x16_bf16 v[128:143], a[220:223], a[40:43], v[128:143]
buffer_load_dwordx4 a[100:103], v186, s[20:23], s43 offen offset:0
v_mfma_f32_32x32x16_bf16 v[144:159], a[220:223], a[44:47], v[144:159]
s_waitcnt vmcnt(26)
s_waitcnt lgkmcnt(0)
v_mfma_f32_32x32x16_bf16 v[32:47], a[192:195], a[48:51], v[32:47]
ds_read_b64_tr_b16 a[208:209], v200 offset:26624
buffer_load_dwordx4 a[104:107], v186, s[20:23], s42 offen offset:1024
ds_read_b64_tr_b16 a[210:211], v200 offset:27648
v_mfma_f32_32x32x16_bf16 v[48:63], a[192:195], a[52:55], v[48:63]
buffer_load_dwordx4 a[108:111], v186, s[20:23], s43 offen offset:1024
ds_read_b64_tr_b16 a[212:213], v201 offset:26624
v_mfma_f32_32x32x16_bf16 v[64:79], a[196:199], a[48:51], v[64:79]
ds_read_b64_tr_b16 a[214:215], v201 offset:27648
buffer_load_dwordx4 a[112:115], v186, s[20:23], s42 offen offset:2048
v_mfma_f32_32x32x16_bf16 v[80:95], a[196:199], a[52:55], v[80:95]
ds_read_b64_tr_b16 a[216:217], v202 offset:26624
ds_read_b64_tr_b16 a[218:219], v202 offset:27648
buffer_load_dwordx4 a[116:119], v186, s[20:23], s43 offen offset:2048
v_mfma_f32_32x32x16_bf16 v[96:111], a[200:203], a[48:51], v[96:111]
ds_read_b64_tr_b16 a[220:221], v203 offset:26624
buffer_load_dwordx4 a[120:123], v186, s[20:23], s42 offen offset:3072
v_mfma_f32_32x32x16_bf16 v[112:127], a[200:203], a[52:55], v[112:127]
ds_read_b64_tr_b16 a[222:223], v203 offset:27648
v_mfma_f32_32x32x16_bf16 v[128:143], a[204:207], a[48:51], v[128:143]
buffer_load_dwordx4 a[124:127], v186, s[20:23], s43 offen offset:3072
v_mfma_f32_32x32x16_bf16 v[144:159], a[204:207], a[52:55], v[144:159]
s_add_u32 s42, s42, 4096
s_add_u32 s43, s43, 4096
s_waitcnt vmcnt(30)
s_waitcnt lgkmcnt(0)
s_waitcnt vmcnt(26)
s_barrier
v_mfma_f32_32x32x16_bf16 v[32:47], a[208:211], a[56:59], v[32:47]
ds_read_b64_tr_b16 a[192:193], v200 offset:32768
s_add_u32 m0, s35, 32768
s_mov_b32 s38, 16384
ds_read_b64_tr_b16 a[194:195], v200 offset:33792
v_mfma_f32_32x32x16_bf16 v[48:63], a[208:211], a[60:63], v[48:63]
buffer_load_dwordx4 v182, s[8:11], s38 offen lds
ds_read_b64_tr_b16 a[196:197], v201 offset:32768
v_mfma_f32_32x32x16_bf16 v[64:79], a[212:215], a[56:59], v[64:79]
ds_read_b64_tr_b16 a[198:199], v201 offset:33792
buffer_load_dwordx4 v183, s[8:11], s38 offen offset:1024 lds
v_mfma_f32_32x32x16_bf16 v[80:95], a[212:215], a[60:63], v[80:95]
ds_read_b64_tr_b16 a[200:201], v202 offset:32768
ds_read_b64_tr_b16 a[202:203], v202 offset:33792
v_mfma_f32_32x32x16_bf16 v[96:111], a[216:219], a[56:59], v[96:111]
ds_read_b64_tr_b16 a[204:205], v203 offset:32768
buffer_load_dwordx4 v184, s[12:15], s38 offen offset:2048 lds
v_mfma_f32_32x32x16_bf16 v[112:127], a[216:219], a[60:63], v[112:127]
ds_read_b64_tr_b16 a[206:207], v203 offset:33792
v_mfma_f32_32x32x16_bf16 v[128:143], a[220:223], a[56:59], v[128:143]
buffer_load_dwordx4 v184, s[12:15], s38 offen offset:3072 lds
v_mfma_f32_32x32x16_bf16 v[144:159], a[220:223], a[60:63], v[144:159]
s_waitcnt vmcnt(28)
s_waitcnt lgkmcnt(0)
v_mfma_f32_32x32x16_bf16 v[32:47], a[192:195], a[64:67], v[32:47]
ds_read_b64_tr_b16 a[208:209], v200 offset:40960
ds_read_b64_tr_b16 a[210:211], v200 offset:41984
v_mfma_f32_32x32x16_bf16 v[48:63], a[192:195], a[68:71], v[48:63]
ds_read_b64_tr_b16 a[212:213], v201 offset:40960
v_mfma_f32_32x32x16_bf16 v[64:79], a[196:199], a[64:67], v[64:79]
ds_read_b64_tr_b16 a[214:215], v201 offset:41984
v_mfma_f32_32x32x16_bf16 v[80:95], a[196:199], a[68:71], v[80:95]
ds_read_b64_tr_b16 a[216:217], v202 offset:40960
ds_read_b64_tr_b16 a[218:219], v202 offset:41984
v_mfma_f32_32x32x16_bf16 v[96:111], a[200:203], a[64:67], v[96:111]
ds_read_b64_tr_b16 a[220:221], v203 offset:40960
v_mfma_f32_32x32x16_bf16 v[112:127], a[200:203], a[68:71], v[112:127]
ds_read_b64_tr_b16 a[222:223], v203 offset:41984
v_mfma_f32_32x32x16_bf16 v[128:143], a[204:207], a[64:67], v[128:143]
v_mfma_f32_32x32x16_bf16 v[144:159], a[204:207], a[68:71], v[144:159]
s_waitcnt vmcnt(26)
s_waitcnt lgkmcnt(0)
v_mfma_f32_32x32x16_bf16 v[32:47], a[208:211], a[72:75], v[32:47]
ds_read_b64_tr_b16 a[192:193], v200 offset:34816
ds_read_b64_tr_b16 a[194:195], v200 offset:35840
v_mfma_f32_32x32x16_bf16 v[48:63], a[208:211], a[76:79], v[48:63]
ds_read_b64_tr_b16 a[196:197], v201 offset:34816
v_mfma_f32_32x32x16_bf16 v[64:79], a[212:215], a[72:75], v[64:79]
ds_read_b64_tr_b16 a[198:199], v201 offset:35840
v_mfma_f32_32x32x16_bf16 v[80:95], a[212:215], a[76:79], v[80:95]
ds_read_b64_tr_b16 a[200:201], v202 offset:34816
ds_read_b64_tr_b16 a[202:203], v202 offset:35840
v_mfma_f32_32x32x16_bf16 v[96:111], a[216:219], a[72:75], v[96:111]
ds_read_b64_tr_b16 a[204:205], v203 offset:34816
v_mfma_f32_32x32x16_bf16 v[112:127], a[216:219], a[76:79], v[112:127]
ds_read_b64_tr_b16 a[206:207], v203 offset:35840
v_mfma_f32_32x32x16_bf16 v[128:143], a[220:223], a[72:75], v[128:143]
v_mfma_f32_32x32x16_bf16 v[144:159], a[220:223], a[76:79], v[144:159]
s_waitcnt vmcnt(24)
s_waitcnt lgkmcnt(0)
v_mfma_f32_32x32x16_bf16 v[32:47], a[192:195], a[80:83], v[32:47]
ds_read_b64_tr_b16 a[208:209], v200 offset:43008
ds_read_b64_tr_b16 a[210:211], v200 offset:44032
v_mfma_f32_32x32x16_bf16 v[48:63], a[192:195], a[84:87], v[48:63]
ds_read_b64_tr_b16 a[212:213], v201 offset:43008
v_mfma_f32_32x32x16_bf16 v[64:79], a[196:199], a[80:83], v[64:79]
ds_read_b64_tr_b16 a[214:215], v201 offset:44032
v_mfma_f32_32x32x16_bf16 v[80:95], a[196:199], a[84:87], v[80:95]
ds_read_b64_tr_b16 a[216:217], v202 offset:43008
ds_read_b64_tr_b16 a[218:219], v202 offset:44032
v_mfma_f32_32x32x16_bf16 v[96:111], a[200:203], a[80:83], v[96:111]
ds_read_b64_tr_b16 a[220:221], v203 offset:43008
v_mfma_f32_32x32x16_bf16 v[112:127], a[200:203], a[84:87], v[112:127]
ds_read_b64_tr_b16 a[222:223], v203 offset:44032
v_mfma_f32_32x32x16_bf16 v[128:143], a[204:207], a[80:83], v[128:143]
v_mfma_f32_32x32x16_bf16 v[144:159], a[204:207], a[84:87], v[144:159]
s_waitcnt vmcnt(22)
s_waitcnt lgkmcnt(0)
s_waitcnt vmcnt(12)
s_barrier
v_mfma_f32_32x32x16_bf16 v[32:47], a[208:211], a[88:91], v[32:47]
ds_read_b64_tr_b16 a[192:193], v200 offset:49152
s_add_u32 m0, s35, 49152
s_mov_b32 s38, 24576
ds_read_b64_tr_b16 a[194:195], v200 offset:50176
v_mfma_f32_32x32x16_bf16 v[48:63], a[208:211], a[92:95], v[48:63]
buffer_load_dwordx4 v182, s[8:11], s38 offen lds
ds_read_b64_tr_b16 a[196:197], v201 offset:49152
v_mfma_f32_32x32x16_bf16 v[64:79], a[212:215], a[88:91], v[64:79]
ds_read_b64_tr_b16 a[198:199], v201 offset:50176
buffer_load_dwordx4 v183, s[8:11], s38 offen offset:1024 lds
v_mfma_f32_32x32x16_bf16 v[80:95], a[212:215], a[92:95], v[80:95]
ds_read_b64_tr_b16 a[200:201], v202 offset:49152
ds_read_b64_tr_b16 a[202:203], v202 offset:50176
v_mfma_f32_32x32x16_bf16 v[96:111], a[216:219], a[88:91], v[96:111]
ds_read_b64_tr_b16 a[204:205], v203 offset:49152
buffer_load_dwordx4 v184, s[12:15], s38 offen offset:2048 lds
v_mfma_f32_32x32x16_bf16 v[112:127], a[216:219], a[92:95], v[112:127]
ds_read_b64_tr_b16 a[206:207], v203 offset:50176
v_mfma_f32_32x32x16_bf16 v[128:143], a[220:223], a[88:91], v[128:143]
buffer_load_dwordx4 v184, s[12:15], s38 offen offset:3072 lds
v_mfma_f32_32x32x16_bf16 v[144:159], a[220:223], a[92:95], v[144:159]
s_waitcnt vmcnt(14)
s_waitcnt lgkmcnt(0)
v_mfma_f32_32x32x16_bf16 v[32:47], a[192:195], a[96:99], v[32:47]
ds_read_b64_tr_b16 a[208:209], v200 offset:57344
ds_read_b64_tr_b16 a[210:211], v200 offset:58368
v_mfma_f32_32x32x16_bf16 v[48:63], a[192:195], a[100:103], v[48:63]
ds_read_b64_tr_b16 a[212:213], v201 offset:57344
v_mfma_f32_32x32x16_bf16 v[64:79], a[196:199], a[96:99], v[64:79]
ds_read_b64_tr_b16 a[214:215], v201 offset:58368
v_mfma_f32_32x32x16_bf16 v[80:95], a[196:199], a[100:103], v[80:95]
ds_read_b64_tr_b16 a[216:217], v202 offset:57344
ds_read_b64_tr_b16 a[218:219], v202 offset:58368
v_mfma_f32_32x32x16_bf16 v[96:111], a[200:203], a[96:99], v[96:111]
ds_read_b64_tr_b16 a[220:221], v203 offset:57344
v_mfma_f32_32x32x16_bf16 v[112:127], a[200:203], a[100:103], v[112:127]
ds_read_b64_tr_b16 a[222:223], v203 offset:58368
v_mfma_f32_32x32x16_bf16 v[128:143], a[204:207], a[96:99], v[128:143]
v_mfma_f32_32x32x16_bf16 v[144:159], a[204:207], a[100:103], v[144:159]
s_waitcnt vmcnt(12)
s_waitcnt lgkmcnt(0)
v_mfma_f32_32x32x16_bf16 v[32:47], a[208:211], a[104:107], v[32:47]
ds_read_b64_tr_b16 a[192:193], v200 offset:51200
ds_read_b64_tr_b16 a[194:195], v200 offset:52224
v_mfma_f32_32x32x16_bf16 v[48:63], a[208:211], a[108:111], v[48:63]
ds_read_b64_tr_b16 a[196:197], v201 offset:51200
v_mfma_f32_32x32x16_bf16 v[64:79], a[212:215], a[104:107], v[64:79]
ds_read_b64_tr_b16 a[198:199], v201 offset:52224
v_mfma_f32_32x32x16_bf16 v[80:95], a[212:215], a[108:111], v[80:95]
ds_read_b64_tr_b16 a[200:201], v202 offset:51200
ds_read_b64_tr_b16 a[202:203], v202 offset:52224
v_mfma_f32_32x32x16_bf16 v[96:111], a[216:219], a[104:107], v[96:111]
ds_read_b64_tr_b16 a[204:205], v203 offset:51200
v_mfma_f32_32x32x16_bf16 v[112:127], a[216:219], a[108:111], v[112:127]
ds_read_b64_tr_b16 a[206:207], v203 offset:52224
v_mfma_f32_32x32x16_bf16 v[128:143], a[220:223], a[104:107], v[128:143]
v_mfma_f32_32x32x16_bf16 v[144:159], a[220:223], a[108:111], v[144:159]
s_waitcnt vmcnt(10)
s_waitcnt lgkmcnt(0)
v_mfma_f32_32x32x16_bf16 v[32:47], a[192:195], a[112:115], v[32:47]
ds_read_b64_tr_b16 a[208:209], v200 offset:59392
ds_read_b64_tr_b16 a[210:211], v200 offset:60416
v_mfma_f32_32x32x16_bf16 v[48:63], a[192:195], a[116:119], v[48:63]
ds_read_b64_tr_b16 a[212:213], v201 offset:59392
v_mfma_f32_32x32x16_bf16 v[64:79], a[196:199], a[112:115], v[64:79]
ds_read_b64_tr_b16 a[214:215], v201 offset:60416
v_mfma_f32_32x32x16_bf16 v[80:95], a[196:199], a[116:119], v[80:95]
ds_read_b64_tr_b16 a[216:217], v202 offset:59392
ds_read_b64_tr_b16 a[218:219], v202 offset:60416
v_mfma_f32_32x32x16_bf16 v[96:111], a[200:203], a[112:115], v[96:111]
ds_read_b64_tr_b16 a[220:221], v203 offset:59392
v_mfma_f32_32x32x16_bf16 v[112:127], a[200:203], a[116:119], v[112:127]
ds_read_b64_tr_b16 a[222:223], v203 offset:60416
v_mfma_f32_32x32x16_bf16 v[128:143], a[204:207], a[112:115], v[128:143]
v_mfma_f32_32x32x16_bf16 v[144:159], a[204:207], a[116:119], v[144:159]
s_waitcnt vmcnt(8)
s_waitcnt lgkmcnt(0)
s_barrier
v_mfma_f32_32x32x16_bf16 v[32:47], a[208:211], a[120:123], v[32:47]
s_add_u32 m0, s35, 65536
s_mov_b32 s38, 32768
buffer_load_dwordx4 v182, s[8:11], s38 offen lds
v_mfma_f32_32x32x16_bf16 v[48:63], a[208:211], a[124:127], v[48:63]
v_mfma_f32_32x32x16_bf16 v[64:79], a[212:215], a[120:123], v[64:79]
buffer_load_dwordx4 v183, s[8:11], s38 offen offset:1024 lds
v_mfma_f32_32x32x16_bf16 v[80:95], a[212:215], a[124:127], v[80:95]
v_mfma_f32_32x32x16_bf16 v[96:111], a[216:219], a[120:123], v[96:111]
buffer_load_dwordx4 v184, s[12:15], s38 offen offset:2048 lds
v_mfma_f32_32x32x16_bf16 v[112:127], a[216:219], a[124:127], v[112:127]
v_mfma_f32_32x32x16_bf16 v[128:143], a[220:223], a[120:123], v[128:143]
buffer_load_dwordx4 v184, s[12:15], s38 offen offset:3072 lds
v_mfma_f32_32x32x16_bf16 v[144:159], a[220:223], a[124:127], v[144:159]
ds_read_b128 a[192:195], v16 offset:0
ds_read_b128 a[196:199], v17 offset:0
ds_read_b128 a[200:203], v18 offset:0
ds_read_b128 a[204:207], v19 offset:0
ds_read_b128 a[208:211], v20 offset:0
ds_read_b128 a[212:215], v21 offset:0
ds_read_b128 a[216:219], v22 offset:0
ds_read_b128 a[220:223], v23 offset:0
s_mov_b32 s39, 0x3e0293ee
s_nop 4
v_mul_f32 v32, s39, v32
v_mul_f32 v33, s39, v33
v_mul_f32 v34, s39, v34
v_mul_f32 v35, s39, v35
v_mul_f32 v36, s39, v36
v_mul_f32 v37, s39, v37
v_mul_f32 v38, s39, v38
v_mul_f32 v39, s39, v39
v_cvt_pk_bf16_f32 v172, v32, v33
v_cvt_pk_bf16_f32 v173, v34, v35
v_cvt_pk_bf16_f32 v174, v36, v37
v_cvt_pk_bf16_f32 v175, v38, v39
v_accvgpr_write_b32 a128, v172
v_accvgpr_write_b32 a129, v173
v_accvgpr_write_b32 a130, v174
v_accvgpr_write_b32 a131, v175
v_mul_f32 v40, s39, v40
v_mul_f32 v41, s39, v41
v_mul_f32 v42, s39, v42
v_mul_f32 v43, s39, v43
v_mul_f32 v44, s39, v44
v_mul_f32 v45, s39, v45
v_mul_f32 v46, s39, v46
v_mul_f32 v47, s39, v47
v_cvt_pk_bf16_f32 v176, v40, v41
v_cvt_pk_bf16_f32 v177, v42, v43
v_cvt_pk_bf16_f32 v178, v44, v45
v_cvt_pk_bf16_f32 v179, v46, v47
v_accvgpr_write_b32 a132, v176
v_accvgpr_write_b32 a133, v177
v_accvgpr_write_b32 a134, v178
v_accvgpr_write_b32 a135, v179
v_mul_f32 v48, s39, v48
v_mul_f32 v49, s39, v49
v_mul_f32 v50, s39, v50
v_mul_f32 v51, s39, v51
v_mul_f32 v52, s39, v52
v_mul_f32 v53, s39, v53
v_mul_f32 v54, s39, v54
v_mul_f32 v55, s39, v55
v_cvt_pk_bf16_f32 v172, v48, v49
v_cvt_pk_bf16_f32 v173, v50, v51
v_cvt_pk_bf16_f32 v174, v52, v53
v_cvt_pk_bf16_f32 v175, v54, v55
v_accvgpr_write_b32 a160, v172
v_accvgpr_write_b32 a161, v173
v_accvgpr_write_b32 a162, v174
v_accvgpr_write_b32 a163, v175
v_mul_f32 v56, s39, v56
v_mul_f32 v57, s39, v57
v_mul_f32 v58, s39, v58
v_mul_f32 v59, s39, v59
v_mul_f32 v60, s39, v60
v_mul_f32 v61, s39, v61
v_mul_f32 v62, s39, v62
v_mul_f32 v63, s39, v63
v_cvt_pk_bf16_f32 v176, v56, v57
v_cvt_pk_bf16_f32 v177, v58, v59
v_cvt_pk_bf16_f32 v178, v60, v61
v_cvt_pk_bf16_f32 v179, v62, v63
v_accvgpr_write_b32 a164, v176
v_accvgpr_write_b32 a165, v177
v_accvgpr_write_b32 a166, v178
v_accvgpr_write_b32 a167, v179
s_waitcnt lgkmcnt(0)
v_mfma_f32_32x32x16_bf16 v[32:47], a[192:195], a[128:131], 0
v_mul_f32 v64, s39, v64
v_mul_f32 v65, s39, v65
v_mul_f32 v66, s39, v66
v_mul_f32 v67, s39, v67
v_mul_f32 v68, s39, v68
v_mul_f32 v69, s39, v69
v_mfma_f32_32x32x16_bf16 v[48:63], a[192:195], a[160:163], 0
v_mul_f32 v70, s39, v70
v_mul_f32 v71, s39, v71
v_cvt_pk_bf16_f32 v172, v64, v65
v_cvt_pk_bf16_f32 v173, v66, v67
v_cvt_pk_bf16_f32 v174, v68, v69
v_cvt_pk_bf16_f32 v175, v70, v71
v_mfma_f32_32x32x16_bf16 v[32:47], a[196:199], a[132:135], v[32:47]
v_accvgpr_write_b32 a136, v172
v_accvgpr_write_b32 a137, v173
v_accvgpr_write_b32 a138, v174
v_accvgpr_write_b32 a139, v175
v_mul_f32 v72, s39, v72
v_mul_f32 v73, s39, v73
v_mfma_f32_32x32x16_bf16 v[48:63], a[196:199], a[164:167], v[48:63]
v_mul_f32 v74, s39, v74
v_mul_f32 v75, s39, v75
v_mul_f32 v76, s39, v76
v_mul_f32 v77, s39, v77
v_mul_f32 v78, s39, v78
v_mul_f32 v79, s39, v79
v_cvt_pk_bf16_f32 v176, v72, v73
v_cvt_pk_bf16_f32 v177, v74, v75
v_cvt_pk_bf16_f32 v178, v76, v77
v_cvt_pk_bf16_f32 v179, v78, v79
v_accvgpr_write_b32 a140, v176
v_accvgpr_write_b32 a141, v177
v_accvgpr_write_b32 a142, v178
v_accvgpr_write_b32 a143, v179
v_mul_f32 v80, s39, v80
v_mul_f32 v81, s39, v81
v_mul_f32 v82, s39, v82
v_mul_f32 v83, s39, v83
v_mul_f32 v84, s39, v84
v_mul_f32 v85, s39, v85
v_mul_f32 v86, s39, v86
v_mul_f32 v87, s39, v87
v_cvt_pk_bf16_f32 v172, v80, v81
v_cvt_pk_bf16_f32 v173, v82, v83
v_cvt_pk_bf16_f32 v174, v84, v85
v_cvt_pk_bf16_f32 v175, v86, v87
v_accvgpr_write_b32 a168, v172
v_accvgpr_write_b32 a169, v173
v_accvgpr_write_b32 a170, v174
v_accvgpr_write_b32 a171, v175
v_mul_f32 v88, s39, v88
v_mul_f32 v89, s39, v89
v_mul_f32 v90, s39, v90
v_mul_f32 v91, s39, v91
v_mul_f32 v92, s39, v92
v_mul_f32 v93, s39, v93
v_mul_f32 v94, s39, v94
v_mul_f32 v95, s39, v95
v_cvt_pk_bf16_f32 v176, v88, v89
v_cvt_pk_bf16_f32 v177, v90, v91
v_cvt_pk_bf16_f32 v178, v92, v93
v_cvt_pk_bf16_f32 v179, v94, v95
v_accvgpr_write_b32 a172, v176
v_accvgpr_write_b32 a173, v177
v_accvgpr_write_b32 a174, v178
v_accvgpr_write_b32 a175, v179
v_mfma_f32_32x32x16_bf16 v[32:47], a[200:203], a[136:139], v[32:47]
v_mul_f32 v96, s39, v96
v_mul_f32 v97, s39, v97
v_mul_f32 v98, s39, v98
v_mul_f32 v99, s39, v99
v_mul_f32 v100, s39, v100
v_mul_f32 v101, s39, v101
v_mfma_f32_32x32x16_bf16 v[48:63], a[200:203], a[168:171], v[48:63]
v_mul_f32 v102, s39, v102
v_mul_f32 v103, s39, v103
v_cvt_pk_bf16_f32 v172, v96, v97
v_cvt_pk_bf16_f32 v173, v98, v99
v_cvt_pk_bf16_f32 v174, v100, v101
v_cvt_pk_bf16_f32 v175, v102, v103
v_mfma_f32_32x32x16_bf16 v[32:47], a[204:207], a[140:143], v[32:47]
v_accvgpr_write_b32 a144, v172
v_accvgpr_write_b32 a145, v173
v_accvgpr_write_b32 a146, v174
v_accvgpr_write_b32 a147, v175
v_mul_f32 v104, s39, v104
v_mul_f32 v105, s39, v105
v_mfma_f32_32x32x16_bf16 v[48:63], a[204:207], a[172:175], v[48:63]
v_mul_f32 v106, s39, v106
v_mul_f32 v107, s39, v107
v_mul_f32 v108, s39, v108
v_mul_f32 v109, s39, v109
v_mul_f32 v110, s39, v110
v_mul_f32 v111, s39, v111
v_cvt_pk_bf16_f32 v176, v104, v105
v_cvt_pk_bf16_f32 v177, v106, v107
v_cvt_pk_bf16_f32 v178, v108, v109
v_cvt_pk_bf16_f32 v179, v110, v111
v_accvgpr_write_b32 a148, v176
v_accvgpr_write_b32 a149, v177
v_accvgpr_write_b32 a150, v178
v_accvgpr_write_b32 a151, v179
v_mul_f32 v112, s39, v112
v_mul_f32 v113, s39, v113
v_mul_f32 v114, s39, v114
v_mul_f32 v115, s39, v115
v_mul_f32 v116, s39, v116
v_mul_f32 v117, s39, v117
v_mul_f32 v118, s39, v118
v_mul_f32 v119, s39, v119
v_cvt_pk_bf16_f32 v172, v112, v113
v_cvt_pk_bf16_f32 v173, v114, v115
v_cvt_pk_bf16_f32 v174, v116, v117
v_cvt_pk_bf16_f32 v175, v118, v119
v_accvgpr_write_b32 a176, v172
v_accvgpr_write_b32 a177, v173
v_accvgpr_write_b32 a178, v174
v_accvgpr_write_b32 a179, v175
v_mul_f32 v120, s39, v120
v_mul_f32 v121, s39, v121
v_mul_f32 v122, s39, v122
v_mul_f32 v123, s39, v123
v_mul_f32 v124, s39, v124
v_mul_f32 v125, s39, v125
v_mul_f32 v126, s39, v126
v_mul_f32 v127, s39, v127
v_cvt_pk_bf16_f32 v176, v120, v121
v_cvt_pk_bf16_f32 v177, v122, v123
v_cvt_pk_bf16_f32 v178, v124, v125
v_cvt_pk_bf16_f32 v179, v126, v127
v_accvgpr_write_b32 a180, v176
v_accvgpr_write_b32 a181, v177
v_accvgpr_write_b32 a182, v178
v_accvgpr_write_b32 a183, v179
v_mfma_f32_32x32x16_bf16 v[32:47], a[208:211], a[144:147], v[32:47]
v_mul_f32 v128, s39, v128
v_mul_f32 v129, s39, v129
v_mul_f32 v130, s39, v130
v_mul_f32 v131, s39, v131
v_mul_f32 v132, s39, v132
v_mul_f32 v133, s39, v133
v_mfma_f32_32x32x16_bf16 v[48:63], a[208:211], a[176:179], v[48:63]
v_mul_f32 v134, s39, v134
v_mul_f32 v135, s39, v135
v_cvt_pk_bf16_f32 v172, v128, v129
v_cvt_pk_bf16_f32 v173, v130, v131
v_cvt_pk_bf16_f32 v174, v132, v133
v_cvt_pk_bf16_f32 v175, v134, v135
v_mfma_f32_32x32x16_bf16 v[32:47], a[212:215], a[148:151], v[32:47]
v_accvgpr_write_b32 a152, v172
v_accvgpr_write_b32 a153, v173
v_accvgpr_write_b32 a154, v174
v_accvgpr_write_b32 a155, v175
v_mul_f32 v136, s39, v136
v_mul_f32 v137, s39, v137
v_mfma_f32_32x32x16_bf16 v[48:63], a[212:215], a[180:183], v[48:63]
v_mul_f32 v138, s39, v138
v_mul_f32 v139, s39, v139
v_mul_f32 v140, s39, v140
v_mul_f32 v141, s39, v141
v_mul_f32 v142, s39, v142
v_mul_f32 v143, s39, v143
v_cvt_pk_bf16_f32 v176, v136, v137
v_cvt_pk_bf16_f32 v177, v138, v139
v_cvt_pk_bf16_f32 v178, v140, v141
v_cvt_pk_bf16_f32 v179, v142, v143
v_accvgpr_write_b32 a156, v176
v_accvgpr_write_b32 a157, v177
v_accvgpr_write_b32 a158, v178
v_accvgpr_write_b32 a159, v179
v_mul_f32 v144, s39, v144
v_mul_f32 v145, s39, v145
v_mul_f32 v146, s39, v146
v_mul_f32 v147, s39, v147
v_mul_f32 v148, s39, v148
v_mul_f32 v149, s39, v149
v_mul_f32 v150, s39, v150
v_mul_f32 v151, s39, v151
v_cvt_pk_bf16_f32 v172, v144, v145
v_cvt_pk_bf16_f32 v173, v146, v147
v_cvt_pk_bf16_f32 v174, v148, v149
v_cvt_pk_bf16_f32 v175, v150, v151
v_accvgpr_write_b32 a184, v172
v_accvgpr_write_b32 a185, v173
v_accvgpr_write_b32 a186, v174
v_accvgpr_write_b32 a187, v175
v_mul_f32 v152, s39, v152
v_mul_f32 v153, s39, v153
v_mul_f32 v154, s39, v154
v_mul_f32 v155, s39, v155
v_mul_f32 v156, s39, v156
v_mul_f32 v157, s39, v157
v_mul_f32 v158, s39, v158
v_mul_f32 v159, s39, v159
v_cvt_pk_bf16_f32 v176, v152, v153
v_cvt_pk_bf16_f32 v177, v154, v155
v_cvt_pk_bf16_f32 v178, v156, v157
v_cvt_pk_bf16_f32 v179, v158, v159
v_accvgpr_write_b32 a188, v176
v_accvgpr_write_b32 a189, v177
v_accvgpr_write_b32 a190, v178
v_accvgpr_write_b32 a191, v179
s_nop 1
v_mfma_f32_32x32x16_bf16 v[32:47], a[216:219], a[152:155], v[32:47]
v_mfma_f32_32x32x16_bf16 v[48:63], a[216:219], a[184:187], v[48:63]
v_mfma_f32_32x32x16_bf16 v[32:47], a[220:223], a[156:159], v[32:47]
v_mfma_f32_32x32x16_bf16 v[48:63], a[220:223], a[188:191], v[48:63]
s_nop 15
v_max_f32 v189, v32, v33
v_max3_f32 v189, v189, v34, v35
v_max3_f32 v189, v189, v36, v37
v_max3_f32 v189, v189, v38, v39
v_max3_f32 v189, v189, v40, v41
v_max3_f32 v189, v189, v42, v43
v_max3_f32 v189, v189, v44, v45
v_max3_f32 v189, v189, v46, v47
v_mov_b32 v190, v189
s_nop 1
v_permlane32_swap_b32 v189, v190
v_max_f32 v189, v189, v190
v_ceil_f32 v189, v189
v_add_f32 v189, 0x42c00000, v189
v_sub_f32 v128, 0, v189
v_mov_b32 v129, v128
v_mov_b32 v130, v128
v_mov_b32 v131, v128
v_mov_b32 v132, v128
v_mov_b32 v133, v128
v_mov_b32 v134, v128
v_mov_b32 v135, v128
v_mov_b32 v136, v128
v_mov_b32 v137, v128
v_mov_b32 v138, v128
v_mov_b32 v139, v128
v_mov_b32 v140, v128
v_mov_b32 v141, v128
v_mov_b32 v142, v128
v_mov_b32 v143, v128
v_sub_f32 v32, v32, v189
v_sub_f32 v33, v33, v189
v_sub_f32 v34, v34, v189
v_sub_f32 v35, v35, v189
v_sub_f32 v36, v36, v189
v_sub_f32 v37, v37, v189
v_sub_f32 v38, v38, v189
v_sub_f32 v39, v39, v189
v_sub_f32 v40, v40, v189
v_sub_f32 v41, v41, v189
v_sub_f32 v42, v42, v189
v_sub_f32 v43, v43, v189
v_sub_f32 v44, v44, v189
v_sub_f32 v45, v45, v189
v_sub_f32 v46, v46, v189
v_sub_f32 v47, v47, v189
v_max_f32 v189, v48, v49
v_max3_f32 v189, v189, v50, v51
v_max3_f32 v189, v189, v52, v53
v_max3_f32 v189, v189, v54, v55
v_max3_f32 v189, v189, v56, v57
v_max3_f32 v189, v189, v58, v59
v_max3_f32 v189, v189, v60, v61
v_max3_f32 v189, v189, v62, v63
v_mov_b32 v190, v189
s_nop 1
v_permlane32_swap_b32 v189, v190
v_max_f32 v189, v189, v190
v_ceil_f32 v189, v189
v_add_f32 v189, 0x42c00000, v189
v_sub_f32 v144, 0, v189
v_mov_b32 v145, v144
v_mov_b32 v146, v144
v_mov_b32 v147, v144
v_mov_b32 v148, v144
v_mov_b32 v149, v144
v_mov_b32 v150, v144
v_mov_b32 v151, v144
v_mov_b32 v152, v144
v_mov_b32 v153, v144
v_mov_b32 v154, v144
v_mov_b32 v155, v144
v_mov_b32 v156, v144
v_mov_b32 v157, v144
v_mov_b32 v158, v144
v_mov_b32 v159, v144
v_sub_f32 v48, v48, v189
v_sub_f32 v49, v49, v189
v_sub_f32 v50, v50, v189
v_sub_f32 v51, v51, v189
v_sub_f32 v52, v52, v189
v_sub_f32 v53, v53, v189
v_sub_f32 v54, v54, v189
v_sub_f32 v55, v55, v189
v_sub_f32 v56, v56, v189
v_sub_f32 v57, v57, v189
v_sub_f32 v58, v58, v189
v_sub_f32 v59, v59, v189
v_sub_f32 v60, v60, v189
v_sub_f32 v61, v61, v189
v_sub_f32 v62, v62, v189
v_sub_f32 v63, v63, v189
s_mov_b32 s32, 40960
s_waitcnt vmcnt(63)
s_barrier
ds_read_b128 a[192:195], v16 offset:16384
ds_read_b128 a[196:199], v17 offset:16384
ds_read_b128 a[200:203], v18 offset:16384
ds_read_b128 a[204:207], v19 offset:16384
ds_read_b128 a[208:211], v20 offset:16384
ds_read_b128 a[212:215], v21 offset:16384
ds_read_b128 a[216:219], v22 offset:16384
ds_read_b128 a[220:223], v23 offset:16384
s_waitcnt lgkmcnt(0)
v_mfma_f32_32x32x16_bf16 v[64:79], a[192:195], a[128:131], v[128:143]
ds_read_b64_tr_b16 a[224:225], v24 offset:16384
ds_read_b64_tr_b16 a[226:227], v24 offset:20480
v_mfma_f32_32x32x16_bf16 v[80:95], a[192:195], a[160:163], v[144:159]
ds_read_b64_tr_b16 a[228:229], v25 offset:16384
v_mfma_f32_32x32x16_bf16 v[64:79], a[196:199], a[132:135], v[64:79]
s_add_u32 m0, s35, 81920
ds_read_b64_tr_b16 a[230:231], v25 offset:20480
v_mfma_f32_32x32x16_bf16 v[80:95], a[196:199], a[164:167], v[80:95]
v_exp_f32 v172, v32
v_exp_f32 v173, v33
v_exp_f32 v174, v34
v_mfma_f32_32x32x16_bf16 v[64:79], a[200:203], a[136:139], v[64:79]
v_cvt_pk_bf16_f32 v96, v172, v173
v_exp_f32 v175, v35
ds_read_b64_tr_b16 a[232:233], v26 offset:16384
v_add_f32 v162, v172, v173
ds_read_b64_tr_b16 a[234:235], v26 offset:20480
v_mfma_f32_32x32x16_bf16 v[80:95], a[200:203], a[168:171], v[80:95]
v_exp_f32 v176, v36
v_cvt_pk_bf16_f32 v97, v174, v175
v_exp_f32 v177, v37
v_add_f32 v162, v162, v174
v_mfma_f32_32x32x16_bf16 v[64:79], a[204:207], a[140:143], v[64:79]
v_add_f32 v162, v162, v175
v_exp_f32 v178, v38
v_cvt_pk_bf16_f32 v98, v176, v177
ds_read_b64_tr_b16 a[236:237], v27 offset:16384
ds_read_b64_tr_b16 a[238:239], v27 offset:20480
v_mfma_f32_32x32x16_bf16 v[80:95], a[204:207], a[172:175], v[80:95]
v_exp_f32 v179, v39
buffer_load_dwordx4 v182, s[8:11], s32 offen lds
v_mfma_f32_32x32x16_bf16 v[64:79], a[208:211], a[144:147], v[64:79]
v_add_f32 v162, v162, v176
v_add_f32 v162, v162, v177
v_exp_f32 v172, v40
v_cvt_pk_bf16_f32 v99, v178, v179
ds_read_b64_tr_b16 a[240:241], v24 offset:24576
v_mfma_f32_32x32x16_bf16 v[80:95], a[208:211], a[176:179], v[80:95]
v_exp_f32 v173, v41
v_add_f32 v162, v162, v178
v_add_f32 v162, v162, v179
v_exp_f32 v174, v42
v_mfma_f32_32x32x16_bf16 v[64:79], a[212:215], a[148:151], v[64:79]
v_cvt_pk_bf16_f32 v100, v172, v173
v_exp_f32 v175, v43
v_add_f32 v162, v162, v172
v_add_f32 v162, v162, v173
ds_read_b64_tr_b16 a[242:243], v24 offset:28672
v_mfma_f32_32x32x16_bf16 v[80:95], a[212:215], a[180:183], v[80:95]
ds_read_b64_tr_b16 a[244:245], v25 offset:24576
ds_read_b64_tr_b16 a[246:247], v25 offset:28672
ds_read_b64_tr_b16 a[248:249], v26 offset:24576
ds_read_b64_tr_b16 a[250:251], v26 offset:28672
ds_read_b64_tr_b16 a[252:253], v27 offset:24576
ds_read_b64_tr_b16 a[254:255], v27 offset:28672
v_mfma_f32_32x32x16_bf16 v[64:79], a[216:219], a[152:155], v[64:79]
buffer_load_dwordx4 v183, s[8:11], s32 offen offset:1024 lds
v_exp_f32 v176, v44
v_mfma_f32_32x32x16_bf16 v[80:95], a[216:219], a[184:187], v[80:95]
buffer_load_dwordx4 v184, s[12:15], s32 offen offset:2048 lds
buffer_load_dwordx4 v184, s[12:15], s32 offen offset:3072 lds
s_add_u32 s32, s32, 8192
v_mfma_f32_32x32x16_bf16 v[64:79], a[220:223], a[156:159], v[64:79]
v_cvt_pk_bf16_f32 v101, v174, v175
v_exp_f32 v177, v45
v_add_f32 v162, v162, v174
v_add_f32 v162, v162, v175
v_exp_f32 v178, v46
v_cvt_pk_bf16_f32 v102, v176, v177
v_exp_f32 v179, v47
v_add_f32 v162, v162, v176
v_add_f32 v162, v162, v177
v_exp_f32 v172, v48
v_cvt_pk_bf16_f32 v103, v178, v179
v_exp_f32 v173, v49
v_add_f32 v162, v162, v178
v_add_f32 v162, v162, v179
v_exp_f32 v174, v50
v_cvt_pk_bf16_f32 v104, v172, v173
v_exp_f32 v175, v51
v_add_f32 v163, v172, v173
v_exp_f32 v176, v52
v_cvt_pk_bf16_f32 v105, v174, v175
v_exp_f32 v177, v53
v_add_f32 v163, v163, v174
v_add_f32 v163, v163, v175
v_exp_f32 v178, v54
v_cvt_pk_bf16_f32 v106, v176, v177
v_exp_f32 v179, v55
v_add_f32 v163, v163, v176
v_add_f32 v163, v163, v177
v_exp_f32 v172, v56
v_cvt_pk_bf16_f32 v107, v178, v179
v_exp_f32 v173, v57
v_add_f32 v163, v163, v178
v_add_f32 v163, v163, v179
v_exp_f32 v174, v58
v_cvt_pk_bf16_f32 v108, v172, v173
v_exp_f32 v175, v59
v_add_f32 v163, v163, v172
v_add_f32 v163, v163, v173
v_exp_f32 v176, v60
v_cvt_pk_bf16_f32 v109, v174, v175
v_exp_f32 v177, v61
v_add_f32 v163, v163, v174
v_add_f32 v163, v163, v175
v_exp_f32 v178, v62
v_cvt_pk_bf16_f32 v110, v176, v177
v_exp_f32 v179, v63
v_add_f32 v163, v163, v176
v_add_f32 v163, v163, v177
v_cvt_pk_bf16_f32 v111, v178, v179
v_add_f32 v163, v163, v178
v_add_f32 v163, v163, v179
v_max_f32 v188, v162, v163
v_cmp_nle_f32 vcc, v188, v180
v_mfma_f32_32x32x16_bf16 v[80:95], a[220:223], a[188:191], v[80:95]
s_cbranch_vccnz attn_kernel_tr_p0
attn_kernel_back_p0:
s_waitcnt lgkmcnt(0)
v_mfma_f32_32x32x16_bf16 a[0:15], a[224:227], v[96:99], 0
s_waitcnt vmcnt(12)
s_barrier
v_mfma_f32_32x32x16_bf16 a[16:31], a[224:227], v[104:107], 0
ds_read_b128 a[192:195], v16 offset:32768
v_mfma_f32_32x32x16_bf16 a[32:47], a[228:231], v[96:99], 0
ds_read_b128 a[196:199], v17 offset:32768
v_mfma_f32_32x32x16_bf16 a[48:63], a[228:231], v[104:107], 0
ds_read_b128 a[200:203], v18 offset:32768
v_add_f32 v160, v160, v162
v_add_f32 v161, v161, v163
v_exp_f32 v172, v64
v_mfma_f32_32x32x16_bf16 a[64:79], a[232:235], v[96:99], 0
s_add_u32 m0, s35, 98304
ds_read_b128 a[204:207], v19 offset:32768
v_mfma_f32_32x32x16_bf16 a[80:95], a[232:235], v[104:107], 0
v_exp_f32 v173, v65
v_exp_f32 v174, v66
v_cvt_pk_bf16_f32 v112, v172, v173
v_mfma_f32_32x32x16_bf16 a[96:111], a[236:239], v[96:99], 0
ds_read_b128 a[208:211], v20 offset:32768
v_exp_f32 v175, v67
v_add_f32 v162, v172, v173
v_exp_f32 v176, v68
v_mfma_f32_32x32x16_bf16 a[112:127], a[236:239], v[104:107], 0
ds_read_b128 a[212:215], v21 offset:32768
v_cvt_pk_bf16_f32 v113, v174, v175
v_exp_f32 v177, v69
v_add_f32 v162, v162, v174
v_add_f32 v162, v162, v175
v_mfma_f32_32x32x16_bf16 a[0:15], a[240:243], v[100:103], a[0:15]
buffer_load_dwordx4 v182, s[8:11], s32 offen lds
ds_read_b128 a[216:219], v22 offset:32768
v_mfma_f32_32x32x16_bf16 a[16:31], a[240:243], v[108:111], a[16:31]
v_exp_f32 v178, v70
v_cvt_pk_bf16_f32 v114, v176, v177
v_exp_f32 v179, v71
v_add_f32 v162, v162, v176
v_mfma_f32_32x32x16_bf16 a[32:47], a[244:247], v[100:103], a[32:47]
ds_read_b128 a[220:223], v23 offset:32768
v_add_f32 v162, v162, v177
v_exp_f32 v172, v72
v_cvt_pk_bf16_f32 v115, v178, v179
v_mfma_f32_32x32x16_bf16 a[48:63], a[244:247], v[108:111], a[48:63]
v_exp_f32 v173, v73
buffer_load_dwordx4 v183, s[8:11], s32 offen offset:1024 lds
v_mfma_f32_32x32x16_bf16 a[64:79], a[248:251], v[100:103], a[64:79]
v_add_f32 v162, v162, v178
v_add_f32 v162, v162, v179
v_exp_f32 v174, v74
v_cvt_pk_bf16_f32 v116, v172, v173
v_mfma_f32_32x32x16_bf16 a[80:95], a[248:251], v[108:111], a[80:95]
v_exp_f32 v175, v75
v_add_f32 v162, v162, v172
v_add_f32 v162, v162, v173
v_exp_f32 v176, v76
v_mfma_f32_32x32x16_bf16 a[96:111], a[252:255], v[100:103], a[96:111]
v_cvt_pk_bf16_f32 v117, v174, v175
buffer_load_dwordx4 v184, s[12:15], s32 offen offset:2048 lds
v_mfma_f32_32x32x16_bf16 a[112:127], a[252:255], v[108:111], a[112:127]
v_exp_f32 v177, v77
v_add_f32 v162, v162, v174
v_add_f32 v162, v162, v175
v_exp_f32 v178, v78
s_waitcnt lgkmcnt(0)
v_mfma_f32_32x32x16_bf16 v[32:47], a[192:195], a[128:131], v[128:143]
ds_read_b64_tr_b16 a[224:225], v24 offset:32768
v_cvt_pk_bf16_f32 v118, v176, v177
v_exp_f32 v179, v79
v_add_f32 v162, v162, v176
v_add_f32 v162, v162, v177
v_mfma_f32_32x32x16_bf16 v[48:63], a[192:195], a[160:163], v[144:159]
ds_read_b64_tr_b16 a[226:227], v24 offset:36864
v_exp_f32 v172, v80
v_cvt_pk_bf16_f32 v119, v178, v179
ds_read_b64_tr_b16 a[228:229], v25 offset:32768
v_mfma_f32_32x32x16_bf16 v[32:47], a[196:199], a[132:135], v[32:47]
buffer_load_dwordx4 v184, s[12:15], s32 offen offset:3072 lds
v_exp_f32 v173, v81
v_mfma_f32_32x32x16_bf16 v[48:63], a[196:199], a[164:167], v[48:63]
ds_read_b64_tr_b16 a[230:231], v25 offset:36864
v_add_f32 v162, v162, v178
ds_read_b64_tr_b16 a[232:233], v26 offset:32768
v_add_f32 v162, v162, v179
v_exp_f32 v174, v82
v_mfma_f32_32x32x16_bf16 v[32:47], a[200:203], a[136:139], v[32:47]
s_add_u32 s32, s32, 8192
ds_read_b64_tr_b16 a[234:235], v26 offset:36864
v_cvt_pk_bf16_f32 v120, v172, v173
v_exp_f32 v175, v83
v_add_f32 v163, v172, v173
v_mfma_f32_32x32x16_bf16 v[48:63], a[200:203], a[168:171], v[48:63]
ds_read_b64_tr_b16 a[236:237], v27 offset:32768
v_exp_f32 v176, v84
v_cvt_pk_bf16_f32 v121, v174, v175
v_exp_f32 v177, v85
v_mfma_f32_32x32x16_bf16 v[32:47], a[204:207], a[140:143], v[32:47]
ds_read_b64_tr_b16 a[238:239], v27 offset:36864
ds_read_b64_tr_b16 a[240:241], v24 offset:40960
v_add_f32 v163, v163, v174
v_add_f32 v163, v163, v175
v_exp_f32 v178, v86
v_mfma_f32_32x32x16_bf16 v[48:63], a[204:207], a[172:175], v[48:63]
ds_read_b64_tr_b16 a[242:243], v24 offset:45056
v_cvt_pk_bf16_f32 v122, v176, v177
v_exp_f32 v179, v87
v_add_f32 v163, v163, v176
v_add_f32 v163, v163, v177
v_mfma_f32_32x32x16_bf16 v[32:47], a[208:211], a[144:147], v[32:47]
ds_read_b64_tr_b16 a[244:245], v25 offset:40960
v_exp_f32 v172, v88
ds_read_b64_tr_b16 a[246:247], v25 offset:45056
v_cvt_pk_bf16_f32 v123, v178, v179
v_mfma_f32_32x32x16_bf16 v[48:63], a[208:211], a[176:179], v[48:63]
v_exp_f32 v173, v89
ds_read_b64_tr_b16 a[248:249], v26 offset:40960
v_add_f32 v163, v163, v178
v_add_f32 v163, v163, v179
ds_read_b64_tr_b16 a[250:251], v26 offset:45056
v_mfma_f32_32x32x16_bf16 v[32:47], a[212:215], a[148:151], v[32:47]
v_exp_f32 v174, v90
v_cvt_pk_bf16_f32 v124, v172, v173
v_exp_f32 v175, v91
ds_read_b64_tr_b16 a[252:253], v27 offset:40960
v_mfma_f32_32x32x16_bf16 v[48:63], a[212:215], a[180:183], v[48:63]
ds_read_b64_tr_b16 a[254:255], v27 offset:45056
v_add_f32 v163, v163, v172
v_add_f32 v163, v163, v173
v_exp_f32 v176, v92
v_cvt_pk_bf16_f32 v125, v174, v175
v_mfma_f32_32x32x16_bf16 v[32:47], a[216:219], a[152:155], v[32:47]
v_exp_f32 v177, v93
v_add_f32 v163, v163, v174
v_add_f32 v163, v163, v175
v_exp_f32 v178, v94
v_mfma_f32_32x32x16_bf16 v[48:63], a[216:219], a[184:187], v[48:63]
v_cvt_pk_bf16_f32 v126, v176, v177
v_exp_f32 v179, v95
v_add_f32 v163, v163, v176
v_add_f32 v163, v163, v177
v_cvt_pk_bf16_f32 v127, v178, v179
v_mfma_f32_32x32x16_bf16 v[32:47], a[220:223], a[156:159], v[32:47]
v_add_f32 v163, v163, v178
v_add_f32 v163, v163, v179
v_max_f32 v188, v162, v163
v_cmp_nle_f32 vcc, v188, v180
v_mfma_f32_32x32x16_bf16 v[48:63], a[220:223], a[188:191], v[48:63]
s_cbranch_vccnz attn_kernel_tr_p1
attn_kernel_back_p1:
s_mov_b32 s31, 7
attn_kernel_loop:
s_waitcnt lgkmcnt(0)
v_mfma_f32_32x32x16_bf16 a[0:15], a[224:227], v[112:115], a[0:15]
s_waitcnt vmcnt(12)
s_barrier
v_mfma_f32_32x32x16_bf16 a[16:31], a[224:227], v[120:123], a[16:31]
ds_read_b128 a[192:195], v16 offset:49152
v_mfma_f32_32x32x16_bf16 a[32:47], a[228:231], v[112:115], a[32:47]
ds_read_b128 a[196:199], v17 offset:49152
v_mfma_f32_32x32x16_bf16 a[48:63], a[228:231], v[120:123], a[48:63]
ds_read_b128 a[200:203], v18 offset:49152
v_add_f32 v160, v160, v162
v_add_f32 v161, v161, v163
v_exp_f32 v172, v32
v_mfma_f32_32x32x16_bf16 a[64:79], a[232:235], v[112:115], a[64:79]
s_add_u32 m0, s35, 114688
ds_read_b128 a[204:207], v19 offset:49152
v_mfma_f32_32x32x16_bf16 a[80:95], a[232:235], v[120:123], a[80:95]
v_exp_f32 v173, v33
v_exp_f32 v174, v34
v_cvt_pk_bf16_f32 v96, v172, v173
v_mfma_f32_32x32x16_bf16 a[96:111], a[236:239], v[112:115], a[96:111]
ds_read_b128 a[208:211], v20 offset:49152
v_exp_f32 v175, v35
v_add_f32 v162, v172, v173
v_exp_f32 v176, v36
v_mfma_f32_32x32x16_bf16 a[112:127], a[236:239], v[120:123], a[112:127]
ds_read_b128 a[212:215], v21 offset:49152
v_cvt_pk_bf16_f32 v97, v174, v175
v_exp_f32 v177, v37
v_add_f32 v162, v162, v174
v_add_f32 v162, v162, v175
v_mfma_f32_32x32x16_bf16 a[0:15], a[240:243], v[116:119], a[0:15]
buffer_load_dwordx4 v182, s[8:11], s32 offen lds
ds_read_b128 a[216:219], v22 offset:49152
v_mfma_f32_32x32x16_bf16 a[16:31], a[240:243], v[124:127], a[16:31]
v_exp_f32 v178, v38
v_cvt_pk_bf16_f32 v98, v176, v177
v_exp_f32 v179, v39
v_add_f32 v162, v162, v176
v_mfma_f32_32x32x16_bf16 a[32:47], a[244:247], v[116:119], a[32:47]
ds_read_b128 a[220:223], v23 offset:49152
v_add_f32 v162, v162, v177
v_exp_f32 v172, v40
v_cvt_pk_bf16_f32 v99, v178, v179
v_mfma_f32_32x32x16_bf16 a[48:63], a[244:247], v[124:127], a[48:63]
v_exp_f32 v173, v41
buffer_load_dwordx4 v183, s[8:11], s32 offen offset:1024 lds
v_mfma_f32_32x32x16_bf16 a[64:79], a[248:251], v[116:119], a[64:79]
v_add_f32 v162, v162, v178
v_add_f32 v162, v162, v179
v_exp_f32 v174, v42
v_cvt_pk_bf16_f32 v100, v172, v173
v_mfma_f32_32x32x16_bf16 a[80:95], a[248:251], v[124:127], a[80:95]
v_exp_f32 v175, v43
v_add_f32 v162, v162, v172
v_add_f32 v162, v162, v173
v_exp_f32 v176, v44
v_mfma_f32_32x32x16_bf16 a[96:111], a[252:255], v[116:119], a[96:111]
v_cvt_pk_bf16_f32 v101, v174, v175
buffer_load_dwordx4 v184, s[12:15], s32 offen offset:2048 lds
v_mfma_f32_32x32x16_bf16 a[112:127], a[252:255], v[124:127], a[112:127]
v_exp_f32 v177, v45
v_add_f32 v162, v162, v174
v_add_f32 v162, v162, v175
v_exp_f32 v178, v46
s_waitcnt lgkmcnt(0)
v_mfma_f32_32x32x16_bf16 v[64:79], a[192:195], a[128:131], v[128:143]
ds_read_b64_tr_b16 a[224:225], v24 offset:49152
v_cvt_pk_bf16_f32 v102, v176, v177
v_exp_f32 v179, v47
v_add_f32 v162, v162, v176
v_add_f32 v162, v162, v177
v_mfma_f32_32x32x16_bf16 v[80:95], a[192:195], a[160:163], v[144:159]
ds_read_b64_tr_b16 a[226:227], v24 offset:53248
v_exp_f32 v172, v48
v_cvt_pk_bf16_f32 v103, v178, v179
ds_read_b64_tr_b16 a[228:229], v25 offset:49152
v_mfma_f32_32x32x16_bf16 v[64:79], a[196:199], a[132:135], v[64:79]
buffer_load_dwordx4 v184, s[12:15], s32 offen offset:3072 lds
v_exp_f32 v173, v49
v_mfma_f32_32x32x16_bf16 v[80:95], a[196:199], a[164:167], v[80:95]
ds_read_b64_tr_b16 a[230:231], v25 offset:53248
v_add_f32 v162, v162, v178
ds_read_b64_tr_b16 a[232:233], v26 offset:49152
v_add_f32 v162, v162, v179
v_exp_f32 v174, v50
v_mfma_f32_32x32x16_bf16 v[64:79], a[200:203], a[136:139], v[64:79]
s_add_u32 s32, s32, 8192
ds_read_b64_tr_b16 a[234:235], v26 offset:53248
v_cvt_pk_bf16_f32 v104, v172, v173
v_exp_f32 v175, v51
v_add_f32 v163, v172, v173
v_mfma_f32_32x32x16_bf16 v[80:95], a[200:203], a[168:171], v[80:95]
ds_read_b64_tr_b16 a[236:237], v27 offset:49152
v_exp_f32 v176, v52
v_cvt_pk_bf16_f32 v105, v174, v175
v_exp_f32 v177, v53
v_mfma_f32_32x32x16_bf16 v[64:79], a[204:207], a[140:143], v[64:79]
ds_read_b64_tr_b16 a[238:239], v27 offset:53248
ds_read_b64_tr_b16 a[240:241], v24 offset:57344
v_add_f32 v163, v163, v174
v_add_f32 v163, v163, v175
v_exp_f32 v178, v54
v_mfma_f32_32x32x16_bf16 v[80:95], a[204:207], a[172:175], v[80:95]
ds_read_b64_tr_b16 a[242:243], v24 offset:61440
v_cvt_pk_bf16_f32 v106, v176, v177
v_exp_f32 v179, v55
v_add_f32 v163, v163, v176
v_add_f32 v163, v163, v177
v_mfma_f32_32x32x16_bf16 v[64:79], a[208:211], a[144:147], v[64:79]
ds_read_b64_tr_b16 a[244:245], v25 offset:57344
v_exp_f32 v172, v56
ds_read_b64_tr_b16 a[246:247], v25 offset:61440
v_cvt_pk_bf16_f32 v107, v178, v179
v_mfma_f32_32x32x16_bf16 v[80:95], a[208:211], a[176:179], v[80:95]
v_exp_f32 v173, v57
ds_read_b64_tr_b16 a[248:249], v26 offset:57344
v_add_f32 v163, v163, v178
v_add_f32 v163, v163, v179
ds_read_b64_tr_b16 a[250:251], v26 offset:61440
v_mfma_f32_32x32x16_bf16 v[64:79], a[212:215], a[148:151], v[64:79]
v_exp_f32 v174, v58
v_cvt_pk_bf16_f32 v108, v172, v173
v_exp_f32 v175, v59
ds_read_b64_tr_b16 a[252:253], v27 offset:57344
v_mfma_f32_32x32x16_bf16 v[80:95], a[212:215], a[180:183], v[80:95]
ds_read_b64_tr_b16 a[254:255], v27 offset:61440
v_add_f32 v163, v163, v172
v_add_f32 v163, v163, v173
v_exp_f32 v176, v60
v_cvt_pk_bf16_f32 v109, v174, v175
v_mfma_f32_32x32x16_bf16 v[64:79], a[216:219], a[152:155], v[64:79]
v_exp_f32 v177, v61
v_add_f32 v163, v163, v174
v_add_f32 v163, v163, v175
v_exp_f32 v178, v62
v_mfma_f32_32x32x16_bf16 v[80:95], a[216:219], a[184:187], v[80:95]
v_cvt_pk_bf16_f32 v110, v176, v177
v_exp_f32 v179, v63
v_add_f32 v163, v163, v176
v_add_f32 v163, v163, v177
v_cvt_pk_bf16_f32 v111, v178, v179
v_mfma_f32_32x32x16_bf16 v[64:79], a[220:223], a[156:159], v[64:79]
v_add_f32 v163, v163, v178
v_add_f32 v163, v163, v179
v_max_f32 v188, v162, v163
v_cmp_nle_f32 vcc, v188, v180
v_mfma_f32_32x32x16_bf16 v[80:95], a[220:223], a[188:191], v[80:95]
s_cbranch_vccnz attn_kernel_tr_l0
attn_kernel_back_l0:
s_waitcnt lgkmcnt(0)
v_mfma_f32_32x32x16_bf16 a[0:15], a[224:227], v[96:99], a[0:15]
s_waitcnt vmcnt(12)
s_barrier
v_mfma_f32_32x32x16_bf16 a[16:31], a[224:227], v[104:107], a[16:31]
ds_read_b128 a[192:195], v210 offset:0
v_mfma_f32_32x32x16_bf16 a[32:47], a[228:231], v[96:99], a[32:47]
ds_read_b128 a[196:199], v211 offset:0
v_mfma_f32_32x32x16_bf16 a[48:63], a[228:231], v[104:107], a[48:63]
ds_read_b128 a[200:203], v212 offset:0
v_add_f32 v160, v160, v162
v_add_f32 v161, v161, v163
v_exp_f32 v172, v64
v_mfma_f32_32x32x16_bf16 a[64:79], a[232:235], v[96:99], a[64:79]
s_add_u32 m0, s35, 0
ds_read_b128 a[204:207], v213 offset:0
v_mfma_f32_32x32x16_bf16 a[80:95], a[232:235], v[104:107], a[80:95]
v_exp_f32 v173, v65
v_exp_f32 v174, v66
v_cvt_pk_bf16_f32 v112, v172, v173
v_mfma_f32_32x32x16_bf16 a[96:111], a[236:239], v[96:99], a[96:111]
ds_read_b128 a[208:211], v214 offset:0
v_exp_f32 v175, v67
v_add_f32 v162, v172, v173
v_exp_f32 v176, v68
v_mfma_f32_32x32x16_bf16 a[112:127], a[236:239], v[104:107], a[112:127]
ds_read_b128 a[212:215], v215 offset:0
v_cvt_pk_bf16_f32 v113, v174, v175
v_exp_f32 v177, v69
v_add_f32 v162, v162, v174
v_add_f32 v162, v162, v175
v_mfma_f32_32x32x16_bf16 a[0:15], a[240:243], v[100:103], a[0:15]
buffer_load_dwordx4 v182, s[8:11], s32 offen lds
ds_read_b128 a[216:219], v216 offset:0
v_mfma_f32_32x32x16_bf16 a[16:31], a[240:243], v[108:111], a[16:31]
v_exp_f32 v178, v70
v_cvt_pk_bf16_f32 v114, v176, v177
v_exp_f32 v179, v71
v_add_f32 v162, v162, v176
v_mfma_f32_32x32x16_bf16 a[32:47], a[244:247], v[100:103], a[32:47]
ds_read_b128 a[220:223], v217 offset:0
v_add_f32 v162, v162, v177
v_exp_f32 v172, v72
v_cvt_pk_bf16_f32 v115, v178, v179
v_mfma_f32_32x32x16_bf16 a[48:63], a[244:247], v[108:111], a[48:63]
v_exp_f32 v173, v73
buffer_load_dwordx4 v183, s[8:11], s32 offen offset:1024 lds
v_mfma_f32_32x32x16_bf16 a[64:79], a[248:251], v[100:103], a[64:79]
v_add_f32 v162, v162, v178
v_add_f32 v162, v162, v179
v_exp_f32 v174, v74
v_cvt_pk_bf16_f32 v116, v172, v173
v_mfma_f32_32x32x16_bf16 a[80:95], a[248:251], v[108:111], a[80:95]
v_exp_f32 v175, v75
v_add_f32 v162, v162, v172
v_add_f32 v162, v162, v173
v_exp_f32 v176, v76
v_mfma_f32_32x32x16_bf16 a[96:111], a[252:255], v[100:103], a[96:111]
v_cvt_pk_bf16_f32 v117, v174, v175
buffer_load_dwordx4 v184, s[12:15], s32 offen offset:2048 lds
v_mfma_f32_32x32x16_bf16 a[112:127], a[252:255], v[108:111], a[112:127]
v_exp_f32 v177, v77
v_add_f32 v162, v162, v174
v_add_f32 v162, v162, v175
v_exp_f32 v178, v78
s_waitcnt lgkmcnt(0)
v_mfma_f32_32x32x16_bf16 v[32:47], a[192:195], a[128:131], v[128:143]
ds_read_b64_tr_b16 a[224:225], v218 offset:0
v_cvt_pk_bf16_f32 v118, v176, v177
v_exp_f32 v179, v79
v_add_f32 v162, v162, v176
v_add_f32 v162, v162, v177
v_mfma_f32_32x32x16_bf16 v[48:63], a[192:195], a[160:163], v[144:159]
ds_read_b64_tr_b16 a[226:227], v218 offset:4096
v_exp_f32 v172, v80
v_cvt_pk_bf16_f32 v119, v178, v179
ds_read_b64_tr_b16 a[228:229], v219 offset:0
v_mfma_f32_32x32x16_bf16 v[32:47], a[196:199], a[132:135], v[32:47]
buffer_load_dwordx4 v184, s[12:15], s32 offen offset:3072 lds
v_exp_f32 v173, v81
v_mfma_f32_32x32x16_bf16 v[48:63], a[196:199], a[164:167], v[48:63]
ds_read_b64_tr_b16 a[230:231], v219 offset:4096
v_add_f32 v162, v162, v178
ds_read_b64_tr_b16 a[232:233], v220 offset:0
v_add_f32 v162, v162, v179
v_exp_f32 v174, v82
v_mfma_f32_32x32x16_bf16 v[32:47], a[200:203], a[136:139], v[32:47]
s_add_u32 s32, s32, 8192
ds_read_b64_tr_b16 a[234:235], v220 offset:4096
v_cvt_pk_bf16_f32 v120, v172, v173
v_exp_f32 v175, v83
v_add_f32 v163, v172, v173
v_mfma_f32_32x32x16_bf16 v[48:63], a[200:203], a[168:171], v[48:63]
ds_read_b64_tr_b16 a[236:237], v221 offset:0
v_exp_f32 v176, v84
v_cvt_pk_bf16_f32 v121, v174, v175
v_exp_f32 v177, v85
v_mfma_f32_32x32x16_bf16 v[32:47], a[204:207], a[140:143], v[32:47]
ds_read_b64_tr_b16 a[238:239], v221 offset:4096
ds_read_b64_tr_b16 a[240:241], v218 offset:8192
v_add_f32 v163, v163, v174
v_add_f32 v163, v163, v175
v_exp_f32 v178, v86
v_mfma_f32_32x32x16_bf16 v[48:63], a[204:207], a[172:175], v[48:63]
ds_read_b64_tr_b16 a[242:243], v218 offset:12288
v_cvt_pk_bf16_f32 v122, v176, v177
v_exp_f32 v179, v87
v_add_f32 v163, v163, v176
v_add_f32 v163, v163, v177
v_mfma_f32_32x32x16_bf16 v[32:47], a[208:211], a[144:147], v[32:47]
ds_read_b64_tr_b16 a[244:245], v219 offset:8192
v_exp_f32 v172, v88
ds_read_b64_tr_b16 a[246:247], v219 offset:12288
v_cvt_pk_bf16_f32 v123, v178, v179
v_mfma_f32_32x32x16_bf16 v[48:63], a[208:211], a[176:179], v[48:63]
v_exp_f32 v173, v89
ds_read_b64_tr_b16 a[248:249], v220 offset:8192
v_add_f32 v163, v163, v178
v_add_f32 v163, v163, v179
ds_read_b64_tr_b16 a[250:251], v220 offset:12288
v_mfma_f32_32x32x16_bf16 v[32:47], a[212:215], a[148:151], v[32:47]
v_exp_f32 v174, v90
v_cvt_pk_bf16_f32 v124, v172, v173
v_exp_f32 v175, v91
ds_read_b64_tr_b16 a[252:253], v221 offset:8192
v_mfma_f32_32x32x16_bf16 v[48:63], a[212:215], a[180:183], v[48:63]
ds_read_b64_tr_b16 a[254:255], v221 offset:12288
v_add_f32 v163, v163, v172
v_add_f32 v163, v163, v173
v_exp_f32 v176, v92
v_cvt_pk_bf16_f32 v125, v174, v175
v_mfma_f32_32x32x16_bf16 v[32:47], a[216:219], a[152:155], v[32:47]
v_exp_f32 v177, v93
v_add_f32 v163, v163, v174
v_add_f32 v163, v163, v175
v_exp_f32 v178, v94
v_mfma_f32_32x32x16_bf16 v[48:63], a[216:219], a[184:187], v[48:63]
v_cvt_pk_bf16_f32 v126, v176, v177
v_exp_f32 v179, v95
v_add_f32 v163, v163, v176
v_add_f32 v163, v163, v177
v_cvt_pk_bf16_f32 v127, v178, v179
v_mfma_f32_32x32x16_bf16 v[32:47], a[220:223], a[156:159], v[32:47]
v_add_f32 v163, v163, v178
v_add_f32 v163, v163, v179
v_max_f32 v188, v162, v163
v_cmp_nle_f32 vcc, v188, v180
v_mfma_f32_32x32x16_bf16 v[48:63], a[220:223], a[188:191], v[48:63]
s_cbranch_vccnz attn_kernel_tr_l1
attn_kernel_back_l1:
s_waitcnt lgkmcnt(0)
v_mfma_f32_32x32x16_bf16 a[0:15], a[224:227], v[112:115], a[0:15]
s_waitcnt vmcnt(12)
s_barrier
v_mfma_f32_32x32x16_bf16 a[16:31], a[224:227], v[120:123], a[16:31]
ds_read_b128 a[192:195], v210 offset:16384
v_mfma_f32_32x32x16_bf16 a[32:47], a[228:231], v[112:115], a[32:47]
ds_read_b128 a[196:199], v211 offset:16384
v_mfma_f32_32x32x16_bf16 a[48:63], a[228:231], v[120:123], a[48:63]
ds_read_b128 a[200:203], v212 offset:16384
v_add_f32 v160, v160, v162
v_add_f32 v161, v161, v163
v_exp_f32 v172, v32
v_mfma_f32_32x32x16_bf16 a[64:79], a[232:235], v[112:115], a[64:79]
s_add_u32 m0, s35, 16384
ds_read_b128 a[204:207], v213 offset:16384
v_mfma_f32_32x32x16_bf16 a[80:95], a[232:235], v[120:123], a[80:95]
v_exp_f32 v173, v33
v_exp_f32 v174, v34
v_cvt_pk_bf16_f32 v96, v172, v173
v_mfma_f32_32x32x16_bf16 a[96:111], a[236:239], v[112:115], a[96:111]
ds_read_b128 a[208:211], v214 offset:16384
v_exp_f32 v175, v35
v_add_f32 v162, v172, v173
v_exp_f32 v176, v36
v_mfma_f32_32x32x16_bf16 a[112:127], a[236:239], v[120:123], a[112:127]
ds_read_b128 a[212:215], v215 offset:16384
v_cvt_pk_bf16_f32 v97, v174, v175
v_exp_f32 v177, v37
v_add_f32 v162, v162, v174
v_add_f32 v162, v162, v175
v_mfma_f32_32x32x16_bf16 a[0:15], a[240:243], v[116:119], a[0:15]
buffer_load_dwordx4 v182, s[8:11], s32 offen lds
ds_read_b128 a[216:219], v216 offset:16384
v_mfma_f32_32x32x16_bf16 a[16:31], a[240:243], v[124:127], a[16:31]
v_exp_f32 v178, v38
v_cvt_pk_bf16_f32 v98, v176, v177
v_exp_f32 v179, v39
v_add_f32 v162, v162, v176
v_mfma_f32_32x32x16_bf16 a[32:47], a[244:247], v[116:119], a[32:47]
ds_read_b128 a[220:223], v217 offset:16384
v_add_f32 v162, v162, v177
v_exp_f32 v172, v40
v_cvt_pk_bf16_f32 v99, v178, v179
v_mfma_f32_32x32x16_bf16 a[48:63], a[244:247], v[124:127], a[48:63]
v_exp_f32 v173, v41
buffer_load_dwordx4 v183, s[8:11], s32 offen offset:1024 lds
v_mfma_f32_32x32x16_bf16 a[64:79], a[248:251], v[116:119], a[64:79]
v_add_f32 v162, v162, v178
v_add_f32 v162, v162, v179
v_exp_f32 v174, v42
v_cvt_pk_bf16_f32 v100, v172, v173
v_mfma_f32_32x32x16_bf16 a[80:95], a[248:251], v[124:127], a[80:95]
v_exp_f32 v175, v43
v_add_f32 v162, v162, v172
v_add_f32 v162, v162, v173
v_exp_f32 v176, v44
v_mfma_f32_32x32x16_bf16 a[96:111], a[252:255], v[116:119], a[96:111]
v_cvt_pk_bf16_f32 v101, v174, v175
buffer_load_dwordx4 v184, s[12:15], s32 offen offset:2048 lds
v_mfma_f32_32x32x16_bf16 a[112:127], a[252:255], v[124:127], a[112:127]
v_exp_f32 v177, v45
v_add_f32 v162, v162, v174
v_add_f32 v162, v162, v175
v_exp_f32 v178, v46
s_waitcnt lgkmcnt(0)
v_mfma_f32_32x32x16_bf16 v[64:79], a[192:195], a[128:131], v[128:143]
ds_read_b64_tr_b16 a[224:225], v218 offset:16384
v_cvt_pk_bf16_f32 v102, v176, v177
v_exp_f32 v179, v47
v_add_f32 v162, v162, v176
v_add_f32 v162, v162, v177
v_mfma_f32_32x32x16_bf16 v[80:95], a[192:195], a[160:163], v[144:159]
ds_read_b64_tr_b16 a[226:227], v218 offset:20480
v_exp_f32 v172, v48
v_cvt_pk_bf16_f32 v103, v178, v179
ds_read_b64_tr_b16 a[228:229], v219 offset:16384
v_mfma_f32_32x32x16_bf16 v[64:79], a[196:199], a[132:135], v[64:79]
buffer_load_dwordx4 v184, s[12:15], s32 offen offset:3072 lds
v_exp_f32 v173, v49
v_mfma_f32_32x32x16_bf16 v[80:95], a[196:199], a[164:167], v[80:95]
ds_read_b64_tr_b16 a[230:231], v219 offset:20480
v_add_f32 v162, v162, v178
ds_read_b64_tr_b16 a[232:233], v220 offset:16384
v_add_f32 v162, v162, v179
v_exp_f32 v174, v50
v_mfma_f32_32x32x16_bf16 v[64:79], a[200:203], a[136:139], v[64:79]
s_add_u32 s32, s32, 8192
ds_read_b64_tr_b16 a[234:235], v220 offset:20480
v_cvt_pk_bf16_f32 v104, v172, v173
v_exp_f32 v175, v51
v_add_f32 v163, v172, v173
v_mfma_f32_32x32x16_bf16 v[80:95], a[200:203], a[168:171], v[80:95]
ds_read_b64_tr_b16 a[236:237], v221 offset:16384
v_exp_f32 v176, v52
v_cvt_pk_bf16_f32 v105, v174, v175
v_exp_f32 v177, v53
v_mfma_f32_32x32x16_bf16 v[64:79], a[204:207], a[140:143], v[64:79]
ds_read_b64_tr_b16 a[238:239], v221 offset:20480
ds_read_b64_tr_b16 a[240:241], v218 offset:24576
v_add_f32 v163, v163, v174
v_add_f32 v163, v163, v175
v_exp_f32 v178, v54
v_mfma_f32_32x32x16_bf16 v[80:95], a[204:207], a[172:175], v[80:95]
ds_read_b64_tr_b16 a[242:243], v218 offset:28672
v_cvt_pk_bf16_f32 v106, v176, v177
v_exp_f32 v179, v55
v_add_f32 v163, v163, v176
v_add_f32 v163, v163, v177
v_mfma_f32_32x32x16_bf16 v[64:79], a[208:211], a[144:147], v[64:79]
ds_read_b64_tr_b16 a[244:245], v219 offset:24576
v_exp_f32 v172, v56
ds_read_b64_tr_b16 a[246:247], v219 offset:28672
v_cvt_pk_bf16_f32 v107, v178, v179
v_mfma_f32_32x32x16_bf16 v[80:95], a[208:211], a[176:179], v[80:95]
v_exp_f32 v173, v57
ds_read_b64_tr_b16 a[248:249], v220 offset:24576
v_add_f32 v163, v163, v178
v_add_f32 v163, v163, v179
ds_read_b64_tr_b16 a[250:251], v220 offset:28672
v_mfma_f32_32x32x16_bf16 v[64:79], a[212:215], a[148:151], v[64:79]
v_exp_f32 v174, v58
v_cvt_pk_bf16_f32 v108, v172, v173
v_exp_f32 v175, v59
ds_read_b64_tr_b16 a[252:253], v221 offset:24576
v_mfma_f32_32x32x16_bf16 v[80:95], a[212:215], a[180:183], v[80:95]
ds_read_b64_tr_b16 a[254:255], v221 offset:28672
v_add_f32 v163, v163, v172
v_add_f32 v163, v163, v173
v_exp_f32 v176, v60
v_cvt_pk_bf16_f32 v109, v174, v175
v_mfma_f32_32x32x16_bf16 v[64:79], a[216:219], a[152:155], v[64:79]
v_exp_f32 v177, v61
v_add_f32 v163, v163, v174
v_add_f32 v163, v163, v175
v_exp_f32 v178, v62
v_mfma_f32_32x32x16_bf16 v[80:95], a[216:219], a[184:187], v[80:95]
v_cvt_pk_bf16_f32 v110, v176, v177
v_exp_f32 v179, v63
v_add_f32 v163, v163, v176
v_add_f32 v163, v163, v177
v_cvt_pk_bf16_f32 v111, v178, v179
v_mfma_f32_32x32x16_bf16 v[64:79], a[220:223], a[156:159], v[64:79]
v_add_f32 v163, v163, v178
v_add_f32 v163, v163, v179
v_max_f32 v188, v162, v163
v_cmp_nle_f32 vcc, v188, v180
v_mfma_f32_32x32x16_bf16 v[80:95], a[220:223], a[188:191], v[80:95]
s_cbranch_vccnz attn_kernel_tr_l2
attn_kernel_back_l2:
s_waitcnt lgkmcnt(0)
v_mfma_f32_32x32x16_bf16 a[0:15], a[224:227], v[96:99], a[0:15]
s_waitcnt vmcnt(12)
s_barrier
v_mfma_f32_32x32x16_bf16 a[16:31], a[224:227], v[104:107], a[16:31]
ds_read_b128 a[192:195], v210 offset:32768
v_mfma_f32_32x32x16_bf16 a[32:47], a[228:231], v[96:99], a[32:47]
ds_read_b128 a[196:199], v211 offset:32768
v_mfma_f32_32x32x16_bf16 a[48:63], a[228:231], v[104:107], a[48:63]
ds_read_b128 a[200:203], v212 offset:32768
v_add_f32 v160, v160, v162
v_add_f32 v161, v161, v163
v_exp_f32 v172, v64
v_mfma_f32_32x32x16_bf16 a[64:79], a[232:235], v[96:99], a[64:79]
s_add_u32 m0, s35, 32768
ds_read_b128 a[204:207], v213 offset:32768
v_mfma_f32_32x32x16_bf16 a[80:95], a[232:235], v[104:107], a[80:95]
v_exp_f32 v173, v65
v_exp_f32 v174, v66
v_cvt_pk_bf16_f32 v112, v172, v173
v_mfma_f32_32x32x16_bf16 a[96:111], a[236:239], v[96:99], a[96:111]
ds_read_b128 a[208:211], v214 offset:32768
v_exp_f32 v175, v67
v_add_f32 v162, v172, v173
v_exp_f32 v176, v68
v_mfma_f32_32x32x16_bf16 a[112:127], a[236:239], v[104:107], a[112:127]
ds_read_b128 a[212:215], v215 offset:32768
v_cvt_pk_bf16_f32 v113, v174, v175
v_exp_f32 v177, v69
v_add_f32 v162, v162, v174
v_add_f32 v162, v162, v175
v_mfma_f32_32x32x16_bf16 a[0:15], a[240:243], v[100:103], a[0:15]
buffer_load_dwordx4 v182, s[8:11], s32 offen lds
ds_read_b128 a[216:219], v216 offset:32768
v_mfma_f32_32x32x16_bf16 a[16:31], a[240:243], v[108:111], a[16:31]
v_exp_f32 v178, v70
v_cvt_pk_bf16_f32 v114, v176, v177
v_exp_f32 v179, v71
v_add_f32 v162, v162, v176
v_mfma_f32_32x32x16_bf16 a[32:47], a[244:247], v[100:103], a[32:47]
ds_read_b128 a[220:223], v217 offset:32768
v_add_f32 v162, v162, v177
v_exp_f32 v172, v72
v_cvt_pk_bf16_f32 v115, v178, v179
v_mfma_f32_32x32x16_bf16 a[48:63], a[244:247], v[108:111], a[48:63]
v_exp_f32 v173, v73
buffer_load_dwordx4 v183, s[8:11], s32 offen offset:1024 lds
v_mfma_f32_32x32x16_bf16 a[64:79], a[248:251], v[100:103], a[64:79]
v_add_f32 v162, v162, v178
v_add_f32 v162, v162, v179
v_exp_f32 v174, v74
v_cvt_pk_bf16_f32 v116, v172, v173
v_mfma_f32_32x32x16_bf16 a[80:95], a[248:251], v[108:111], a[80:95]
v_exp_f32 v175, v75
v_add_f32 v162, v162, v172
v_add_f32 v162, v162, v173
v_exp_f32 v176, v76
v_mfma_f32_32x32x16_bf16 a[96:111], a[252:255], v[100:103], a[96:111]
v_cvt_pk_bf16_f32 v117, v174, v175
buffer_load_dwordx4 v184, s[12:15], s32 offen offset:2048 lds
v_mfma_f32_32x32x16_bf16 a[112:127], a[252:255], v[108:111], a[112:127]
v_exp_f32 v177, v77
v_add_f32 v162, v162, v174
v_add_f32 v162, v162, v175
v_exp_f32 v178, v78
s_waitcnt lgkmcnt(0)
v_mfma_f32_32x32x16_bf16 v[32:47], a[192:195], a[128:131], v[128:143]
ds_read_b64_tr_b16 a[224:225], v218 offset:32768
v_cvt_pk_bf16_f32 v118, v176, v177
v_exp_f32 v179, v79
v_add_f32 v162, v162, v176
v_add_f32 v162, v162, v177
v_mfma_f32_32x32x16_bf16 v[48:63], a[192:195], a[160:163], v[144:159]
ds_read_b64_tr_b16 a[226:227], v218 offset:36864
v_exp_f32 v172, v80
v_cvt_pk_bf16_f32 v119, v178, v179
ds_read_b64_tr_b16 a[228:229], v219 offset:32768
v_mfma_f32_32x32x16_bf16 v[32:47], a[196:199], a[132:135], v[32:47]
buffer_load_dwordx4 v184, s[12:15], s32 offen offset:3072 lds
v_exp_f32 v173, v81
v_mfma_f32_32x32x16_bf16 v[48:63], a[196:199], a[164:167], v[48:63]
ds_read_b64_tr_b16 a[230:231], v219 offset:36864
v_add_f32 v162, v162, v178
ds_read_b64_tr_b16 a[232:233], v220 offset:32768
v_add_f32 v162, v162, v179
v_exp_f32 v174, v82
v_mfma_f32_32x32x16_bf16 v[32:47], a[200:203], a[136:139], v[32:47]
s_add_u32 s32, s32, 8192
ds_read_b64_tr_b16 a[234:235], v220 offset:36864
v_cvt_pk_bf16_f32 v120, v172, v173
v_exp_f32 v175, v83
v_add_f32 v163, v172, v173
v_mfma_f32_32x32x16_bf16 v[48:63], a[200:203], a[168:171], v[48:63]
ds_read_b64_tr_b16 a[236:237], v221 offset:32768
v_exp_f32 v176, v84
v_cvt_pk_bf16_f32 v121, v174, v175
v_exp_f32 v177, v85
v_mfma_f32_32x32x16_bf16 v[32:47], a[204:207], a[140:143], v[32:47]
ds_read_b64_tr_b16 a[238:239], v221 offset:36864
ds_read_b64_tr_b16 a[240:241], v218 offset:40960
v_add_f32 v163, v163, v174
v_add_f32 v163, v163, v175
v_exp_f32 v178, v86
v_mfma_f32_32x32x16_bf16 v[48:63], a[204:207], a[172:175], v[48:63]
ds_read_b64_tr_b16 a[242:243], v218 offset:45056
v_cvt_pk_bf16_f32 v122, v176, v177
v_exp_f32 v179, v87
v_add_f32 v163, v163, v176
v_add_f32 v163, v163, v177
v_mfma_f32_32x32x16_bf16 v[32:47], a[208:211], a[144:147], v[32:47]
ds_read_b64_tr_b16 a[244:245], v219 offset:40960
v_exp_f32 v172, v88
ds_read_b64_tr_b16 a[246:247], v219 offset:45056
v_cvt_pk_bf16_f32 v123, v178, v179
v_mfma_f32_32x32x16_bf16 v[48:63], a[208:211], a[176:179], v[48:63]
v_exp_f32 v173, v89
ds_read_b64_tr_b16 a[248:249], v220 offset:40960
v_add_f32 v163, v163, v178
v_add_f32 v163, v163, v179
ds_read_b64_tr_b16 a[250:251], v220 offset:45056
v_mfma_f32_32x32x16_bf16 v[32:47], a[212:215], a[148:151], v[32:47]
v_exp_f32 v174, v90
v_cvt_pk_bf16_f32 v124, v172, v173
v_exp_f32 v175, v91
ds_read_b64_tr_b16 a[252:253], v221 offset:40960
v_mfma_f32_32x32x16_bf16 v[48:63], a[212:215], a[180:183], v[48:63]
ds_read_b64_tr_b16 a[254:255], v221 offset:45056
v_add_f32 v163, v163, v172
v_add_f32 v163, v163, v173
v_exp_f32 v176, v92
v_cvt_pk_bf16_f32 v125, v174, v175
v_mfma_f32_32x32x16_bf16 v[32:47], a[216:219], a[152:155], v[32:47]
v_exp_f32 v177, v93
v_add_f32 v163, v163, v174
v_add_f32 v163, v163, v175
v_exp_f32 v178, v94
v_mfma_f32_32x32x16_bf16 v[48:63], a[216:219], a[184:187], v[48:63]
v_cvt_pk_bf16_f32 v126, v176, v177
v_exp_f32 v179, v95
v_add_f32 v163, v163, v176
v_add_f32 v163, v163, v177
v_cvt_pk_bf16_f32 v127, v178, v179
v_mfma_f32_32x32x16_bf16 v[32:47], a[220:223], a[156:159], v[32:47]
v_add_f32 v163, v163, v178
v_add_f32 v163, v163, v179
v_max_f32 v188, v162, v163
v_cmp_nle_f32 vcc, v188, v180
v_mfma_f32_32x32x16_bf16 v[48:63], a[220:223], a[188:191], v[48:63]
s_cbranch_vccnz attn_kernel_tr_l3
attn_kernel_back_l3:
s_waitcnt lgkmcnt(0)
v_mfma_f32_32x32x16_bf16 a[0:15], a[224:227], v[112:115], a[0:15]
s_waitcnt vmcnt(12)
s_barrier
v_mfma_f32_32x32x16_bf16 a[16:31], a[224:227], v[120:123], a[16:31]
ds_read_b128 a[192:195], v210 offset:49152
v_mfma_f32_32x32x16_bf16 a[32:47], a[228:231], v[112:115], a[32:47]
ds_read_b128 a[196:199], v211 offset:49152
v_mfma_f32_32x32x16_bf16 a[48:63], a[228:231], v[120:123], a[48:63]
ds_read_b128 a[200:203], v212 offset:49152
v_add_f32 v160, v160, v162
v_add_f32 v161, v161, v163
v_exp_f32 v172, v32
v_mfma_f32_32x32x16_bf16 a[64:79], a[232:235], v[112:115], a[64:79]
s_add_u32 m0, s35, 49152
ds_read_b128 a[204:207], v213 offset:49152
v_mfma_f32_32x32x16_bf16 a[80:95], a[232:235], v[120:123], a[80:95]
v_exp_f32 v173, v33
v_exp_f32 v174, v34
v_cvt_pk_bf16_f32 v96, v172, v173
v_mfma_f32_32x32x16_bf16 a[96:111], a[236:239], v[112:115], a[96:111]
ds_read_b128 a[208:211], v214 offset:49152
v_exp_f32 v175, v35
v_add_f32 v162, v172, v173
v_exp_f32 v176, v36
v_mfma_f32_32x32x16_bf16 a[112:127], a[236:239], v[120:123], a[112:127]
ds_read_b128 a[212:215], v215 offset:49152
v_cvt_pk_bf16_f32 v97, v174, v175
v_exp_f32 v177, v37
v_add_f32 v162, v162, v174
v_add_f32 v162, v162, v175
v_mfma_f32_32x32x16_bf16 a[0:15], a[240:243], v[116:119], a[0:15]
buffer_load_dwordx4 v182, s[8:11], s32 offen lds
ds_read_b128 a[216:219], v216 offset:49152
v_mfma_f32_32x32x16_bf16 a[16:31], a[240:243], v[124:127], a[16:31]
v_exp_f32 v178, v38
v_cvt_pk_bf16_f32 v98, v176, v177
v_exp_f32 v179, v39
v_add_f32 v162, v162, v176
v_mfma_f32_32x32x16_bf16 a[32:47], a[244:247], v[116:119], a[32:47]
ds_read_b128 a[220:223], v217 offset:49152
v_add_f32 v162, v162, v177
v_exp_f32 v172, v40
v_cvt_pk_bf16_f32 v99, v178, v179
v_mfma_f32_32x32x16_bf16 a[48:63], a[244:247], v[124:127], a[48:63]
v_exp_f32 v173, v41
buffer_load_dwordx4 v183, s[8:11], s32 offen offset:1024 lds
v_mfma_f32_32x32x16_bf16 a[64:79], a[248:251], v[116:119], a[64:79]
v_add_f32 v162, v162, v178
v_add_f32 v162, v162, v179
v_exp_f32 v174, v42
v_cvt_pk_bf16_f32 v100, v172, v173
v_mfma_f32_32x32x16_bf16 a[80:95], a[248:251], v[124:127], a[80:95]
v_exp_f32 v175, v43
v_add_f32 v162, v162, v172
v_add_f32 v162, v162, v173
v_exp_f32 v176, v44
v_mfma_f32_32x32x16_bf16 a[96:111], a[252:255], v[116:119], a[96:111]
v_cvt_pk_bf16_f32 v101, v174, v175
buffer_load_dwordx4 v184, s[12:15], s32 offen offset:2048 lds
v_mfma_f32_32x32x16_bf16 a[112:127], a[252:255], v[124:127], a[112:127]
v_exp_f32 v177, v45
v_add_f32 v162, v162, v174
v_add_f32 v162, v162, v175
v_exp_f32 v178, v46
s_waitcnt lgkmcnt(0)
v_mfma_f32_32x32x16_bf16 v[64:79], a[192:195], a[128:131], v[128:143]
ds_read_b64_tr_b16 a[224:225], v218 offset:49152
v_cvt_pk_bf16_f32 v102, v176, v177
v_exp_f32 v179, v47
v_add_f32 v162, v162, v176
v_add_f32 v162, v162, v177
v_mfma_f32_32x32x16_bf16 v[80:95], a[192:195], a[160:163], v[144:159]
ds_read_b64_tr_b16 a[226:227], v218 offset:53248
v_exp_f32 v172, v48
v_cvt_pk_bf16_f32 v103, v178, v179
ds_read_b64_tr_b16 a[228:229], v219 offset:49152
v_mfma_f32_32x32x16_bf16 v[64:79], a[196:199], a[132:135], v[64:79]
buffer_load_dwordx4 v184, s[12:15], s32 offen offset:3072 lds
v_exp_f32 v173, v49
v_mfma_f32_32x32x16_bf16 v[80:95], a[196:199], a[164:167], v[80:95]
ds_read_b64_tr_b16 a[230:231], v219 offset:53248
v_add_f32 v162, v162, v178
ds_read_b64_tr_b16 a[232:233], v220 offset:49152
v_add_f32 v162, v162, v179
v_exp_f32 v174, v50
v_mfma_f32_32x32x16_bf16 v[64:79], a[200:203], a[136:139], v[64:79]
s_add_u32 s32, s32, 8192
ds_read_b64_tr_b16 a[234:235], v220 offset:53248
v_cvt_pk_bf16_f32 v104, v172, v173
v_exp_f32 v175, v51
v_add_f32 v163, v172, v173
v_mfma_f32_32x32x16_bf16 v[80:95], a[200:203], a[168:171], v[80:95]
ds_read_b64_tr_b16 a[236:237], v221 offset:49152
v_exp_f32 v176, v52
v_cvt_pk_bf16_f32 v105, v174, v175
v_exp_f32 v177, v53
v_mfma_f32_32x32x16_bf16 v[64:79], a[204:207], a[140:143], v[64:79]
ds_read_b64_tr_b16 a[238:239], v221 offset:53248
ds_read_b64_tr_b16 a[240:241], v218 offset:57344
v_add_f32 v163, v163, v174
v_add_f32 v163, v163, v175
v_exp_f32 v178, v54
v_mfma_f32_32x32x16_bf16 v[80:95], a[204:207], a[172:175], v[80:95]
ds_read_b64_tr_b16 a[242:243], v218 offset:61440
v_cvt_pk_bf16_f32 v106, v176, v177
v_exp_f32 v179, v55
v_add_f32 v163, v163, v176
v_add_f32 v163, v163, v177
v_mfma_f32_32x32x16_bf16 v[64:79], a[208:211], a[144:147], v[64:79]
ds_read_b64_tr_b16 a[244:245], v219 offset:57344
v_exp_f32 v172, v56
ds_read_b64_tr_b16 a[246:247], v219 offset:61440
v_cvt_pk_bf16_f32 v107, v178, v179
v_mfma_f32_32x32x16_bf16 v[80:95], a[208:211], a[176:179], v[80:95]
v_exp_f32 v173, v57
ds_read_b64_tr_b16 a[248:249], v220 offset:57344
v_add_f32 v163, v163, v178
v_add_f32 v163, v163, v179
ds_read_b64_tr_b16 a[250:251], v220 offset:61440
v_mfma_f32_32x32x16_bf16 v[64:79], a[212:215], a[148:151], v[64:79]
v_exp_f32 v174, v58
v_cvt_pk_bf16_f32 v108, v172, v173
v_exp_f32 v175, v59
ds_read_b64_tr_b16 a[252:253], v221 offset:57344
v_mfma_f32_32x32x16_bf16 v[80:95], a[212:215], a[180:183], v[80:95]
ds_read_b64_tr_b16 a[254:255], v221 offset:61440
v_add_f32 v163, v163, v172
v_add_f32 v163, v163, v173
v_exp_f32 v176, v60
v_cvt_pk_bf16_f32 v109, v174, v175
v_mfma_f32_32x32x16_bf16 v[64:79], a[216:219], a[152:155], v[64:79]
v_exp_f32 v177, v61
v_add_f32 v163, v163, v174
v_add_f32 v163, v163, v175
v_exp_f32 v178, v62
v_mfma_f32_32x32x16_bf16 v[80:95], a[216:219], a[184:187], v[80:95]
v_cvt_pk_bf16_f32 v110, v176, v177
v_exp_f32 v179, v63
v_add_f32 v163, v163, v176
v_add_f32 v163, v163, v177
v_cvt_pk_bf16_f32 v111, v178, v179
v_mfma_f32_32x32x16_bf16 v[64:79], a[220:223], a[156:159], v[64:79]
v_add_f32 v163, v163, v178
v_add_f32 v163, v163, v179
v_max_f32 v188, v162, v163
v_cmp_nle_f32 vcc, v188, v180
v_mfma_f32_32x32x16_bf16 v[80:95], a[220:223], a[188:191], v[80:95]
s_cbranch_vccnz attn_kernel_tr_l4
attn_kernel_back_l4:
s_waitcnt lgkmcnt(0)
v_mfma_f32_32x32x16_bf16 a[0:15], a[224:227], v[96:99], a[0:15]
s_waitcnt vmcnt(12)
s_barrier
v_mfma_f32_32x32x16_bf16 a[16:31], a[224:227], v[104:107], a[16:31]
ds_read_b128 a[192:195], v16 offset:0
v_mfma_f32_32x32x16_bf16 a[32:47], a[228:231], v[96:99], a[32:47]
ds_read_b128 a[196:199], v17 offset:0
v_mfma_f32_32x32x16_bf16 a[48:63], a[228:231], v[104:107], a[48:63]
ds_read_b128 a[200:203], v18 offset:0
v_add_f32 v160, v160, v162
v_add_f32 v161, v161, v163
v_exp_f32 v172, v64
v_mfma_f32_32x32x16_bf16 a[64:79], a[232:235], v[96:99], a[64:79]
s_add_u32 m0, s35, 65536
ds_read_b128 a[204:207], v19 offset:0
v_mfma_f32_32x32x16_bf16 a[80:95], a[232:235], v[104:107], a[80:95]
v_exp_f32 v173, v65
v_exp_f32 v174, v66
v_cvt_pk_bf16_f32 v112, v172, v173
v_mfma_f32_32x32x16_bf16 a[96:111], a[236:239], v[96:99], a[96:111]
ds_read_b128 a[208:211], v20 offset:0
v_exp_f32 v175, v67
v_add_f32 v162, v172, v173
v_exp_f32 v176, v68
v_mfma_f32_32x32x16_bf16 a[112:127], a[236:239], v[104:107], a[112:127]
ds_read_b128 a[212:215], v21 offset:0
v_cvt_pk_bf16_f32 v113, v174, v175
v_exp_f32 v177, v69
v_add_f32 v162, v162, v174
v_add_f32 v162, v162, v175
v_mfma_f32_32x32x16_bf16 a[0:15], a[240:243], v[100:103], a[0:15]
buffer_load_dwordx4 v182, s[8:11], s32 offen lds
ds_read_b128 a[216:219], v22 offset:0
v_mfma_f32_32x32x16_bf16 a[16:31], a[240:243], v[108:111], a[16:31]
v_exp_f32 v178, v70
v_cvt_pk_bf16_f32 v114, v176, v177
v_exp_f32 v179, v71
v_add_f32 v162, v162, v176
v_mfma_f32_32x32x16_bf16 a[32:47], a[244:247], v[100:103], a[32:47]
ds_read_b128 a[220:223], v23 offset:0
v_add_f32 v162, v162, v177
v_exp_f32 v172, v72
v_cvt_pk_bf16_f32 v115, v178, v179
v_mfma_f32_32x32x16_bf16 a[48:63], a[244:247], v[108:111], a[48:63]
v_exp_f32 v173, v73
buffer_load_dwordx4 v183, s[8:11], s32 offen offset:1024 lds
v_mfma_f32_32x32x16_bf16 a[64:79], a[248:251], v[100:103], a[64:79]
v_add_f32 v162, v162, v178
v_add_f32 v162, v162, v179
v_exp_f32 v174, v74
v_cvt_pk_bf16_f32 v116, v172, v173
v_mfma_f32_32x32x16_bf16 a[80:95], a[248:251], v[108:111], a[80:95]
v_exp_f32 v175, v75
v_add_f32 v162, v162, v172
v_add_f32 v162, v162, v173
v_exp_f32 v176, v76
v_mfma_f32_32x32x16_bf16 a[96:111], a[252:255], v[100:103], a[96:111]
v_cvt_pk_bf16_f32 v117, v174, v175
buffer_load_dwordx4 v184, s[12:15], s32 offen offset:2048 lds
v_mfma_f32_32x32x16_bf16 a[112:127], a[252:255], v[108:111], a[112:127]
v_exp_f32 v177, v77
v_add_f32 v162, v162, v174
v_add_f32 v162, v162, v175
v_exp_f32 v178, v78
s_waitcnt lgkmcnt(0)
v_mfma_f32_32x32x16_bf16 v[32:47], a[192:195], a[128:131], v[128:143]
ds_read_b64_tr_b16 a[224:225], v24 offset:0
v_cvt_pk_bf16_f32 v118, v176, v177
v_exp_f32 v179, v79
v_add_f32 v162, v162, v176
v_add_f32 v162, v162, v177
v_mfma_f32_32x32x16_bf16 v[48:63], a[192:195], a[160:163], v[144:159]
ds_read_b64_tr_b16 a[226:227], v24 offset:4096
v_exp_f32 v172, v80
v_cvt_pk_bf16_f32 v119, v178, v179
ds_read_b64_tr_b16 a[228:229], v25 offset:0
v_mfma_f32_32x32x16_bf16 v[32:47], a[196:199], a[132:135], v[32:47]
buffer_load_dwordx4 v184, s[12:15], s32 offen offset:3072 lds
v_exp_f32 v173, v81
v_mfma_f32_32x32x16_bf16 v[48:63], a[196:199], a[164:167], v[48:63]
ds_read_b64_tr_b16 a[230:231], v25 offset:4096
v_add_f32 v162, v162, v178
ds_read_b64_tr_b16 a[232:233], v26 offset:0
v_add_f32 v162, v162, v179
v_exp_f32 v174, v82
v_mfma_f32_32x32x16_bf16 v[32:47], a[200:203], a[136:139], v[32:47]
s_add_u32 s32, s32, 8192
ds_read_b64_tr_b16 a[234:235], v26 offset:4096
v_cvt_pk_bf16_f32 v120, v172, v173
v_exp_f32 v175, v83
v_add_f32 v163, v172, v173
v_mfma_f32_32x32x16_bf16 v[48:63], a[200:203], a[168:171], v[48:63]
ds_read_b64_tr_b16 a[236:237], v27 offset:0
v_exp_f32 v176, v84
v_cvt_pk_bf16_f32 v121, v174, v175
v_exp_f32 v177, v85
v_mfma_f32_32x32x16_bf16 v[32:47], a[204:207], a[140:143], v[32:47]
ds_read_b64_tr_b16 a[238:239], v27 offset:4096
ds_read_b64_tr_b16 a[240:241], v24 offset:8192
v_add_f32 v163, v163, v174
v_add_f32 v163, v163, v175
v_exp_f32 v178, v86
v_mfma_f32_32x32x16_bf16 v[48:63], a[204:207], a[172:175], v[48:63]
ds_read_b64_tr_b16 a[242:243], v24 offset:12288
v_cvt_pk_bf16_f32 v122, v176, v177
v_exp_f32 v179, v87
v_add_f32 v163, v163, v176
v_add_f32 v163, v163, v177
v_mfma_f32_32x32x16_bf16 v[32:47], a[208:211], a[144:147], v[32:47]
ds_read_b64_tr_b16 a[244:245], v25 offset:8192
v_exp_f32 v172, v88
ds_read_b64_tr_b16 a[246:247], v25 offset:12288
v_cvt_pk_bf16_f32 v123, v178, v179
v_mfma_f32_32x32x16_bf16 v[48:63], a[208:211], a[176:179], v[48:63]
v_exp_f32 v173, v89
ds_read_b64_tr_b16 a[248:249], v26 offset:8192
v_add_f32 v163, v163, v178
v_add_f32 v163, v163, v179
ds_read_b64_tr_b16 a[250:251], v26 offset:12288
v_mfma_f32_32x32x16_bf16 v[32:47], a[212:215], a[148:151], v[32:47]
v_exp_f32 v174, v90
v_cvt_pk_bf16_f32 v124, v172, v173
v_exp_f32 v175, v91
ds_read_b64_tr_b16 a[252:253], v27 offset:8192
v_mfma_f32_32x32x16_bf16 v[48:63], a[212:215], a[180:183], v[48:63]
ds_read_b64_tr_b16 a[254:255], v27 offset:12288
v_add_f32 v163, v163, v172
v_add_f32 v163, v163, v173
v_exp_f32 v176, v92
v_cvt_pk_bf16_f32 v125, v174, v175
v_mfma_f32_32x32x16_bf16 v[32:47], a[216:219], a[152:155], v[32:47]
v_exp_f32 v177, v93
v_add_f32 v163, v163, v174
v_add_f32 v163, v163, v175
v_exp_f32 v178, v94
v_mfma_f32_32x32x16_bf16 v[48:63], a[216:219], a[184:187], v[48:63]
v_cvt_pk_bf16_f32 v126, v176, v177
v_exp_f32 v179, v95
v_add_f32 v163, v163, v176
v_add_f32 v163, v163, v177
v_cvt_pk_bf16_f32 v127, v178, v179
v_mfma_f32_32x32x16_bf16 v[32:47], a[220:223], a[156:159], v[32:47]
v_add_f32 v163, v163, v178
v_add_f32 v163, v163, v179
v_max_f32 v188, v162, v163
v_cmp_nle_f32 vcc, v188, v180
v_mfma_f32_32x32x16_bf16 v[48:63], a[220:223], a[188:191], v[48:63]
s_cbranch_vccnz attn_kernel_tr_l5
attn_kernel_back_l5:
s_waitcnt lgkmcnt(0)
v_mfma_f32_32x32x16_bf16 a[0:15], a[224:227], v[112:115], a[0:15]
s_waitcnt vmcnt(12)
s_barrier
v_mfma_f32_32x32x16_bf16 a[16:31], a[224:227], v[120:123], a[16:31]
ds_read_b128 a[192:195], v16 offset:16384
v_mfma_f32_32x32x16_bf16 a[32:47], a[228:231], v[112:115], a[32:47]
ds_read_b128 a[196:199], v17 offset:16384
v_mfma_f32_32x32x16_bf16 a[48:63], a[228:231], v[120:123], a[48:63]
ds_read_b128 a[200:203], v18 offset:16384
v_add_f32 v160, v160, v162
v_add_f32 v161, v161, v163
v_exp_f32 v172, v32
v_mfma_f32_32x32x16_bf16 a[64:79], a[232:235], v[112:115], a[64:79]
s_add_u32 m0, s35, 81920
ds_read_b128 a[204:207], v19 offset:16384
v_mfma_f32_32x32x16_bf16 a[80:95], a[232:235], v[120:123], a[80:95]
v_exp_f32 v173, v33
v_exp_f32 v174, v34
v_cvt_pk_bf16_f32 v96, v172, v173
v_mfma_f32_32x32x16_bf16 a[96:111], a[236:239], v[112:115], a[96:111]
ds_read_b128 a[208:211], v20 offset:16384
v_exp_f32 v175, v35
v_add_f32 v162, v172, v173
v_exp_f32 v176, v36
v_mfma_f32_32x32x16_bf16 a[112:127], a[236:239], v[120:123], a[112:127]
ds_read_b128 a[212:215], v21 offset:16384
v_cvt_pk_bf16_f32 v97, v174, v175
v_exp_f32 v177, v37
v_add_f32 v162, v162, v174
v_add_f32 v162, v162, v175
v_mfma_f32_32x32x16_bf16 a[0:15], a[240:243], v[116:119], a[0:15]
buffer_load_dwordx4 v182, s[8:11], s32 offen lds
ds_read_b128 a[216:219], v22 offset:16384
v_mfma_f32_32x32x16_bf16 a[16:31], a[240:243], v[124:127], a[16:31]
v_exp_f32 v178, v38
v_cvt_pk_bf16_f32 v98, v176, v177
v_exp_f32 v179, v39
v_add_f32 v162, v162, v176
v_mfma_f32_32x32x16_bf16 a[32:47], a[244:247], v[116:119], a[32:47]
ds_read_b128 a[220:223], v23 offset:16384
v_add_f32 v162, v162, v177
v_exp_f32 v172, v40
v_cvt_pk_bf16_f32 v99, v178, v179
v_mfma_f32_32x32x16_bf16 a[48:63], a[244:247], v[124:127], a[48:63]
v_exp_f32 v173, v41
buffer_load_dwordx4 v183, s[8:11], s32 offen offset:1024 lds
v_mfma_f32_32x32x16_bf16 a[64:79], a[248:251], v[116:119], a[64:79]
v_add_f32 v162, v162, v178
v_add_f32 v162, v162, v179
v_exp_f32 v174, v42
v_cvt_pk_bf16_f32 v100, v172, v173
v_mfma_f32_32x32x16_bf16 a[80:95], a[248:251], v[124:127], a[80:95]
v_exp_f32 v175, v43
v_add_f32 v162, v162, v172
v_add_f32 v162, v162, v173
v_exp_f32 v176, v44
v_mfma_f32_32x32x16_bf16 a[96:111], a[252:255], v[116:119], a[96:111]
v_cvt_pk_bf16_f32 v101, v174, v175
buffer_load_dwordx4 v184, s[12:15], s32 offen offset:2048 lds
v_mfma_f32_32x32x16_bf16 a[112:127], a[252:255], v[124:127], a[112:127]
v_exp_f32 v177, v45
v_add_f32 v162, v162, v174
v_add_f32 v162, v162, v175
v_exp_f32 v178, v46
s_waitcnt lgkmcnt(0)
v_mfma_f32_32x32x16_bf16 v[64:79], a[192:195], a[128:131], v[128:143]
ds_read_b64_tr_b16 a[224:225], v24 offset:16384
v_cvt_pk_bf16_f32 v102, v176, v177
v_exp_f32 v179, v47
v_add_f32 v162, v162, v176
v_add_f32 v162, v162, v177
v_mfma_f32_32x32x16_bf16 v[80:95], a[192:195], a[160:163], v[144:159]
ds_read_b64_tr_b16 a[226:227], v24 offset:20480
v_exp_f32 v172, v48
v_cvt_pk_bf16_f32 v103, v178, v179
ds_read_b64_tr_b16 a[228:229], v25 offset:16384
v_mfma_f32_32x32x16_bf16 v[64:79], a[196:199], a[132:135], v[64:79]
buffer_load_dwordx4 v184, s[12:15], s32 offen offset:3072 lds
v_exp_f32 v173, v49
v_mfma_f32_32x32x16_bf16 v[80:95], a[196:199], a[164:167], v[80:95]
ds_read_b64_tr_b16 a[230:231], v25 offset:20480
v_add_f32 v162, v162, v178
ds_read_b64_tr_b16 a[232:233], v26 offset:16384
v_add_f32 v162, v162, v179
v_exp_f32 v174, v50
v_mfma_f32_32x32x16_bf16 v[64:79], a[200:203], a[136:139], v[64:79]
s_add_u32 s32, s32, 8192
ds_read_b64_tr_b16 a[234:235], v26 offset:20480
v_cvt_pk_bf16_f32 v104, v172, v173
v_exp_f32 v175, v51
v_add_f32 v163, v172, v173
v_mfma_f32_32x32x16_bf16 v[80:95], a[200:203], a[168:171], v[80:95]
ds_read_b64_tr_b16 a[236:237], v27 offset:16384
v_exp_f32 v176, v52
v_cvt_pk_bf16_f32 v105, v174, v175
v_exp_f32 v177, v53
v_mfma_f32_32x32x16_bf16 v[64:79], a[204:207], a[140:143], v[64:79]
ds_read_b64_tr_b16 a[238:239], v27 offset:20480
ds_read_b64_tr_b16 a[240:241], v24 offset:24576
v_add_f32 v163, v163, v174
v_add_f32 v163, v163, v175
v_exp_f32 v178, v54
v_mfma_f32_32x32x16_bf16 v[80:95], a[204:207], a[172:175], v[80:95]
ds_read_b64_tr_b16 a[242:243], v24 offset:28672
v_cvt_pk_bf16_f32 v106, v176, v177
v_exp_f32 v179, v55
v_add_f32 v163, v163, v176
v_add_f32 v163, v163, v177
v_mfma_f32_32x32x16_bf16 v[64:79], a[208:211], a[144:147], v[64:79]
ds_read_b64_tr_b16 a[244:245], v25 offset:24576
v_exp_f32 v172, v56
ds_read_b64_tr_b16 a[246:247], v25 offset:28672
v_cvt_pk_bf16_f32 v107, v178, v179
v_mfma_f32_32x32x16_bf16 v[80:95], a[208:211], a[176:179], v[80:95]
v_exp_f32 v173, v57
ds_read_b64_tr_b16 a[248:249], v26 offset:24576
v_add_f32 v163, v163, v178
v_add_f32 v163, v163, v179
ds_read_b64_tr_b16 a[250:251], v26 offset:28672
v_mfma_f32_32x32x16_bf16 v[64:79], a[212:215], a[148:151], v[64:79]
v_exp_f32 v174, v58
v_cvt_pk_bf16_f32 v108, v172, v173
v_exp_f32 v175, v59
ds_read_b64_tr_b16 a[252:253], v27 offset:24576
v_mfma_f32_32x32x16_bf16 v[80:95], a[212:215], a[180:183], v[80:95]
ds_read_b64_tr_b16 a[254:255], v27 offset:28672
v_add_f32 v163, v163, v172
v_add_f32 v163, v163, v173
v_exp_f32 v176, v60
v_cvt_pk_bf16_f32 v109, v174, v175
v_mfma_f32_32x32x16_bf16 v[64:79], a[216:219], a[152:155], v[64:79]
v_exp_f32 v177, v61
v_add_f32 v163, v163, v174
v_add_f32 v163, v163, v175
v_exp_f32 v178, v62
v_mfma_f32_32x32x16_bf16 v[80:95], a[216:219], a[184:187], v[80:95]
v_cvt_pk_bf16_f32 v110, v176, v177
v_exp_f32 v179, v63
v_add_f32 v163, v163, v176
v_add_f32 v163, v163, v177
v_cvt_pk_bf16_f32 v111, v178, v179
v_mfma_f32_32x32x16_bf16 v[64:79], a[220:223], a[156:159], v[64:79]
v_add_f32 v163, v163, v178
v_add_f32 v163, v163, v179
v_max_f32 v188, v162, v163
v_cmp_nle_f32 vcc, v188, v180
v_mfma_f32_32x32x16_bf16 v[80:95], a[220:223], a[188:191], v[80:95]
s_cbranch_vccnz attn_kernel_tr_l6
attn_kernel_back_l6:
s_waitcnt lgkmcnt(0)
v_mfma_f32_32x32x16_bf16 a[0:15], a[224:227], v[96:99], a[0:15]
s_waitcnt vmcnt(12)
s_barrier
v_mfma_f32_32x32x16_bf16 a[16:31], a[224:227], v[104:107], a[16:31]
ds_read_b128 a[192:195], v16 offset:32768
v_mfma_f32_32x32x16_bf16 a[32:47], a[228:231], v[96:99], a[32:47]
ds_read_b128 a[196:199], v17 offset:32768
v_mfma_f32_32x32x16_bf16 a[48:63], a[228:231], v[104:107], a[48:63]
ds_read_b128 a[200:203], v18 offset:32768
v_add_f32 v160, v160, v162
v_add_f32 v161, v161, v163
v_exp_f32 v172, v64
v_mfma_f32_32x32x16_bf16 a[64:79], a[232:235], v[96:99], a[64:79]
s_add_u32 m0, s35, 98304
ds_read_b128 a[204:207], v19 offset:32768
v_mfma_f32_32x32x16_bf16 a[80:95], a[232:235], v[104:107], a[80:95]
v_exp_f32 v173, v65
v_exp_f32 v174, v66
v_cvt_pk_bf16_f32 v112, v172, v173
v_mfma_f32_32x32x16_bf16 a[96:111], a[236:239], v[96:99], a[96:111]
ds_read_b128 a[208:211], v20 offset:32768
v_exp_f32 v175, v67
v_add_f32 v162, v172, v173
v_exp_f32 v176, v68
v_mfma_f32_32x32x16_bf16 a[112:127], a[236:239], v[104:107], a[112:127]
ds_read_b128 a[212:215], v21 offset:32768
v_cvt_pk_bf16_f32 v113, v174, v175
v_exp_f32 v177, v69
v_add_f32 v162, v162, v174
v_add_f32 v162, v162, v175
v_mfma_f32_32x32x16_bf16 a[0:15], a[240:243], v[100:103], a[0:15]
buffer_load_dwordx4 v182, s[8:11], s32 offen lds
ds_read_b128 a[216:219], v22 offset:32768
v_mfma_f32_32x32x16_bf16 a[16:31], a[240:243], v[108:111], a[16:31]
v_exp_f32 v178, v70
v_cvt_pk_bf16_f32 v114, v176, v177
v_exp_f32 v179, v71
v_add_f32 v162, v162, v176
v_mfma_f32_32x32x16_bf16 a[32:47], a[244:247], v[100:103], a[32:47]
ds_read_b128 a[220:223], v23 offset:32768
v_add_f32 v162, v162, v177
v_exp_f32 v172, v72
v_cvt_pk_bf16_f32 v115, v178, v179
v_mfma_f32_32x32x16_bf16 a[48:63], a[244:247], v[108:111], a[48:63]
v_exp_f32 v173, v73
buffer_load_dwordx4 v183, s[8:11], s32 offen offset:1024 lds
v_mfma_f32_32x32x16_bf16 a[64:79], a[248:251], v[100:103], a[64:79]
v_add_f32 v162, v162, v178
v_add_f32 v162, v162, v179
v_exp_f32 v174, v74
v_cvt_pk_bf16_f32 v116, v172, v173
v_mfma_f32_32x32x16_bf16 a[80:95], a[248:251], v[108:111], a[80:95]
v_exp_f32 v175, v75
v_add_f32 v162, v162, v172
v_add_f32 v162, v162, v173
v_exp_f32 v176, v76
v_mfma_f32_32x32x16_bf16 a[96:111], a[252:255], v[100:103], a[96:111]
v_cvt_pk_bf16_f32 v117, v174, v175
buffer_load_dwordx4 v184, s[12:15], s32 offen offset:2048 lds
v_mfma_f32_32x32x16_bf16 a[112:127], a[252:255], v[108:111], a[112:127]
v_exp_f32 v177, v77
v_add_f32 v162, v162, v174
v_add_f32 v162, v162, v175
v_exp_f32 v178, v78
s_waitcnt lgkmcnt(0)
v_mfma_f32_32x32x16_bf16 v[32:47], a[192:195], a[128:131], v[128:143]
ds_read_b64_tr_b16 a[224:225], v24 offset:32768
v_cvt_pk_bf16_f32 v118, v176, v177
v_exp_f32 v179, v79
v_add_f32 v162, v162, v176
v_add_f32 v162, v162, v177
v_mfma_f32_32x32x16_bf16 v[48:63], a[192:195], a[160:163], v[144:159]
ds_read_b64_tr_b16 a[226:227], v24 offset:36864
v_exp_f32 v172, v80
v_cvt_pk_bf16_f32 v119, v178, v179
ds_read_b64_tr_b16 a[228:229], v25 offset:32768
v_mfma_f32_32x32x16_bf16 v[32:47], a[196:199], a[132:135], v[32:47]
buffer_load_dwordx4 v184, s[12:15], s32 offen offset:3072 lds
v_exp_f32 v173, v81
v_mfma_f32_32x32x16_bf16 v[48:63], a[196:199], a[164:167], v[48:63]
ds_read_b64_tr_b16 a[230:231], v25 offset:36864
v_add_f32 v162, v162, v178
ds_read_b64_tr_b16 a[232:233], v26 offset:32768
v_add_f32 v162, v162, v179
v_exp_f32 v174, v82
v_mfma_f32_32x32x16_bf16 v[32:47], a[200:203], a[136:139], v[32:47]
s_add_u32 s32, s32, 8192
ds_read_b64_tr_b16 a[234:235], v26 offset:36864
v_cvt_pk_bf16_f32 v120, v172, v173
v_exp_f32 v175, v83
v_add_f32 v163, v172, v173
v_mfma_f32_32x32x16_bf16 v[48:63], a[200:203], a[168:171], v[48:63]
ds_read_b64_tr_b16 a[236:237], v27 offset:32768
v_exp_f32 v176, v84
v_cvt_pk_bf16_f32 v121, v174, v175
v_exp_f32 v177, v85
v_mfma_f32_32x32x16_bf16 v[32:47], a[204:207], a[140:143], v[32:47]
ds_read_b64_tr_b16 a[238:239], v27 offset:36864
ds_read_b64_tr_b16 a[240:241], v24 offset:40960
v_add_f32 v163, v163, v174
v_add_f32 v163, v163, v175
v_exp_f32 v178, v86
v_mfma_f32_32x32x16_bf16 v[48:63], a[204:207], a[172:175], v[48:63]
ds_read_b64_tr_b16 a[242:243], v24 offset:45056
v_cvt_pk_bf16_f32 v122, v176, v177
v_exp_f32 v179, v87
v_add_f32 v163, v163, v176
v_add_f32 v163, v163, v177
v_mfma_f32_32x32x16_bf16 v[32:47], a[208:211], a[144:147], v[32:47]
ds_read_b64_tr_b16 a[244:245], v25 offset:40960
v_exp_f32 v172, v88
ds_read_b64_tr_b16 a[246:247], v25 offset:45056
v_cvt_pk_bf16_f32 v123, v178, v179
v_mfma_f32_32x32x16_bf16 v[48:63], a[208:211], a[176:179], v[48:63]
v_exp_f32 v173, v89
ds_read_b64_tr_b16 a[248:249], v26 offset:40960
v_add_f32 v163, v163, v178
v_add_f32 v163, v163, v179
ds_read_b64_tr_b16 a[250:251], v26 offset:45056
v_mfma_f32_32x32x16_bf16 v[32:47], a[212:215], a[148:151], v[32:47]
v_exp_f32 v174, v90
v_cvt_pk_bf16_f32 v124, v172, v173
v_exp_f32 v175, v91
ds_read_b64_tr_b16 a[252:253], v27 offset:40960
v_mfma_f32_32x32x16_bf16 v[48:63], a[212:215], a[180:183], v[48:63]
ds_read_b64_tr_b16 a[254:255], v27 offset:45056
v_add_f32 v163, v163, v172
v_add_f32 v163, v163, v173
v_exp_f32 v176, v92
v_cvt_pk_bf16_f32 v125, v174, v175
v_mfma_f32_32x32x16_bf16 v[32:47], a[216:219], a[152:155], v[32:47]
v_exp_f32 v177, v93
v_add_f32 v163, v163, v174
v_add_f32 v163, v163, v175
v_exp_f32 v178, v94
v_mfma_f32_32x32x16_bf16 v[48:63], a[216:219], a[184:187], v[48:63]
v_cvt_pk_bf16_f32 v126, v176, v177
v_exp_f32 v179, v95
v_add_f32 v163, v163, v176
v_add_f32 v163, v163, v177
v_cvt_pk_bf16_f32 v127, v178, v179
v_mfma_f32_32x32x16_bf16 v[32:47], a[220:223], a[156:159], v[32:47]
v_add_f32 v163, v163, v178
v_add_f32 v163, v163, v179
v_max_f32 v188, v162, v163
v_cmp_nle_f32 vcc, v188, v180
v_mfma_f32_32x32x16_bf16 v[48:63], a[220:223], a[188:191], v[48:63]
s_cbranch_vccnz attn_kernel_tr_l7
attn_kernel_back_l7:
s_sub_u32 s31, s31, 1
s_cmp_lg_u32 s31, 0
s_cbranch_scc1 attn_kernel_loop
s_waitcnt lgkmcnt(0)
v_mfma_f32_32x32x16_bf16 a[0:15], a[224:227], v[112:115], a[0:15]
s_waitcnt vmcnt(12)
s_barrier
v_mfma_f32_32x32x16_bf16 a[16:31], a[224:227], v[120:123], a[16:31]
ds_read_b128 a[192:195], v16 offset:49152
v_mfma_f32_32x32x16_bf16 a[32:47], a[228:231], v[112:115], a[32:47]
ds_read_b128 a[196:199], v17 offset:49152
v_mfma_f32_32x32x16_bf16 a[48:63], a[228:231], v[120:123], a[48:63]
ds_read_b128 a[200:203], v18 offset:49152
v_add_f32 v160, v160, v162
v_add_f32 v161, v161, v163
v_exp_f32 v172, v32
v_mfma_f32_32x32x16_bf16 a[64:79], a[232:235], v[112:115], a[64:79]
s_add_u32 m0, s35, 114688
ds_read_b128 a[204:207], v19 offset:49152
v_mfma_f32_32x32x16_bf16 a[80:95], a[232:235], v[120:123], a[80:95]
v_exp_f32 v173, v33
v_exp_f32 v174, v34
v_cvt_pk_bf16_f32 v96, v172, v173
v_mfma_f32_32x32x16_bf16 a[96:111], a[236:239], v[112:115], a[96:111]
ds_read_b128 a[208:211], v20 offset:49152
v_exp_f32 v175, v35
v_add_f32 v162, v172, v173
v_exp_f32 v176, v36
v_mfma_f32_32x32x16_bf16 a[112:127], a[236:239], v[120:123], a[112:127]
ds_read_b128 a[212:215], v21 offset:49152
v_cvt_pk_bf16_f32 v97, v174, v175
v_exp_f32 v177, v37
v_add_f32 v162, v162, v174
v_add_f32 v162, v162, v175
v_mfma_f32_32x32x16_bf16 a[0:15], a[240:243], v[116:119], a[0:15]
buffer_load_dwordx4 v182, s[8:11], s32 offen lds
ds_read_b128 a[216:219], v22 offset:49152
v_mfma_f32_32x32x16_bf16 a[16:31], a[240:243], v[124:127], a[16:31]
v_exp_f32 v178, v38
v_cvt_pk_bf16_f32 v98, v176, v177
v_exp_f32 v179, v39
v_add_f32 v162, v162, v176
v_mfma_f32_32x32x16_bf16 a[32:47], a[244:247], v[116:119], a[32:47]
ds_read_b128 a[220:223], v23 offset:49152
v_add_f32 v162, v162, v177
v_exp_f32 v172, v40
v_cvt_pk_bf16_f32 v99, v178, v179
v_mfma_f32_32x32x16_bf16 a[48:63], a[244:247], v[124:127], a[48:63]
v_exp_f32 v173, v41
buffer_load_dwordx4 v183, s[8:11], s32 offen offset:1024 lds
v_mfma_f32_32x32x16_bf16 a[64:79], a[248:251], v[116:119], a[64:79]
v_add_f32 v162, v162, v178
v_add_f32 v162, v162, v179
v_exp_f32 v174, v42
v_cvt_pk_bf16_f32 v100, v172, v173
v_mfma_f32_32x32x16_bf16 a[80:95], a[248:251], v[124:127], a[80:95]
v_exp_f32 v175, v43
v_add_f32 v162, v162, v172
v_add_f32 v162, v162, v173
v_exp_f32 v176, v44
v_mfma_f32_32x32x16_bf16 a[96:111], a[252:255], v[116:119], a[96:111]
v_cvt_pk_bf16_f32 v101, v174, v175
buffer_load_dwordx4 v184, s[12:15], s32 offen offset:2048 lds
v_mfma_f32_32x32x16_bf16 a[112:127], a[252:255], v[124:127], a[112:127]
v_exp_f32 v177, v45
v_add_f32 v162, v162, v174
v_add_f32 v162, v162, v175
v_exp_f32 v178, v46
s_waitcnt lgkmcnt(0)
v_mfma_f32_32x32x16_bf16 v[64:79], a[192:195], a[128:131], v[128:143]
ds_read_b64_tr_b16 a[224:225], v24 offset:49152
v_cvt_pk_bf16_f32 v102, v176, v177
v_exp_f32 v179, v47
v_add_f32 v162, v162, v176
v_add_f32 v162, v162, v177
v_mfma_f32_32x32x16_bf16 v[80:95], a[192:195], a[160:163], v[144:159]
ds_read_b64_tr_b16 a[226:227], v24 offset:53248
v_exp_f32 v172, v48
v_cvt_pk_bf16_f32 v103, v178, v179
ds_read_b64_tr_b16 a[228:229], v25 offset:49152
v_mfma_f32_32x32x16_bf16 v[64:79], a[196:199], a[132:135], v[64:79]
buffer_load_dwordx4 v184, s[12:15], s32 offen offset:3072 lds
v_exp_f32 v173, v49
v_mfma_f32_32x32x16_bf16 v[80:95], a[196:199], a[164:167], v[80:95]
ds_read_b64_tr_b16 a[230:231], v25 offset:53248
v_add_f32 v162, v162, v178
ds_read_b64_tr_b16 a[232:233], v26 offset:49152
v_add_f32 v162, v162, v179
v_exp_f32 v174, v50
v_mfma_f32_32x32x16_bf16 v[64:79], a[200:203], a[136:139], v[64:79]
s_add_u32 s32, s32, 8192
ds_read_b64_tr_b16 a[234:235], v26 offset:53248
v_cvt_pk_bf16_f32 v104, v172, v173
v_exp_f32 v175, v51
v_add_f32 v163, v172, v173
v_mfma_f32_32x32x16_bf16 v[80:95], a[200:203], a[168:171], v[80:95]
ds_read_b64_tr_b16 a[236:237], v27 offset:49152
v_exp_f32 v176, v52
v_cvt_pk_bf16_f32 v105, v174, v175
v_exp_f32 v177, v53
v_mfma_f32_32x32x16_bf16 v[64:79], a[204:207], a[140:143], v[64:79]
ds_read_b64_tr_b16 a[238:239], v27 offset:53248
ds_read_b64_tr_b16 a[240:241], v24 offset:57344
v_add_f32 v163, v163, v174
v_add_f32 v163, v163, v175
v_exp_f32 v178, v54
v_mfma_f32_32x32x16_bf16 v[80:95], a[204:207], a[172:175], v[80:95]
ds_read_b64_tr_b16 a[242:243], v24 offset:61440
v_cvt_pk_bf16_f32 v106, v176, v177
v_exp_f32 v179, v55
v_add_f32 v163, v163, v176
v_add_f32 v163, v163, v177
v_mfma_f32_32x32x16_bf16 v[64:79], a[208:211], a[144:147], v[64:79]
ds_read_b64_tr_b16 a[244:245], v25 offset:57344
v_exp_f32 v172, v56
ds_read_b64_tr_b16 a[246:247], v25 offset:61440
v_cvt_pk_bf16_f32 v107, v178, v179
v_mfma_f32_32x32x16_bf16 v[80:95], a[208:211], a[176:179], v[80:95]
v_exp_f32 v173, v57
ds_read_b64_tr_b16 a[248:249], v26 offset:57344
v_add_f32 v163, v163, v178
v_add_f32 v163, v163, v179
ds_read_b64_tr_b16 a[250:251], v26 offset:61440
v_mfma_f32_32x32x16_bf16 v[64:79], a[212:215], a[148:151], v[64:79]
v_exp_f32 v174, v58
v_cvt_pk_bf16_f32 v108, v172, v173
v_exp_f32 v175, v59
ds_read_b64_tr_b16 a[252:253], v27 offset:57344
v_mfma_f32_32x32x16_bf16 v[80:95], a[212:215], a[180:183], v[80:95]
ds_read_b64_tr_b16 a[254:255], v27 offset:61440
v_add_f32 v163, v163, v172
v_add_f32 v163, v163, v173
v_exp_f32 v176, v60
v_cvt_pk_bf16_f32 v109, v174, v175
v_mfma_f32_32x32x16_bf16 v[64:79], a[216:219], a[152:155], v[64:79]
v_exp_f32 v177, v61
v_add_f32 v163, v163, v174
v_add_f32 v163, v163, v175
v_exp_f32 v178, v62
v_mfma_f32_32x32x16_bf16 v[80:95], a[216:219], a[184:187], v[80:95]
v_cvt_pk_bf16_f32 v110, v176, v177
v_exp_f32 v179, v63
v_add_f32 v163, v163, v176
v_add_f32 v163, v163, v177
v_cvt_pk_bf16_f32 v111, v178, v179
v_mfma_f32_32x32x16_bf16 v[64:79], a[220:223], a[156:159], v[64:79]
v_add_f32 v163, v163, v178
v_add_f32 v163, v163, v179
v_max_f32 v188, v162, v163
v_cmp_nle_f32 vcc, v188, v180
v_mfma_f32_32x32x16_bf16 v[80:95], a[220:223], a[188:191], v[80:95]
s_cbranch_vccnz attn_kernel_tr_t58
attn_kernel_back_t58:
s_waitcnt lgkmcnt(0)
v_mfma_f32_32x32x16_bf16 a[0:15], a[224:227], v[96:99], a[0:15]
s_waitcnt vmcnt(12)
s_barrier
v_mfma_f32_32x32x16_bf16 a[16:31], a[224:227], v[104:107], a[16:31]
ds_read_b128 a[192:195], v210 offset:0
v_mfma_f32_32x32x16_bf16 a[32:47], a[228:231], v[96:99], a[32:47]
ds_read_b128 a[196:199], v211 offset:0
v_mfma_f32_32x32x16_bf16 a[48:63], a[228:231], v[104:107], a[48:63]
ds_read_b128 a[200:203], v212 offset:0
v_add_f32 v160, v160, v162
v_add_f32 v161, v161, v163
v_exp_f32 v172, v64
v_mfma_f32_32x32x16_bf16 a[64:79], a[232:235], v[96:99], a[64:79]
s_add_u32 m0, s35, 0
ds_read_b128 a[204:207], v213 offset:0
v_mfma_f32_32x32x16_bf16 a[80:95], a[232:235], v[104:107], a[80:95]
v_exp_f32 v173, v65
v_exp_f32 v174, v66
v_cvt_pk_bf16_f32 v112, v172, v173
v_mfma_f32_32x32x16_bf16 a[96:111], a[236:239], v[96:99], a[96:111]
ds_read_b128 a[208:211], v214 offset:0
v_exp_f32 v175, v67
v_add_f32 v162, v172, v173
v_exp_f32 v176, v68
v_mfma_f32_32x32x16_bf16 a[112:127], a[236:239], v[104:107], a[112:127]
ds_read_b128 a[212:215], v215 offset:0
v_cvt_pk_bf16_f32 v113, v174, v175
v_exp_f32 v177, v69
v_add_f32 v162, v162, v174
v_add_f32 v162, v162, v175
v_mfma_f32_32x32x16_bf16 a[0:15], a[240:243], v[100:103], a[0:15]
buffer_load_dwordx4 v182, s[8:11], s32 offen lds
ds_read_b128 a[216:219], v216 offset:0
v_mfma_f32_32x32x16_bf16 a[16:31], a[240:243], v[108:111], a[16:31]
v_exp_f32 v178, v70
v_cvt_pk_bf16_f32 v114, v176, v177
v_exp_f32 v179, v71
v_add_f32 v162, v162, v176
v_mfma_f32_32x32x16_bf16 a[32:47], a[244:247], v[100:103], a[32:47]
ds_read_b128 a[220:223], v217 offset:0
v_add_f32 v162, v162, v177
v_exp_f32 v172, v72
v_cvt_pk_bf16_f32 v115, v178, v179
v_mfma_f32_32x32x16_bf16 a[48:63], a[244:247], v[108:111], a[48:63]
v_exp_f32 v173, v73
buffer_load_dwordx4 v183, s[8:11], s32 offen offset:1024 lds
v_mfma_f32_32x32x16_bf16 a[64:79], a[248:251], v[100:103], a[64:79]
v_add_f32 v162, v162, v178
v_add_f32 v162, v162, v179
v_exp_f32 v174, v74
v_cvt_pk_bf16_f32 v116, v172, v173
v_mfma_f32_32x32x16_bf16 a[80:95], a[248:251], v[108:111], a[80:95]
v_exp_f32 v175, v75
v_add_f32 v162, v162, v172
v_add_f32 v162, v162, v173
v_exp_f32 v176, v76
v_mfma_f32_32x32x16_bf16 a[96:111], a[252:255], v[100:103], a[96:111]
v_cvt_pk_bf16_f32 v117, v174, v175
buffer_load_dwordx4 v184, s[12:15], s32 offen offset:2048 lds
v_mfma_f32_32x32x16_bf16 a[112:127], a[252:255], v[108:111], a[112:127]
v_exp_f32 v177, v77
v_add_f32 v162, v162, v174
v_add_f32 v162, v162, v175
v_exp_f32 v178, v78
s_waitcnt lgkmcnt(0)
v_mfma_f32_32x32x16_bf16 v[32:47], a[192:195], a[128:131], v[128:143]
ds_read_b64_tr_b16 a[224:225], v218 offset:0
v_cvt_pk_bf16_f32 v118, v176, v177
v_exp_f32 v179, v79
v_add_f32 v162, v162, v176
v_add_f32 v162, v162, v177
v_mfma_f32_32x32x16_bf16 v[48:63], a[192:195], a[160:163], v[144:159]
ds_read_b64_tr_b16 a[226:227], v218 offset:4096
v_exp_f32 v172, v80
v_cvt_pk_bf16_f32 v119, v178, v179
ds_read_b64_tr_b16 a[228:229], v219 offset:0
v_mfma_f32_32x32x16_bf16 v[32:47], a[196:199], a[132:135], v[32:47]
buffer_load_dwordx4 v184, s[12:15], s32 offen offset:3072 lds
v_exp_f32 v173, v81
v_mfma_f32_32x32x16_bf16 v[48:63], a[196:199], a[164:167], v[48:63]
ds_read_b64_tr_b16 a[230:231], v219 offset:4096
v_add_f32 v162, v162, v178
ds_read_b64_tr_b16 a[232:233], v220 offset:0
v_add_f32 v162, v162, v179
v_exp_f32 v174, v82
v_mfma_f32_32x32x16_bf16 v[32:47], a[200:203], a[136:139], v[32:47]
s_add_u32 s32, s32, 8192
ds_read_b64_tr_b16 a[234:235], v220 offset:4096
v_cvt_pk_bf16_f32 v120, v172, v173
v_exp_f32 v175, v83
v_add_f32 v163, v172, v173
v_mfma_f32_32x32x16_bf16 v[48:63], a[200:203], a[168:171], v[48:63]
ds_read_b64_tr_b16 a[236:237], v221 offset:0
v_exp_f32 v176, v84
v_cvt_pk_bf16_f32 v121, v174, v175
v_exp_f32 v177, v85
v_mfma_f32_32x32x16_bf16 v[32:47], a[204:207], a[140:143], v[32:47]
ds_read_b64_tr_b16 a[238:239], v221 offset:4096
ds_read_b64_tr_b16 a[240:241], v218 offset:8192
v_add_f32 v163, v163, v174
v_add_f32 v163, v163, v175
v_exp_f32 v178, v86
v_mfma_f32_32x32x16_bf16 v[48:63], a[204:207], a[172:175], v[48:63]
ds_read_b64_tr_b16 a[242:243], v218 offset:12288
v_cvt_pk_bf16_f32 v122, v176, v177
v_exp_f32 v179, v87
v_add_f32 v163, v163, v176
v_add_f32 v163, v163, v177
v_mfma_f32_32x32x16_bf16 v[32:47], a[208:211], a[144:147], v[32:47]
ds_read_b64_tr_b16 a[244:245], v219 offset:8192
v_exp_f32 v172, v88
ds_read_b64_tr_b16 a[246:247], v219 offset:12288
v_cvt_pk_bf16_f32 v123, v178, v179
v_mfma_f32_32x32x16_bf16 v[48:63], a[208:211], a[176:179], v[48:63]
v_exp_f32 v173, v89
ds_read_b64_tr_b16 a[248:249], v220 offset:8192
v_add_f32 v163, v163, v178
v_add_f32 v163, v163, v179
ds_read_b64_tr_b16 a[250:251], v220 offset:12288
v_mfma_f32_32x32x16_bf16 v[32:47], a[212:215], a[148:151], v[32:47]
v_exp_f32 v174, v90
v_cvt_pk_bf16_f32 v124, v172, v173
v_exp_f32 v175, v91
ds_read_b64_tr_b16 a[252:253], v221 offset:8192
v_mfma_f32_32x32x16_bf16 v[48:63], a[212:215], a[180:183], v[48:63]
ds_read_b64_tr_b16 a[254:255], v221 offset:12288
v_add_f32 v163, v163, v172
v_add_f32 v163, v163, v173
v_exp_f32 v176, v92
v_cvt_pk_bf16_f32 v125, v174, v175
v_mfma_f32_32x32x16_bf16 v[32:47], a[216:219], a[152:155], v[32:47]
v_exp_f32 v177, v93
v_add_f32 v163, v163, v174
v_add_f32 v163, v163, v175
v_exp_f32 v178, v94
v_mfma_f32_32x32x16_bf16 v[48:63], a[216:219], a[184:187], v[48:63]
v_cvt_pk_bf16_f32 v126, v176, v177
v_exp_f32 v179, v95
v_add_f32 v163, v163, v176
v_add_f32 v163, v163, v177
v_cvt_pk_bf16_f32 v127, v178, v179
v_mfma_f32_32x32x16_bf16 v[32:47], a[220:223], a[156:159], v[32:47]
v_add_f32 v163, v163, v178
v_add_f32 v163, v163, v179
v_max_f32 v188, v162, v163
v_cmp_nle_f32 vcc, v188, v180
v_mfma_f32_32x32x16_bf16 v[48:63], a[220:223], a[188:191], v[48:63]
s_cbranch_vccnz attn_kernel_tr_t59
attn_kernel_back_t59:
s_waitcnt lgkmcnt(0)
v_mfma_f32_32x32x16_bf16 a[0:15], a[224:227], v[112:115], a[0:15]
s_waitcnt vmcnt(12)
s_barrier
v_mfma_f32_32x32x16_bf16 a[16:31], a[224:227], v[120:123], a[16:31]
ds_read_b128 a[192:195], v210 offset:16384
v_mfma_f32_32x32x16_bf16 a[32:47], a[228:231], v[112:115], a[32:47]
ds_read_b128 a[196:199], v211 offset:16384
buffer_load_dwordx4 v[204:207], v186, s[4:7], s58 offen offset:0
v_mfma_f32_32x32x16_bf16 a[48:63], a[228:231], v[120:123], a[48:63]
ds_read_b128 a[200:203], v212 offset:16384
v_add_f32 v160, v160, v162
v_add_f32 v161, v161, v163
v_exp_f32 v172, v32
v_mfma_f32_32x32x16_bf16 a[64:79], a[232:235], v[112:115], a[64:79]
v_exp_f32 v173, v33
ds_read_b128 a[204:207], v213 offset:16384
v_exp_f32 v174, v34
v_cvt_pk_bf16_f32 v96, v172, v173
v_mfma_f32_32x32x16_bf16 a[80:95], a[232:235], v[120:123], a[80:95]
v_exp_f32 v175, v35
buffer_load_dwordx4 v[204:207], v186, s[4:7], s58 offen offset:1024
v_mfma_f32_32x32x16_bf16 a[96:111], a[236:239], v[112:115], a[96:111]
ds_read_b128 a[208:211], v214 offset:16384
v_add_f32 v162, v172, v173
v_exp_f32 v176, v36
v_cvt_pk_bf16_f32 v97, v174, v175
v_mfma_f32_32x32x16_bf16 a[112:127], a[236:239], v[120:123], a[112:127]
ds_read_b128 a[212:215], v215 offset:16384
v_exp_f32 v177, v37
v_add_f32 v162, v162, v174
v_add_f32 v162, v162, v175
v_mfma_f32_32x32x16_bf16 a[0:15], a[240:243], v[116:119], a[0:15]
ds_read_b128 a[216:219], v216 offset:16384
v_exp_f32 v178, v38
v_cvt_pk_bf16_f32 v98, v176, v177
v_exp_f32 v179, v39
v_mfma_f32_32x32x16_bf16 a[16:31], a[240:243], v[124:127], a[16:31]
buffer_load_dwordx4 v[204:207], v186, s[4:7], s58 offen offset:2048
v_add_f32 v162, v162, v176
v_add_f32 v162, v162, v177
v_mfma_f32_32x32x16_bf16 a[32:47], a[244:247], v[116:119], a[32:47]
ds_read_b128 a[220:223], v217 offset:16384
v_exp_f32 v172, v40
v_cvt_pk_bf16_f32 v99, v178, v179
v_exp_f32 v173, v41
v_mfma_f32_32x32x16_bf16 a[48:63], a[244:247], v[124:127], a[48:63]
v_add_f32 v162, v162, v178
v_add_f32 v162, v162, v179
v_exp_f32 v174, v42
v_cvt_pk_bf16_f32 v100, v172, v173
v_mfma_f32_32x32x16_bf16 a[64:79], a[248:251], v[116:119], a[64:79]
v_exp_f32 v175, v43
buffer_load_dwordx4 v[204:207], v186, s[4:7], s58 offen offset:3072
v_mfma_f32_32x32x16_bf16 a[80:95], a[248:251], v[124:127], a[80:95]
v_add_f32 v162, v162, v172
v_add_f32 v162, v162, v173
v_exp_f32 v176, v44
v_cvt_pk_bf16_f32 v101, v174, v175
v_mfma_f32_32x32x16_bf16 a[96:111], a[252:255], v[116:119], a[96:111]
v_exp_f32 v177, v45
v_add_f32 v162, v162, v174
v_add_f32 v162, v162, v175
v_exp_f32 v178, v46
v_mfma_f32_32x32x16_bf16 a[112:127], a[252:255], v[124:127], a[112:127]
v_cvt_pk_bf16_f32 v102, v176, v177
v_exp_f32 v179, v47
v_add_f32 v162, v162, v176
s_waitcnt lgkmcnt(0)
v_mfma_f32_32x32x16_bf16 v[64:79], a[192:195], a[128:131], v[128:143]
ds_read_b64_tr_b16 a[224:225], v218 offset:16384
buffer_load_dwordx4 v[204:207], v186, s[4:7], s59 offen offset:0
v_add_f32 v162, v162, v177
v_mfma_f32_32x32x16_bf16 v[80:95], a[192:195], a[160:163], v[144:159]
ds_read_b64_tr_b16 a[226:227], v218 offset:20480
v_exp_f32 v172, v48
v_cvt_pk_bf16_f32 v103, v178, v179
ds_read_b64_tr_b16 a[228:229], v219 offset:16384
v_mfma_f32_32x32x16_bf16 v[64:79], a[196:199], a[132:135], v[64:79]
v_exp_f32 v173, v49
ds_read_b64_tr_b16 a[230:231], v219 offset:20480
v_add_f32 v162, v162, v178
v_add_f32 v162, v162, v179
v_mfma_f32_32x32x16_bf16 v[80:95], a[196:199], a[164:167], v[80:95]
ds_read_b64_tr_b16 a[232:233], v220 offset:16384
v_exp_f32 v174, v50
v_cvt_pk_bf16_f32 v104, v172, v173
v_exp_f32 v175, v51
v_mfma_f32_32x32x16_bf16 v[64:79], a[200:203], a[136:139], v[64:79]
ds_read_b64_tr_b16 a[234:235], v220 offset:20480
buffer_load_dwordx4 v[204:207], v186, s[4:7], s59 offen offset:1024
v_add_f32 v163, v172, v173
v_mfma_f32_32x32x16_bf16 v[80:95], a[200:203], a[168:171], v[80:95]
ds_read_b64_tr_b16 a[236:237], v221 offset:16384
v_exp_f32 v176, v52
v_cvt_pk_bf16_f32 v105, v174, v175
v_exp_f32 v177, v53
v_mfma_f32_32x32x16_bf16 v[64:79], a[204:207], a[140:143], v[64:79]
ds_read_b64_tr_b16 a[238:239], v221 offset:20480
ds_read_b64_tr_b16 a[240:241], v218 offset:24576
v_add_f32 v163, v163, v174
v_add_f32 v163, v163, v175
v_exp_f32 v178, v54
v_mfma_f32_32x32x16_bf16 v[80:95], a[204:207], a[172:175], v[80:95]
ds_read_b64_tr_b16 a[242:243], v218 offset:28672
v_cvt_pk_bf16_f32 v106, v176, v177
v_exp_f32 v179, v55
v_add_f32 v163, v163, v176
v_add_f32 v163, v163, v177
v_mfma_f32_32x32x16_bf16 v[64:79], a[208:211], a[144:147], v[64:79]
ds_read_b64_tr_b16 a[244:245], v219 offset:24576
buffer_load_dwordx4 v[204:207], v186, s[4:7], s59 offen offset:2048
ds_read_b64_tr_b16 a[246:247], v219 offset:28672
v_mfma_f32_32x32x16_bf16 v[80:95], a[208:211], a[176:179], v[80:95]
v_exp_f32 v172, v56
v_cvt_pk_bf16_f32 v107, v178, v179
v_exp_f32 v173, v57
ds_read_b64_tr_b16 a[248:249], v220 offset:24576
v_mfma_f32_32x32x16_bf16 v[64:79], a[212:215], a[148:151], v[64:79]
ds_read_b64_tr_b16 a[250:251], v220 offset:28672
v_add_f32 v163, v163, v178
v_add_f32 v163, v163, v179
v_exp_f32 v174, v58
v_cvt_pk_bf16_f32 v108, v172, v173
v_mfma_f32_32x32x16_bf16 v[80:95], a[212:215], a[180:183], v[80:95]
ds_read_b64_tr_b16 a[252:253], v221 offset:24576
ds_read_b64_tr_b16 a[254:255], v221 offset:28672
v_exp_f32 v175, v59
v_add_f32 v163, v163, v172
v_add_f32 v163, v163, v173
v_mfma_f32_32x32x16_bf16 v[64:79], a[216:219], a[152:155], v[64:79]
buffer_load_dwordx4 v[204:207], v186, s[4:7], s59 offen offset:3072
v_exp_f32 v176, v60
v_mfma_f32_32x32x16_bf16 v[80:95], a[216:219], a[184:187], v[80:95]
v_cvt_pk_bf16_f32 v109, v174, v175
v_exp_f32 v177, v61
v_add_f32 v163, v163, v174
v_add_f32 v163, v163, v175
v_mfma_f32_32x32x16_bf16 v[64:79], a[220:223], a[156:159], v[64:79]
v_exp_f32 v178, v62
v_cvt_pk_bf16_f32 v110, v176, v177
v_exp_f32 v179, v63
v_add_f32 v163, v163, v176
v_add_f32 v163, v163, v177
v_cvt_pk_bf16_f32 v111, v178, v179
v_add_f32 v163, v163, v178
v_add_f32 v163, v163, v179
v_max_f32 v188, v162, v163
v_cmp_nle_f32 vcc, v188, v180
v_mfma_f32_32x32x16_bf16 v[80:95], a[220:223], a[188:191], v[80:95]
s_cbranch_vccnz attn_kernel_tr_t60
attn_kernel_back_t60:
s_waitcnt lgkmcnt(0)
v_mfma_f32_32x32x16_bf16 a[0:15], a[224:227], v[96:99], a[0:15]
s_waitcnt vmcnt(16)
s_barrier
v_mfma_f32_32x32x16_bf16 a[16:31], a[224:227], v[104:107], a[16:31]
ds_read_b128 a[192:195], v210 offset:32768
v_mfma_f32_32x32x16_bf16 a[32:47], a[228:231], v[96:99], a[32:47]
ds_read_b128 a[196:199], v211 offset:32768
s_add_u32 s38, s57, 0
buffer_load_dwordx4 v[204:207], v208, s[48:51], s38 offen
v_mfma_f32_32x32x16_bf16 a[48:63], a[228:231], v[104:107], a[48:63]
ds_read_b128 a[200:203], v212 offset:32768
v_add_f32 v160, v160, v162
v_add_f32 v161, v161, v163
v_exp_f32 v172, v64
v_mfma_f32_32x32x16_bf16 a[64:79], a[232:235], v[96:99], a[64:79]
v_exp_f32 v173, v65
ds_read_b128 a[204:207], v213 offset:32768
v_exp_f32 v174, v66
v_cvt_pk_bf16_f32 v112, v172, v173
v_mfma_f32_32x32x16_bf16 a[80:95], a[232:235], v[104:107], a[80:95]
v_exp_f32 v175, v67
v_add_f32 v162, v172, v173
v_exp_f32 v176, v68
v_mfma_f32_32x32x16_bf16 a[96:111], a[236:239], v[96:99], a[96:111]
ds_read_b128 a[208:211], v214 offset:32768
v_cvt_pk_bf16_f32 v113, v174, v175
s_add_u32 s38, s57, 1048576
v_exp_f32 v177, v69
v_mfma_f32_32x32x16_bf16 a[112:127], a[236:239], v[104:107], a[112:127]
ds_read_b128 a[212:215], v215 offset:32768
v_add_f32 v162, v162, v174
buffer_load_dwordx4 v[204:207], v208, s[48:51], s38 offen
v_mfma_f32_32x32x16_bf16 a[0:15], a[240:243], v[100:103], a[0:15]
v_add_f32 v162, v162, v175
ds_read_b128 a[216:219], v216 offset:32768
v_exp_f32 v178, v70
v_cvt_pk_bf16_f32 v114, v176, v177
v_mfma_f32_32x32x16_bf16 a[16:31], a[240:243], v[108:111], a[16:31]
v_exp_f32 v179, v71
v_add_f32 v162, v162, v176
v_add_f32 v162, v162, v177
ds_read_b128 a[220:223], v217 offset:32768
v_mfma_f32_32x32x16_bf16 a[32:47], a[244:247], v[100:103], a[32:47]
v_exp_f32 v172, v72
v_cvt_pk_bf16_f32 v115, v178, v179
v_exp_f32 v173, v73
v_add_f32 v162, v162, v178
v_mfma_f32_32x32x16_bf16 a[48:63], a[244:247], v[108:111], a[48:63]
v_add_f32 v162, v162, v179
s_add_u32 s38, s57, 0
v_exp_f32 v174, v74
v_cvt_pk_bf16_f32 v116, v172, v173
v_mfma_f32_32x32x16_bf16 a[64:79], a[248:251], v[100:103], a[64:79]
v_exp_f32 v175, v75
buffer_load_dwordx4 v[204:207], v208, s[52:55], s38 offen
v_mfma_f32_32x32x16_bf16 a[80:95], a[248:251], v[108:111], a[80:95]
v_add_f32 v162, v162, v172
v_add_f32 v162, v162, v173
v_exp_f32 v176, v76
v_cvt_pk_bf16_f32 v117, v174, v175
v_mfma_f32_32x32x16_bf16 a[96:111], a[252:255], v[100:103], a[96:111]
v_exp_f32 v177, v77
v_add_f32 v162, v162, v174
v_add_f32 v162, v162, v175
v_exp_f32 v178, v78
v_mfma_f32_32x32x16_bf16 a[112:127], a[252:255], v[108:111], a[112:127]
v_cvt_pk_bf16_f32 v118, v176, v177
v_exp_f32 v179, v79
s_add_u32 s38, s57, 1048576
v_add_f32 v162, v162, v176
s_waitcnt lgkmcnt(0)
v_mfma_f32_32x32x16_bf16 v[32:47], a[192:195], a[128:131], v[128:143]
ds_read_b64_tr_b16 a[224:225], v218 offset:32768
v_add_f32 v162, v162, v177
v_exp_f32 v172, v80
ds_read_b64_tr_b16 a[226:227], v218 offset:36864
v_cvt_pk_bf16_f32 v119, v178, v179
v_mfma_f32_32x32x16_bf16 v[48:63], a[192:195], a[160:163], v[144:159]
buffer_load_dwordx4 v[204:207], v208, s[52:55], s38 offen
ds_read_b64_tr_b16 a[228:229], v219 offset:32768
v_mfma_f32_32x32x16_bf16 v[32:47], a[196:199], a[132:135], v[32:47]
v_exp_f32 v173, v81
ds_read_b64_tr_b16 a[230:231], v219 offset:36864
v_add_f32 v162, v162, v178
v_add_f32 v162, v162, v179
v_mfma_f32_32x32x16_bf16 v[48:63], a[196:199], a[164:167], v[48:63]
ds_read_b64_tr_b16 a[232:233], v220 offset:32768
v_exp_f32 v174, v82
v_cvt_pk_bf16_f32 v120, v172, v173
v_exp_f32 v175, v83
v_mfma_f32_32x32x16_bf16 v[32:47], a[200:203], a[136:139], v[32:47]
ds_read_b64_tr_b16 a[234:235], v220 offset:36864
v_add_f32 v163, v172, v173
v_exp_f32 v176, v84
ds_read_b64_tr_b16 a[236:237], v221 offset:32768
v_cvt_pk_bf16_f32 v121, v174, v175
v_mfma_f32_32x32x16_bf16 v[48:63], a[200:203], a[168:171], v[48:63]
s_add_u32 s38, s57, 0
v_exp_f32 v177, v85
ds_read_b64_tr_b16 a[238:239], v221 offset:36864
v_add_f32 v163, v163, v174
v_add_f32 v163, v163, v175
v_mfma_f32_32x32x16_bf16 v[32:47], a[204:207], a[140:143], v[32:47]
ds_read_b64_tr_b16 a[240:241], v218 offset:40960
buffer_load_dwordx4 v[204:207], v208, s[60:63], s38 offen
ds_read_b64_tr_b16 a[242:243], v218 offset:45056
v_mfma_f32_32x32x16_bf16 v[48:63], a[204:207], a[172:175], v[48:63]
v_exp_f32 v178, v86
v_cvt_pk_bf16_f32 v122, v176, v177
v_exp_f32 v179, v87
v_add_f32 v163, v163, v176
v_mfma_f32_32x32x16_bf16 v[32:47], a[208:211], a[144:147], v[32:47]
ds_read_b64_tr_b16 a[244:245], v219 offset:40960
v_add_f32 v163, v163, v177
v_exp_f32 v172, v88
ds_read_b64_tr_b16 a[246:247], v219 offset:45056
v_cvt_pk_bf16_f32 v123, v178, v179
v_mfma_f32_32x32x16_bf16 v[48:63], a[208:211], a[176:179], v[48:63]
v_exp_f32 v173, v89
ds_read_b64_tr_b16 a[248:249], v220 offset:40960
v_add_f32 v163, v163, v178
v_add_f32 v163, v163, v179
s_add_u32 s38, s57, 1048576
v_mfma_f32_32x32x16_bf16 v[32:47], a[212:215], a[148:151], v[32:47]
ds_read_b64_tr_b16 a[250:251], v220 offset:45056
v_exp_f32 v174, v90
v_cvt_pk_bf16_f32 v124, v172, v173
v_exp_f32 v175, v91
v_mfma_f32_32x32x16_bf16 v[48:63], a[212:215], a[180:183], v[48:63]
ds_read_b64_tr_b16 a[252:253], v221 offset:40960
ds_read_b64_tr_b16 a[254:255], v221 offset:45056
buffer_load_dwordx4 v[204:207], v208, s[60:63], s38 offen
v_mfma_f32_32x32x16_bf16 v[32:47], a[216:219], a[152:155], v[32:47]
v_add_f32 v163, v163, v172
v_add_f32 v163, v163, v173
v_exp_f32 v176, v92
v_cvt_pk_bf16_f32 v125, v174, v175
v_mfma_f32_32x32x16_bf16 v[48:63], a[216:219], a[184:187], v[48:63]
v_exp_f32 v177, v93
v_add_f32 v163, v163, v174
v_add_f32 v163, v163, v175
v_exp_f32 v178, v94
v_mfma_f32_32x32x16_bf16 v[32:47], a[220:223], a[156:159], v[32:47]
v_cvt_pk_bf16_f32 v126, v176, v177
v_exp_f32 v179, v95
v_add_f32 v163, v163, v176
v_add_f32 v163, v163, v177
v_cvt_pk_bf16_f32 v127, v178, v179
v_add_f32 v163, v163, v178
v_add_f32 v163, v163, v179
v_max_f32 v188, v162, v163
v_cmp_nle_f32 vcc, v188, v180
v_mfma_f32_32x32x16_bf16 v[48:63], a[220:223], a[188:191], v[48:63]
s_cbranch_vccnz attn_kernel_tr_t61
attn_kernel_back_t61:
s_waitcnt lgkmcnt(0)
v_mfma_f32_32x32x16_bf16 a[0:15], a[224:227], v[112:115], a[0:15]
s_waitcnt vmcnt(18)
s_barrier
v_mfma_f32_32x32x16_bf16 a[16:31], a[224:227], v[120:123], a[16:31]
ds_read_b128 a[192:195], v210 offset:49152
v_mfma_f32_32x32x16_bf16 a[32:47], a[228:231], v[112:115], a[32:47]
ds_read_b128 a[196:199], v211 offset:49152
v_mfma_f32_32x32x16_bf16 a[48:63], a[228:231], v[120:123], a[48:63]
ds_read_b128 a[200:203], v212 offset:49152
v_add_f32 v160, v160, v162
v_add_f32 v161, v161, v163
v_exp_f32 v172, v32
v_mfma_f32_32x32x16_bf16 a[64:79], a[232:235], v[112:115], a[64:79]
v_exp_f32 v173, v33
ds_read_b128 a[204:207], v213 offset:49152
v_exp_f32 v174, v34
v_cvt_pk_bf16_f32 v96, v172, v173
v_mfma_f32_32x32x16_bf16 a[80:95], a[232:235], v[120:123], a[80:95]
v_exp_f32 v175, v35
v_add_f32 v162, v172, v173
v_exp_f32 v176, v36
v_mfma_f32_32x32x16_bf16 a[96:111], a[236:239], v[112:115], a[96:111]
ds_read_b128 a[208:211], v214 offset:49152
v_cvt_pk_bf16_f32 v97, v174, v175
v_exp_f32 v177, v37
v_mfma_f32_32x32x16_bf16 a[112:127], a[236:239], v[120:123], a[112:127]
ds_read_b128 a[212:215], v215 offset:49152
v_add_f32 v162, v162, v174
v_add_f32 v162, v162, v175
v_exp_f32 v178, v38
v_mfma_f32_32x32x16_bf16 a[0:15], a[240:243], v[116:119], a[0:15]
ds_read_b128 a[216:219], v216 offset:49152
v_cvt_pk_bf16_f32 v98, v176, v177
v_exp_f32 v179, v39
v_add_f32 v162, v162, v176
v_mfma_f32_32x32x16_bf16 a[16:31], a[240:243], v[124:127], a[16:31]
v_add_f32 v162, v162, v177
ds_read_b128 a[220:223], v217 offset:49152
v_exp_f32 v172, v40
v_cvt_pk_bf16_f32 v99, v178, v179
v_mfma_f32_32x32x16_bf16 a[32:47], a[244:247], v[116:119], a[32:47]
v_exp_f32 v173, v41
v_add_f32 v162, v162, v178
v_add_f32 v162, v162, v179
v_mfma_f32_32x32x16_bf16 a[48:63], a[244:247], v[124:127], a[48:63]
v_exp_f32 v174, v42
v_cvt_pk_bf16_f32 v100, v172, v173
v_exp_f32 v175, v43
v_mfma_f32_32x32x16_bf16 a[64:79], a[248:251], v[116:119], a[64:79]
v_add_f32 v162, v162, v172
v_add_f32 v162, v162, v173
v_exp_f32 v176, v44
v_mfma_f32_32x32x16_bf16 a[80:95], a[248:251], v[124:127], a[80:95]
v_cvt_pk_bf16_f32 v101, v174, v175
v_exp_f32 v177, v45
v_mfma_f32_32x32x16_bf16 a[96:111], a[252:255], v[116:119], a[96:111]
v_add_f32 v162, v162, v174
v_add_f32 v162, v162, v175
v_exp_f32 v178, v46
v_mfma_f32_32x32x16_bf16 a[112:127], a[252:255], v[124:127], a[112:127]
v_cvt_pk_bf16_f32 v102, v176, v177
v_exp_f32 v179, v47
v_add_f32 v162, v162, v176
s_waitcnt lgkmcnt(0)
v_mfma_f32_32x32x16_bf16 v[64:79], a[192:195], a[128:131], v[128:143]
ds_read_b64_tr_b16 a[224:225], v218 offset:49152
v_add_f32 v162, v162, v177
v_exp_f32 v172, v48
ds_read_b64_tr_b16 a[226:227], v218 offset:53248
v_cvt_pk_bf16_f32 v103, v178, v179
v_mfma_f32_32x32x16_bf16 v[80:95], a[192:195], a[160:163], v[144:159]
ds_read_b64_tr_b16 a[228:229], v219 offset:49152
v_exp_f32 v173, v49
v_add_f32 v162, v162, v178
v_add_f32 v162, v162, v179
v_mfma_f32_32x32x16_bf16 v[64:79], a[196:199], a[132:135], v[64:79]
ds_read_b64_tr_b16 a[230:231], v219 offset:53248
v_exp_f32 v174, v50
v_cvt_pk_bf16_f32 v104, v172, v173
v_exp_f32 v175, v51
v_mfma_f32_32x32x16_bf16 v[80:95], a[196:199], a[164:167], v[80:95]
ds_read_b64_tr_b16 a[232:233], v220 offset:49152
v_add_f32 v163, v172, v173
ds_read_b64_tr_b16 a[234:235], v220 offset:53248
v_exp_f32 v176, v52
v_cvt_pk_bf16_f32 v105, v174, v175
v_mfma_f32_32x32x16_bf16 v[64:79], a[200:203], a[136:139], v[64:79]
ds_read_b64_tr_b16 a[236:237], v221 offset:49152
v_exp_f32 v177, v53
v_add_f32 v163, v163, v174
v_add_f32 v163, v163, v175
v_mfma_f32_32x32x16_bf16 v[80:95], a[200:203], a[168:171], v[80:95]
ds_read_b64_tr_b16 a[238:239], v221 offset:53248
v_exp_f32 v178, v54
v_cvt_pk_bf16_f32 v106, v176, v177
v_exp_f32 v179, v55
v_mfma_f32_32x32x16_bf16 v[64:79], a[204:207], a[140:143], v[64:79]
ds_read_b64_tr_b16 a[240:241], v218 offset:57344
v_add_f32 v163, v163, v176
ds_read_b64_tr_b16 a[242:243], v218 offset:61440
v_add_f32 v163, v163, v177
v_exp_f32 v172, v56
v_mfma_f32_32x32x16_bf16 v[80:95], a[204:207], a[172:175], v[80:95]
ds_read_b64_tr_b16 a[244:245], v219 offset:57344
v_cvt_pk_bf16_f32 v107, v178, v179
v_exp_f32 v173, v57
v_mfma_f32_32x32x16_bf16 v[64:79], a[208:211], a[144:147], v[64:79]
ds_read_b64_tr_b16 a[246:247], v219 offset:61440
v_add_f32 v163, v163, v178
v_add_f32 v163, v163, v179
v_exp_f32 v174, v58
v_mfma_f32_32x32x16_bf16 v[80:95], a[208:211], a[176:179], v[80:95]
ds_read_b64_tr_b16 a[248:249], v220 offset:57344
v_cvt_pk_bf16_f32 v108, v172, v173
v_exp_f32 v175, v59
ds_read_b64_tr_b16 a[250:251], v220 offset:61440
v_add_f32 v163, v163, v172
v_mfma_f32_32x32x16_bf16 v[64:79], a[212:215], a[148:151], v[64:79]
ds_read_b64_tr_b16 a[252:253], v221 offset:57344
v_add_f32 v163, v163, v173
v_exp_f32 v176, v60
v_cvt_pk_bf16_f32 v109, v174, v175
v_mfma_f32_32x32x16_bf16 v[80:95], a[212:215], a[180:183], v[80:95]
ds_read_b64_tr_b16 a[254:255], v221 offset:61440
v_exp_f32 v177, v61
v_add_f32 v163, v163, v174
v_add_f32 v163, v163, v175
v_mfma_f32_32x32x16_bf16 v[64:79], a[216:219], a[152:155], v[64:79]
v_exp_f32 v178, v62
v_cvt_pk_bf16_f32 v110, v176, v177
v_exp_f32 v179, v63
v_mfma_f32_32x32x16_bf16 v[80:95], a[216:219], a[184:187], v[80:95]
v_add_f32 v163, v163, v176
v_add_f32 v163, v163, v177
v_cvt_pk_bf16_f32 v111, v178, v179
v_mfma_f32_32x32x16_bf16 v[64:79], a[220:223], a[156:159], v[64:79]
v_add_f32 v163, v163, v178
v_add_f32 v163, v163, v179
v_max_f32 v188, v162, v163
v_cmp_nle_f32 vcc, v188, v180
v_mfma_f32_32x32x16_bf16 v[80:95], a[220:223], a[188:191], v[80:95]
s_cbranch_vccnz attn_kernel_tr_t62
attn_kernel_back_t62:
s_waitcnt lgkmcnt(0)
v_mfma_f32_32x32x16_bf16 a[0:15], a[224:227], v[96:99], a[0:15]
s_waitcnt vmcnt(14)
s_barrier
v_mfma_f32_32x32x16_bf16 a[16:31], a[224:227], v[104:107], a[16:31]
v_mfma_f32_32x32x16_bf16 a[32:47], a[228:231], v[96:99], a[32:47]
v_mfma_f32_32x32x16_bf16 a[48:63], a[228:231], v[104:107], a[48:63]
v_mfma_f32_32x32x16_bf16 a[64:79], a[232:235], v[96:99], a[64:79]
v_mfma_f32_32x32x16_bf16 a[80:95], a[232:235], v[104:107], a[80:95]
v_mfma_f32_32x32x16_bf16 a[96:111], a[236:239], v[96:99], a[96:111]
v_add_f32 v160, v160, v162
v_add_f32 v161, v161, v163
v_exp_f32 v172, v64
v_exp_f32 v173, v65
v_mfma_f32_32x32x16_bf16 a[112:127], a[236:239], v[104:107], a[112:127]
v_exp_f32 v174, v66
v_cvt_pk_bf16_f32 v112, v172, v173
v_exp_f32 v175, v67
v_add_f32 v162, v172, v173
v_mfma_f32_32x32x16_bf16 a[0:15], a[240:243], v[100:103], a[0:15]
v_exp_f32 v176, v68
v_cvt_pk_bf16_f32 v113, v174, v175
v_exp_f32 v177, v69
v_add_f32 v162, v162, v174
v_mfma_f32_32x32x16_bf16 a[16:31], a[240:243], v[108:111], a[16:31]
v_add_f32 v162, v162, v175
v_exp_f32 v178, v70
v_cvt_pk_bf16_f32 v114, v176, v177
v_exp_f32 v179, v71
v_mfma_f32_32x32x16_bf16 a[32:47], a[244:247], v[100:103], a[32:47]
v_add_f32 v162, v162, v176
v_add_f32 v162, v162, v177
v_exp_f32 v172, v72
v_cvt_pk_bf16_f32 v115, v178, v179
v_mfma_f32_32x32x16_bf16 a[48:63], a[244:247], v[108:111], a[48:63]
v_exp_f32 v173, v73
v_add_f32 v162, v162, v178
v_add_f32 v162, v162, v179
v_exp_f32 v174, v74
v_mfma_f32_32x32x16_bf16 a[64:79], a[248:251], v[100:103], a[64:79]
v_cvt_pk_bf16_f32 v116, v172, v173
v_exp_f32 v175, v75
v_add_f32 v162, v162, v172
v_add_f32 v162, v162, v173
v_mfma_f32_32x32x16_bf16 a[80:95], a[248:251], v[108:111], a[80:95]
v_exp_f32 v176, v76
v_cvt_pk_bf16_f32 v117, v174, v175
v_exp_f32 v177, v77
v_add_f32 v162, v162, v174
v_mfma_f32_32x32x16_bf16 a[96:111], a[252:255], v[100:103], a[96:111]
v_add_f32 v162, v162, v175
v_exp_f32 v178, v78
v_cvt_pk_bf16_f32 v118, v176, v177
v_exp_f32 v179, v79
v_add_f32 v162, v162, v176
v_add_f32 v162, v162, v177
v_exp_f32 v172, v80
v_cvt_pk_bf16_f32 v119, v178, v179
v_exp_f32 v173, v81
v_add_f32 v162, v162, v178
v_add_f32 v162, v162, v179
v_exp_f32 v174, v82
v_cvt_pk_bf16_f32 v120, v172, v173
v_exp_f32 v175, v83
v_add_f32 v163, v172, v173
v_exp_f32 v176, v84
v_cvt_pk_bf16_f32 v121, v174, v175
v_exp_f32 v177, v85
v_add_f32 v163, v163, v174
v_add_f32 v163, v163, v175
v_exp_f32 v178, v86
v_cvt_pk_bf16_f32 v122, v176, v177
v_exp_f32 v179, v87
v_add_f32 v163, v163, v176
v_add_f32 v163, v163, v177
v_exp_f32 v172, v88
v_cvt_pk_bf16_f32 v123, v178, v179
v_exp_f32 v173, v89
v_add_f32 v163, v163, v178
v_add_f32 v163, v163, v179
v_exp_f32 v174, v90
v_cvt_pk_bf16_f32 v124, v172, v173
v_exp_f32 v175, v91
v_add_f32 v163, v163, v172
v_add_f32 v163, v163, v173
v_exp_f32 v176, v92
v_cvt_pk_bf16_f32 v125, v174, v175
v_exp_f32 v177, v93
v_add_f32 v163, v163, v174
v_add_f32 v163, v163, v175
v_exp_f32 v178, v94
v_cvt_pk_bf16_f32 v126, v176, v177
v_exp_f32 v179, v95
v_add_f32 v163, v163, v176
v_add_f32 v163, v163, v177
v_cvt_pk_bf16_f32 v127, v178, v179
v_add_f32 v163, v163, v178
v_add_f32 v163, v163, v179
v_max_f32 v188, v162, v163
v_cmp_nle_f32 vcc, v188, v180
v_mfma_f32_32x32x16_bf16 a[112:127], a[252:255], v[108:111], a[112:127]
ds_read_b64_tr_b16 a[224:225], v24 offset:0
ds_read_b64_tr_b16 a[226:227], v24 offset:4096
ds_read_b64_tr_b16 a[228:229], v25 offset:0
ds_read_b64_tr_b16 a[230:231], v25 offset:4096
ds_read_b64_tr_b16 a[232:233], v26 offset:0
ds_read_b64_tr_b16 a[234:235], v26 offset:4096
ds_read_b64_tr_b16 a[236:237], v27 offset:0
ds_read_b64_tr_b16 a[238:239], v27 offset:4096
ds_read_b64_tr_b16 a[240:241], v24 offset:8192
ds_read_b64_tr_b16 a[242:243], v24 offset:12288
ds_read_b64_tr_b16 a[244:245], v25 offset:8192
ds_read_b64_tr_b16 a[246:247], v25 offset:12288
ds_read_b64_tr_b16 a[248:249], v26 offset:8192
ds_read_b64_tr_b16 a[250:251], v26 offset:12288
ds_read_b64_tr_b16 a[252:253], v27 offset:8192
ds_read_b64_tr_b16 a[254:255], v27 offset:12288
s_cbranch_vccnz attn_kernel_tr_t63
attn_kernel_back_t63:
s_getpc_b64 s[60:61]
cpf_attn:
s_add_u32 s60, s60, wo_kernel-cpf_attn
s_addc_u32 s61, s61, (wo_kernel-cpf_attn)>>31
s_lshr_b32 s62, s2, 3
s_mul_i32 s62, s62, 4096
v_lshrrev_b32 v236, 6, v0
v_mul_u32_u24 v236, 0, v236
v_lshl_add_u32 v236, v0, 4, v236
v_add_u32 v236, s62, v236
v_min_u32 v237, code_end-wo_kernel-16, v236
global_load_dwordx4 v[240:243], v237, s[60:61]
v_add_f32 v160, v160, v162
v_mov_b32 v190, v160
v_add_f32 v161, v161, v163
v_mov_b32 v191, v161
s_nop 1
v_permlane32_swap_b32 v160, v190
v_permlane32_swap_b32 v161, v191
v_add_f32 v160, v160, v190
v_add_f32 v161, v161, v191
v_rcp_f32 v188, v160
v_rcp_f32 v189, v161
s_waitcnt lgkmcnt(0)
v_mfma_f32_32x32x16_bf16 a[0:15], a[224:227], v[112:115], a[0:15]
v_mfma_f32_32x32x16_bf16 a[16:31], a[224:227], v[120:123], a[16:31]
v_mfma_f32_32x32x16_bf16 a[32:47], a[228:231], v[112:115], a[32:47]
v_mfma_f32_32x32x16_bf16 a[48:63], a[228:231], v[120:123], a[48:63]
v_mfma_f32_32x32x16_bf16 a[64:79], a[232:235], v[112:115], a[64:79]
v_mfma_f32_32x32x16_bf16 a[80:95], a[232:235], v[120:123], a[80:95]
v_mfma_f32_32x32x16_bf16 a[96:111], a[236:239], v[112:115], a[96:111]
v_mfma_f32_32x32x16_bf16 a[112:127], a[236:239], v[120:123], a[112:127]
v_mfma_f32_32x32x16_bf16 a[0:15], a[240:243], v[116:119], a[0:15]
v_mfma_f32_32x32x16_bf16 a[16:31], a[240:243], v[124:127], a[16:31]
v_mfma_f32_32x32x16_bf16 a[32:47], a[244:247], v[116:119], a[32:47]
v_mfma_f32_32x32x16_bf16 a[48:63], a[244:247], v[124:127], a[48:63]
v_mfma_f32_32x32x16_bf16 a[64:79], a[248:251], v[116:119], a[64:79]
s_nop 7
v_accvgpr_read_b32 v32, a0
v_accvgpr_read_b32 v33, a1
v_accvgpr_read_b32 v34, a2
v_accvgpr_read_b32 v35, a3
v_accvgpr_read_b32 v36, a4
v_mfma_f32_32x32x16_bf16 a[80:95], a[248:251], v[124:127], a[80:95]
v_accvgpr_read_b32 v37, a5
v_accvgpr_read_b32 v38, a6
v_accvgpr_read_b32 v39, a7
v_mul_f32 v32, v32, v188
v_mul_f32 v33, v33, v188
v_mul_f32 v34, v34, v188
v_mfma_f32_32x32x16_bf16 a[96:111], a[252:255], v[116:119], a[96:111]
v_mul_f32 v35, v35, v188
v_mul_f32 v36, v36, v188
v_mul_f32 v37, v37, v188
v_mul_f32 v38, v38, v188
v_mul_f32 v39, v39, v188
v_cvt_pk_bf16_f32 v128, v32, v33
v_mfma_f32_32x32x16_bf16 a[112:127], a[252:255], v[124:127], a[112:127]
v_cvt_pk_bf16_f32 v129, v34, v35
v_cvt_pk_bf16_f32 v130, v36, v37
v_cvt_pk_bf16_f32 v131, v38, v39
buffer_store_dwordx4 v[128:131], v186, s[24:27], s44 offen offset:0 sc0 sc1
v_accvgpr_read_b32 v40, a8
v_accvgpr_read_b32 v41, a9
v_accvgpr_read_b32 v42, a10
v_accvgpr_read_b32 v43, a11
v_accvgpr_read_b32 v44, a12
v_accvgpr_read_b32 v45, a13
v_accvgpr_read_b32 v46, a14
v_accvgpr_read_b32 v47, a15
v_mul_f32 v40, v40, v188
v_mul_f32 v41, v41, v188
v_mul_f32 v42, v42, v188
v_mul_f32 v43, v43, v188
v_mul_f32 v44, v44, v188
v_mul_f32 v45, v45, v188
v_mul_f32 v46, v46, v188
v_mul_f32 v47, v47, v188
v_cvt_pk_bf16_f32 v132, v40, v41
v_cvt_pk_bf16_f32 v133, v42, v43
v_cvt_pk_bf16_f32 v134, v44, v45
v_cvt_pk_bf16_f32 v135, v46, v47
buffer_store_dwordx4 v[132:135], v186, s[24:27], s44 offen offset:1024 sc0 sc1
v_accvgpr_read_b32 v48, a16
v_accvgpr_read_b32 v49, a17
v_accvgpr_read_b32 v50, a18
v_accvgpr_read_b32 v51, a19
v_accvgpr_read_b32 v52, a20
v_accvgpr_read_b32 v53, a21
v_accvgpr_read_b32 v54, a22
v_accvgpr_read_b32 v55, a23
v_mul_f32 v48, v48, v189
v_mul_f32 v49, v49, v189
v_mul_f32 v50, v50, v189
v_mul_f32 v51, v51, v189
v_mul_f32 v52, v52, v189
v_mul_f32 v53, v53, v189
v_mul_f32 v54, v54, v189
v_mul_f32 v55, v55, v189
v_cvt_pk_bf16_f32 v136, v48, v49
v_cvt_pk_bf16_f32 v137, v50, v51
v_cvt_pk_bf16_f32 v138, v52, v53
v_cvt_pk_bf16_f32 v139, v54, v55
buffer_store_dwordx4 v[136:139], v186, s[24:27], s46 offen offset:0 sc0 sc1
v_accvgpr_read_b32 v56, a24
v_accvgpr_read_b32 v57, a25
v_accvgpr_read_b32 v58, a26
v_accvgpr_read_b32 v59, a27
v_accvgpr_read_b32 v60, a28
v_accvgpr_read_b32 v61, a29
v_accvgpr_read_b32 v62, a30
v_accvgpr_read_b32 v63, a31
v_mul_f32 v56, v56, v189
v_mul_f32 v57, v57, v189
v_mul_f32 v58, v58, v189
v_mul_f32 v59, v59, v189
v_mul_f32 v60, v60, v189
v_mul_f32 v61, v61, v189
v_mul_f32 v62, v62, v189
v_mul_f32 v63, v63, v189
v_cvt_pk_bf16_f32 v140, v56, v57
v_cvt_pk_bf16_f32 v141, v58, v59
v_cvt_pk_bf16_f32 v142, v60, v61
v_cvt_pk_bf16_f32 v143, v62, v63
buffer_store_dwordx4 v[140:143], v186, s[24:27], s46 offen offset:1024 sc0 sc1
v_accvgpr_read_b32 v64, a32
v_accvgpr_read_b32 v65, a33
v_accvgpr_read_b32 v66, a34
v_accvgpr_read_b32 v67, a35
v_accvgpr_read_b32 v68, a36
v_accvgpr_read_b32 v69, a37
v_accvgpr_read_b32 v70, a38
v_accvgpr_read_b32 v71, a39
v_mul_f32 v64, v64, v188
v_mul_f32 v65, v65, v188
v_mul_f32 v66, v66, v188
v_mul_f32 v67, v67, v188
v_mul_f32 v68, v68, v188
v_mul_f32 v69, v69, v188
v_mul_f32 v70, v70, v188
v_mul_f32 v71, v71, v188
v_cvt_pk_bf16_f32 v144, v64, v65
v_cvt_pk_bf16_f32 v145, v66, v67
v_cvt_pk_bf16_f32 v146, v68, v69
v_cvt_pk_bf16_f32 v147, v70, v71
buffer_store_dwordx4 v[144:147], v186, s[24:27], s44 offen offset:2048 sc0 sc1
v_accvgpr_read_b32 v72, a40
v_accvgpr_read_b32 v73, a41
v_accvgpr_read_b32 v74, a42
v_accvgpr_read_b32 v75, a43
v_accvgpr_read_b32 v76, a44
v_accvgpr_read_b32 v77, a45
v_accvgpr_read_b32 v78, a46
v_accvgpr_read_b32 v79, a47
v_mul_f32 v72, v72, v188
v_mul_f32 v73, v73, v188
v_mul_f32 v74, v74, v188
v_mul_f32 v75, v75, v188
v_mul_f32 v76, v76, v188
v_mul_f32 v77, v77, v188
v_mul_f32 v78, v78, v188
v_mul_f32 v79, v79, v188
v_cvt_pk_bf16_f32 v148, v72, v73
v_cvt_pk_bf16_f32 v149, v74, v75
v_cvt_pk_bf16_f32 v150, v76, v77
v_cvt_pk_bf16_f32 v151, v78, v79
buffer_store_dwordx4 v[148:151], v186, s[24:27], s44 offen offset:3072 sc0 sc1
v_accvgpr_read_b32 v80, a48
v_accvgpr_read_b32 v81, a49
v_accvgpr_read_b32 v82, a50
v_accvgpr_read_b32 v83, a51
v_accvgpr_read_b32 v84, a52
v_accvgpr_read_b32 v85, a53
v_accvgpr_read_b32 v86, a54
v_accvgpr_read_b32 v87, a55
v_mul_f32 v80, v80, v189
v_mul_f32 v81, v81, v189
v_mul_f32 v82, v82, v189
v_mul_f32 v83, v83, v189
v_mul_f32 v84, v84, v189
v_mul_f32 v85, v85, v189
v_mul_f32 v86, v86, v189
v_mul_f32 v87, v87, v189
v_cvt_pk_bf16_f32 v152, v80, v81
v_cvt_pk_bf16_f32 v153, v82, v83
v_cvt_pk_bf16_f32 v154, v84, v85
v_cvt_pk_bf16_f32 v155, v86, v87
buffer_store_dwordx4 v[152:155], v186, s[24:27], s46 offen offset:2048 sc0 sc1
v_accvgpr_read_b32 v88, a56
v_accvgpr_read_b32 v89, a57
v_accvgpr_read_b32 v90, a58
v_accvgpr_read_b32 v91, a59
v_accvgpr_read_b32 v92, a60
v_accvgpr_read_b32 v93, a61
v_accvgpr_read_b32 v94, a62
v_accvgpr_read_b32 v95, a63
v_mul_f32 v88, v88, v189
v_mul_f32 v89, v89, v189
v_mul_f32 v90, v90, v189
v_mul_f32 v91, v91, v189
v_mul_f32 v92, v92, v189
v_mul_f32 v93, v93, v189
v_mul_f32 v94, v94, v189
v_mul_f32 v95, v95, v189
v_cvt_pk_bf16_f32 v156, v88, v89
v_cvt_pk_bf16_f32 v157, v90, v91
v_cvt_pk_bf16_f32 v158, v92, v93
v_cvt_pk_bf16_f32 v159, v94, v95
buffer_store_dwordx4 v[156:159], v186, s[24:27], s46 offen offset:3072 sc0 sc1
v_accvgpr_read_b32 v32, a64
v_accvgpr_read_b32 v33, a65
v_accvgpr_read_b32 v34, a66
v_accvgpr_read_b32 v35, a67
v_accvgpr_read_b32 v36, a68
v_accvgpr_read_b32 v37, a69
v_accvgpr_read_b32 v38, a70
v_accvgpr_read_b32 v39, a71
v_mul_f32 v32, v32, v188
v_mul_f32 v33, v33, v188
v_mul_f32 v34, v34, v188
v_mul_f32 v35, v35, v188
v_mul_f32 v36, v36, v188
v_mul_f32 v37, v37, v188
v_mul_f32 v38, v38, v188
v_mul_f32 v39, v39, v188
v_cvt_pk_bf16_f32 v128, v32, v33
v_cvt_pk_bf16_f32 v129, v34, v35
v_cvt_pk_bf16_f32 v130, v36, v37
v_cvt_pk_bf16_f32 v131, v38, v39
buffer_store_dwordx4 v[128:131], v186, s[24:27], s45 offen offset:0 sc0 sc1
v_accvgpr_read_b32 v40, a72
v_accvgpr_read_b32 v41, a73
v_accvgpr_read_b32 v42, a74
v_accvgpr_read_b32 v43, a75
v_accvgpr_read_b32 v44, a76
v_accvgpr_read_b32 v45, a77
v_accvgpr_read_b32 v46, a78
v_accvgpr_read_b32 v47, a79
v_mul_f32 v40, v40, v188
v_mul_f32 v41, v41, v188
v_mul_f32 v42, v42, v188
v_mul_f32 v43, v43, v188
v_mul_f32 v44, v44, v188
v_mul_f32 v45, v45, v188
v_mul_f32 v46, v46, v188
v_mul_f32 v47, v47, v188
v_cvt_pk_bf16_f32 v132, v40, v41
v_cvt_pk_bf16_f32 v133, v42, v43
v_cvt_pk_bf16_f32 v134, v44, v45
v_cvt_pk_bf16_f32 v135, v46, v47
buffer_store_dwordx4 v[132:135], v186, s[24:27], s45 offen offset:1024 sc0 sc1
v_accvgpr_read_b32 v48, a80
v_accvgpr_read_b32 v49, a81
v_accvgpr_read_b32 v50, a82
v_accvgpr_read_b32 v51, a83
v_accvgpr_read_b32 v52, a84
v_accvgpr_read_b32 v53, a85
v_accvgpr_read_b32 v54, a86
v_accvgpr_read_b32 v55, a87
v_mul_f32 v48, v48, v189
v_mul_f32 v49, v49, v189
v_mul_f32 v50, v50, v189
v_mul_f32 v51, v51, v189
v_mul_f32 v52, v52, v189
v_mul_f32 v53, v53, v189
v_mul_f32 v54, v54, v189
v_mul_f32 v55, v55, v189
v_cvt_pk_bf16_f32 v136, v48, v49
v_cvt_pk_bf16_f32 v137, v50, v51
v_cvt_pk_bf16_f32 v138, v52, v53
v_cvt_pk_bf16_f32 v139, v54, v55
buffer_store_dwordx4 v[136:139], v186, s[24:27], s47 offen offset:0 sc0 sc1
v_accvgpr_read_b32 v56, a88
v_accvgpr_read_b32 v57, a89
v_accvgpr_read_b32 v58, a90
v_accvgpr_read_b32 v59, a91
v_accvgpr_read_b32 v60, a92
v_accvgpr_read_b32 v61, a93
v_accvgpr_read_b32 v62, a94
v_accvgpr_read_b32 v63, a95
v_mul_f32 v56, v56, v189
v_mul_f32 v57, v57, v189
v_mul_f32 v58, v58, v189
v_mul_f32 v59, v59, v189
v_mul_f32 v60, v60, v189
v_mul_f32 v61, v61, v189
v_mul_f32 v62, v62, v189
v_mul_f32 v63, v63, v189
v_cvt_pk_bf16_f32 v140, v56, v57
v_cvt_pk_bf16_f32 v141, v58, v59
v_cvt_pk_bf16_f32 v142, v60, v61
v_cvt_pk_bf16_f32 v143, v62, v63
buffer_store_dwordx4 v[140:143], v186, s[24:27], s47 offen offset:1024 sc0 sc1
s_nop 0
v_accvgpr_read_b32 v64, a96
v_accvgpr_read_b32 v65, a97
v_accvgpr_read_b32 v66, a98
v_accvgpr_read_b32 v67, a99
v_accvgpr_read_b32 v68, a100
v_accvgpr_read_b32 v69, a101
v_accvgpr_read_b32 v70, a102
v_accvgpr_read_b32 v71, a103
v_mul_f32 v64, v64, v188
v_mul_f32 v65, v65, v188
v_mul_f32 v66, v66, v188
v_mul_f32 v67, v67, v188
v_mul_f32 v68, v68, v188
v_mul_f32 v69, v69, v188
v_mul_f32 v70, v70, v188
v_mul_f32 v71, v71, v188
v_cvt_pk_bf16_f32 v144, v64, v65
v_cvt_pk_bf16_f32 v145, v66, v67
v_cvt_pk_bf16_f32 v146, v68, v69
v_cvt_pk_bf16_f32 v147, v70, v71
buffer_store_dwordx4 v[144:147], v186, s[24:27], s45 offen offset:2048 sc0 sc1
v_accvgpr_read_b32 v72, a104
v_accvgpr_read_b32 v73, a105
v_accvgpr_read_b32 v74, a106
v_accvgpr_read_b32 v75, a107
v_accvgpr_read_b32 v76, a108
v_accvgpr_read_b32 v77, a109
v_accvgpr_read_b32 v78, a110
v_accvgpr_read_b32 v79, a111
v_mul_f32 v72, v72, v188
v_mul_f32 v73, v73, v188
v_mul_f32 v74, v74, v188
v_mul_f32 v75, v75, v188
v_mul_f32 v76, v76, v188
v_mul_f32 v77, v77, v188
v_mul_f32 v78, v78, v188
v_mul_f32 v79, v79, v188
v_cvt_pk_bf16_f32 v148, v72, v73
v_cvt_pk_bf16_f32 v149, v74, v75
v_cvt_pk_bf16_f32 v150, v76, v77
v_cvt_pk_bf16_f32 v151, v78, v79
buffer_store_dwordx4 v[148:151], v186, s[24:27], s45 offen offset:3072 sc0 sc1
v_accvgpr_read_b32 v80, a112
v_accvgpr_read_b32 v81, a113
v_accvgpr_read_b32 v82, a114
v_accvgpr_read_b32 v83, a115
v_accvgpr_read_b32 v84, a116
v_accvgpr_read_b32 v85, a117
v_accvgpr_read_b32 v86, a118
v_accvgpr_read_b32 v87, a119
v_mul_f32 v80, v80, v189
v_mul_f32 v81, v81, v189
v_mul_f32 v82, v82, v189
v_mul_f32 v83, v83, v189
v_mul_f32 v84, v84, v189
v_mul_f32 v85, v85, v189
v_mul_f32 v86, v86, v189
v_mul_f32 v87, v87, v189
v_cvt_pk_bf16_f32 v152, v80, v81
v_cvt_pk_bf16_f32 v153, v82, v83
v_cvt_pk_bf16_f32 v154, v84, v85
v_cvt_pk_bf16_f32 v155, v86, v87
buffer_store_dwordx4 v[152:155], v186, s[24:27], s47 offen offset:2048 sc0 sc1
v_accvgpr_read_b32 v88, a120
v_accvgpr_read_b32 v89, a121
v_accvgpr_read_b32 v90, a122
v_accvgpr_read_b32 v91, a123
v_accvgpr_read_b32 v92, a124
v_accvgpr_read_b32 v93, a125
v_accvgpr_read_b32 v94, a126
v_accvgpr_read_b32 v95, a127
v_mul_f32 v88, v88, v189
v_mul_f32 v89, v89, v189
v_mul_f32 v90, v90, v189
v_mul_f32 v91, v91, v189
v_mul_f32 v92, v92, v189
v_mul_f32 v93, v93, v189
v_mul_f32 v94, v94, v189
v_mul_f32 v95, v95, v189
v_cvt_pk_bf16_f32 v156, v88, v89
v_cvt_pk_bf16_f32 v157, v90, v91
v_cvt_pk_bf16_f32 v158, v92, v93
v_cvt_pk_bf16_f32 v159, v94, v95
buffer_store_dwordx4 v[156:159], v186, s[24:27], s47 offen offset:3072 sc0 sc1
attn_kernel_done:
s_endpgm
attn_kernel_tr_p0:
s_call_b64 s[40:41], attn_kernel_rare0
s_branch attn_kernel_back_p0
attn_kernel_tr_p1:
s_call_b64 s[40:41], attn_kernel_rare1
s_branch attn_kernel_back_p1
attn_kernel_tr_l0:
s_call_b64 s[40:41], attn_kernel_rare0
s_branch attn_kernel_back_l0
attn_kernel_tr_l1:
s_call_b64 s[40:41], attn_kernel_rare1
s_branch attn_kernel_back_l1
attn_kernel_tr_l2:
s_call_b64 s[40:41], attn_kernel_rare0
s_branch attn_kernel_back_l2
attn_kernel_tr_l3:
s_call_b64 s[40:41], attn_kernel_rare1
s_branch attn_kernel_back_l3
attn_kernel_tr_l4:
s_call_b64 s[40:41], attn_kernel_rare0
s_branch attn_kernel_back_l4
attn_kernel_tr_l5:
s_call_b64 s[40:41], attn_kernel_rare1
s_branch attn_kernel_back_l5
attn_kernel_tr_l6:
s_call_b64 s[40:41], attn_kernel_rare0
s_branch attn_kernel_back_l6
attn_kernel_tr_l7:
s_call_b64 s[40:41], attn_kernel_rare1
s_branch attn_kernel_back_l7
attn_kernel_tr_t58:
s_call_b64 s[40:41], attn_kernel_rare0
s_branch attn_kernel_back_t58
attn_kernel_tr_t59:
s_call_b64 s[40:41], attn_kernel_rare1
s_branch attn_kernel_back_t59
attn_kernel_tr_t60:
s_call_b64 s[40:41], attn_kernel_rare0
s_branch attn_kernel_back_t60
attn_kernel_tr_t61:
s_call_b64 s[40:41], attn_kernel_rare1
s_branch attn_kernel_back_t61
attn_kernel_tr_t62:
s_call_b64 s[40:41], attn_kernel_rare0
s_branch attn_kernel_back_t62
attn_kernel_tr_t63:
s_call_b64 s[40:41], attn_kernel_rare1
s_branch attn_kernel_back_t63
attn_kernel_rare0:
s_nop 15
s_nop 15
v_max_f32 v189, v32, v33
v_max3_f32 v189, v189, v34, v35
v_max3_f32 v189, v189, v36, v37
v_max3_f32 v189, v189, v38, v39
v_max3_f32 v189, v189, v40, v41
v_max3_f32 v189, v189, v42, v43
v_max3_f32 v189, v189, v44, v45
v_max3_f32 v189, v189, v46, v47
v_mov_b32 v190, v189
s_nop 1
v_permlane32_swap_b32 v189, v190
v_max_f32 v189, v189, v190
v_ceil_f32 v189, v189
v_add_f32 v189, 0x42c00000, v189
v_max_f32 v189, 0, v189
v_cvt_i32_f32 v191, v189
v_sub_u32 v191, 0, v191
v_sub_f32 v128, v128, v189
v_mov_b32 v129, v128
v_mov_b32 v130, v128
v_mov_b32 v131, v128
v_mov_b32 v132, v128
v_mov_b32 v133, v128
v_mov_b32 v134, v128
v_mov_b32 v135, v128
v_mov_b32 v136, v128
v_mov_b32 v137, v128
v_mov_b32 v138, v128
v_mov_b32 v139, v128
v_mov_b32 v140, v128
v_mov_b32 v141, v128
v_mov_b32 v142, v128
v_mov_b32 v143, v128
v_sub_f32 v32, v32, v189
v_sub_f32 v33, v33, v189
v_sub_f32 v34, v34, v189
v_sub_f32 v35, v35, v189
v_sub_f32 v36, v36, v189
v_sub_f32 v37, v37, v189
v_sub_f32 v38, v38, v189
v_sub_f32 v39, v39, v189
v_sub_f32 v40, v40, v189
v_sub_f32 v41, v41, v189
v_sub_f32 v42, v42, v189
v_sub_f32 v43, v43, v189
v_sub_f32 v44, v44, v189
v_sub_f32 v45, v45, v189
v_sub_f32 v46, v46, v189
v_sub_f32 v47, v47, v189
v_sub_f32 v64, v64, v189
v_sub_f32 v65, v65, v189
v_sub_f32 v66, v66, v189
v_sub_f32 v67, v67, v189
v_sub_f32 v68, v68, v189
v_sub_f32 v69, v69, v189
v_sub_f32 v70, v70, v189
v_sub_f32 v71, v71, v189
v_sub_f32 v72, v72, v189
v_sub_f32 v73, v73, v189
v_sub_f32 v74, v74, v189
v_sub_f32 v75, v75, v189
v_sub_f32 v76, v76, v189
v_sub_f32 v77, v77, v189
v_sub_f32 v78, v78, v189
v_sub_f32 v79, v79, v189
v_mov_b32 v162, 0
v_exp_f32 v192, v32
v_exp_f32 v193, v33
s_nop 0
v_cvt_pk_bf16_f32 v96, v192, v193
v_add_f32 v162, v162, v192
v_add_f32 v162, v162, v193
v_exp_f32 v192, v34
v_exp_f32 v193, v35
s_nop 0
v_cvt_pk_bf16_f32 v97, v192, v193
v_add_f32 v162, v162, v192
v_add_f32 v162, v162, v193
v_exp_f32 v192, v36
v_exp_f32 v193, v37
s_nop 0
v_cvt_pk_bf16_f32 v98, v192, v193
v_add_f32 v162, v162, v192
v_add_f32 v162, v162, v193
v_exp_f32 v192, v38
v_exp_f32 v193, v39
s_nop 0
v_cvt_pk_bf16_f32 v99, v192, v193
v_add_f32 v162, v162, v192
v_add_f32 v162, v162, v193
v_exp_f32 v192, v40
v_exp_f32 v193, v41
s_nop 0
v_cvt_pk_bf16_f32 v100, v192, v193
v_add_f32 v162, v162, v192
v_add_f32 v162, v162, v193
v_exp_f32 v192, v42
v_exp_f32 v193, v43
s_nop 0
v_cvt_pk_bf16_f32 v101, v192, v193
v_add_f32 v162, v162, v192
v_add_f32 v162, v162, v193
v_exp_f32 v192, v44
v_exp_f32 v193, v45
s_nop 0
v_cvt_pk_bf16_f32 v102, v192, v193
v_add_f32 v162, v162, v192
v_add_f32 v162, v162, v193
v_exp_f32 v192, v46
v_exp_f32 v193, v47
s_nop 0
v_cvt_pk_bf16_f32 v103, v192, v193
v_add_f32 v162, v162, v192
v_add_f32 v162, v162, v193
v_ldexp_f32 v160, v160, v191
v_accvgpr_read_b32 v192, a0
v_accvgpr_read_b32 v193, a1
v_accvgpr_read_b32 v194, a2
v_accvgpr_read_b32 v195, a3
v_ldexp_f32 v192, v192, v191
v_ldexp_f32 v193, v193, v191
v_ldexp_f32 v194, v194, v191
v_ldexp_f32 v195, v195, v191
v_accvgpr_write_b32 a0, v192
v_accvgpr_write_b32 a1, v193
v_accvgpr_write_b32 a2, v194
v_accvgpr_write_b32 a3, v195
v_accvgpr_read_b32 v192, a4
v_accvgpr_read_b32 v193, a5
v_accvgpr_read_b32 v194, a6
v_accvgpr_read_b32 v195, a7
v_ldexp_f32 v192, v192, v191
v_ldexp_f32 v193, v193, v191
v_ldexp_f32 v194, v194, v191
v_ldexp_f32 v195, v195, v191
v_accvgpr_write_b32 a4, v192
v_accvgpr_write_b32 a5, v193
v_accvgpr_write_b32 a6, v194
v_accvgpr_write_b32 a7, v195
v_accvgpr_read_b32 v192, a8
v_accvgpr_read_b32 v193, a9
v_accvgpr_read_b32 v194, a10
v_accvgpr_read_b32 v195, a11
v_ldexp_f32 v192, v192, v191
v_ldexp_f32 v193, v193, v191
v_ldexp_f32 v194, v194, v191
v_ldexp_f32 v195, v195, v191
v_accvgpr_write_b32 a8, v192
v_accvgpr_write_b32 a9, v193
v_accvgpr_write_b32 a10, v194
v_accvgpr_write_b32 a11, v195
v_accvgpr_read_b32 v192, a12
v_accvgpr_read_b32 v193, a13
v_accvgpr_read_b32 v194, a14
v_accvgpr_read_b32 v195, a15
v_ldexp_f32 v192, v192, v191
v_ldexp_f32 v193, v193, v191
v_ldexp_f32 v194, v194, v191
v_ldexp_f32 v195, v195, v191
v_accvgpr_write_b32 a12, v192
v_accvgpr_write_b32 a13, v193
v_accvgpr_write_b32 a14, v194
v_accvgpr_write_b32 a15, v195
v_accvgpr_read_b32 v192, a32
v_accvgpr_read_b32 v193, a33
v_accvgpr_read_b32 v194, a34
v_accvgpr_read_b32 v195, a35
v_ldexp_f32 v192, v192, v191
v_ldexp_f32 v193, v193, v191
v_ldexp_f32 v194, v194, v191
v_ldexp_f32 v195, v195, v191
v_accvgpr_write_b32 a32, v192
v_accvgpr_write_b32 a33, v193
v_accvgpr_write_b32 a34, v194
v_accvgpr_write_b32 a35, v195
v_accvgpr_read_b32 v192, a36
v_accvgpr_read_b32 v193, a37
v_accvgpr_read_b32 v194, a38
v_accvgpr_read_b32 v195, a39
v_ldexp_f32 v192, v192, v191
v_ldexp_f32 v193, v193, v191
v_ldexp_f32 v194, v194, v191
v_ldexp_f32 v195, v195, v191
v_accvgpr_write_b32 a36, v192
v_accvgpr_write_b32 a37, v193
v_accvgpr_write_b32 a38, v194
v_accvgpr_write_b32 a39, v195
v_accvgpr_read_b32 v192, a40
v_accvgpr_read_b32 v193, a41
v_accvgpr_read_b32 v194, a42
v_accvgpr_read_b32 v195, a43
v_ldexp_f32 v192, v192, v191
v_ldexp_f32 v193, v193, v191
v_ldexp_f32 v194, v194, v191
v_ldexp_f32 v195, v195, v191
v_accvgpr_write_b32 a40, v192
v_accvgpr_write_b32 a41, v193
v_accvgpr_write_b32 a42, v194
v_accvgpr_write_b32 a43, v195
v_accvgpr_read_b32 v192, a44
v_accvgpr_read_b32 v193, a45
v_accvgpr_read_b32 v194, a46
v_accvgpr_read_b32 v195, a47
v_ldexp_f32 v192, v192, v191
v_ldexp_f32 v193, v193, v191
v_ldexp_f32 v194, v194, v191
v_ldexp_f32 v195, v195, v191
v_accvgpr_write_b32 a44, v192
v_accvgpr_write_b32 a45, v193
v_accvgpr_write_b32 a46, v194
v_accvgpr_write_b32 a47, v195
v_accvgpr_read_b32 v192, a64
v_accvgpr_read_b32 v193, a65
v_accvgpr_read_b32 v194, a66
v_accvgpr_read_b32 v195, a67
v_ldexp_f32 v192, v192, v191
v_ldexp_f32 v193, v193, v191
v_ldexp_f32 v194, v194, v191
v_ldexp_f32 v195, v195, v191
v_accvgpr_write_b32 a64, v192
v_accvgpr_write_b32 a65, v193
v_accvgpr_write_b32 a66, v194
v_accvgpr_write_b32 a67, v195
v_accvgpr_read_b32 v192, a68
v_accvgpr_read_b32 v193, a69
v_accvgpr_read_b32 v194, a70
v_accvgpr_read_b32 v195, a71
v_ldexp_f32 v192, v192, v191
v_ldexp_f32 v193, v193, v191
v_ldexp_f32 v194, v194, v191
v_ldexp_f32 v195, v195, v191
v_accvgpr_write_b32 a68, v192
v_accvgpr_write_b32 a69, v193
v_accvgpr_write_b32 a70, v194
v_accvgpr_write_b32 a71, v195
v_accvgpr_read_b32 v192, a72
v_accvgpr_read_b32 v193, a73
v_accvgpr_read_b32 v194, a74
v_accvgpr_read_b32 v195, a75
v_ldexp_f32 v192, v192, v191
v_ldexp_f32 v193, v193, v191
v_ldexp_f32 v194, v194, v191
v_ldexp_f32 v195, v195, v191
v_accvgpr_write_b32 a72, v192
v_accvgpr_write_b32 a73, v193
v_accvgpr_write_b32 a74, v194
v_accvgpr_write_b32 a75, v195
v_accvgpr_read_b32 v192, a76
v_accvgpr_read_b32 v193, a77
v_accvgpr_read_b32 v194, a78
v_accvgpr_read_b32 v195, a79
v_ldexp_f32 v192, v192, v191
v_ldexp_f32 v193, v193, v191
v_ldexp_f32 v194, v194, v191
v_ldexp_f32 v195, v195, v191
v_accvgpr_write_b32 a76, v192
v_accvgpr_write_b32 a77, v193
v_accvgpr_write_b32 a78, v194
v_accvgpr_write_b32 a79, v195
v_accvgpr_read_b32 v192, a96
v_accvgpr_read_b32 v193, a97
v_accvgpr_read_b32 v194, a98
v_accvgpr_read_b32 v195, a99
v_ldexp_f32 v192, v192, v191
v_ldexp_f32 v193, v193, v191
v_ldexp_f32 v194, v194, v191
v_ldexp_f32 v195, v195, v191
v_accvgpr_write_b32 a96, v192
v_accvgpr_write_b32 a97, v193
v_accvgpr_write_b32 a98, v194
v_accvgpr_write_b32 a99, v195
v_accvgpr_read_b32 v192, a100
v_accvgpr_read_b32 v193, a101
v_accvgpr_read_b32 v194, a102
v_accvgpr_read_b32 v195, a103
v_ldexp_f32 v192, v192, v191
v_ldexp_f32 v193, v193, v191
v_ldexp_f32 v194, v194, v191
v_ldexp_f32 v195, v195, v191
v_accvgpr_write_b32 a100, v192
v_accvgpr_write_b32 a101, v193
v_accvgpr_write_b32 a102, v194
v_accvgpr_write_b32 a103, v195
v_accvgpr_read_b32 v192, a104
v_accvgpr_read_b32 v193, a105
v_accvgpr_read_b32 v194, a106
v_accvgpr_read_b32 v195, a107
v_ldexp_f32 v192, v192, v191
v_ldexp_f32 v193, v193, v191
v_ldexp_f32 v194, v194, v191
v_ldexp_f32 v195, v195, v191
v_accvgpr_write_b32 a104, v192
v_accvgpr_write_b32 a105, v193
v_accvgpr_write_b32 a106, v194
v_accvgpr_write_b32 a107, v195
v_accvgpr_read_b32 v192, a108
v_accvgpr_read_b32 v193, a109
v_accvgpr_read_b32 v194, a110
v_accvgpr_read_b32 v195, a111
v_ldexp_f32 v192, v192, v191
v_ldexp_f32 v193, v193, v191
v_ldexp_f32 v194, v194, v191
v_ldexp_f32 v195, v195, v191
v_accvgpr_write_b32 a108, v192
v_accvgpr_write_b32 a109, v193
v_accvgpr_write_b32 a110, v194
v_accvgpr_write_b32 a111, v195
v_max_f32 v189, v48, v49
v_max3_f32 v189, v189, v50, v51
v_max3_f32 v189, v189, v52, v53
v_max3_f32 v189, v189, v54, v55
v_max3_f32 v189, v189, v56, v57
v_max3_f32 v189, v189, v58, v59
v_max3_f32 v189, v189, v60, v61
v_max3_f32 v189, v189, v62, v63
v_mov_b32 v190, v189
s_nop 1
v_permlane32_swap_b32 v189, v190
v_max_f32 v189, v189, v190
v_ceil_f32 v189, v189
v_add_f32 v189, 0x42c00000, v189
v_max_f32 v189, 0, v189
v_cvt_i32_f32 v191, v189
v_sub_u32 v191, 0, v191
v_sub_f32 v144, v144, v189
v_mov_b32 v145, v144
v_mov_b32 v146, v144
v_mov_b32 v147, v144
v_mov_b32 v148, v144
v_mov_b32 v149, v144
v_mov_b32 v150, v144
v_mov_b32 v151, v144
v_mov_b32 v152, v144
v_mov_b32 v153, v144
v_mov_b32 v154, v144
v_mov_b32 v155, v144
v_mov_b32 v156, v144
v_mov_b32 v157, v144
v_mov_b32 v158, v144
v_mov_b32 v159, v144
v_sub_f32 v48, v48, v189
v_sub_f32 v49, v49, v189
v_sub_f32 v50, v50, v189
v_sub_f32 v51, v51, v189
v_sub_f32 v52, v52, v189
v_sub_f32 v53, v53, v189
v_sub_f32 v54, v54, v189
v_sub_f32 v55, v55, v189
v_sub_f32 v56, v56, v189
v_sub_f32 v57, v57, v189
v_sub_f32 v58, v58, v189
v_sub_f32 v59, v59, v189
v_sub_f32 v60, v60, v189
v_sub_f32 v61, v61, v189
v_sub_f32 v62, v62, v189
v_sub_f32 v63, v63, v189
v_sub_f32 v80, v80, v189
v_sub_f32 v81, v81, v189
v_sub_f32 v82, v82, v189
v_sub_f32 v83, v83, v189
v_sub_f32 v84, v84, v189
v_sub_f32 v85, v85, v189
v_sub_f32 v86, v86, v189
v_sub_f32 v87, v87, v189
v_sub_f32 v88, v88, v189
v_sub_f32 v89, v89, v189
v_sub_f32 v90, v90, v189
v_sub_f32 v91, v91, v189
v_sub_f32 v92, v92, v189
v_sub_f32 v93, v93, v189
v_sub_f32 v94, v94, v189
v_sub_f32 v95, v95, v189
v_mov_b32 v163, 0
v_exp_f32 v192, v48
v_exp_f32 v193, v49
s_nop 0
v_cvt_pk_bf16_f32 v104, v192, v193
v_add_f32 v163, v163, v192
v_add_f32 v163, v163, v193
v_exp_f32 v192, v50
v_exp_f32 v193, v51
s_nop 0
v_cvt_pk_bf16_f32 v105, v192, v193
v_add_f32 v163, v163, v192
v_add_f32 v163, v163, v193
v_exp_f32 v192, v52
v_exp_f32 v193, v53
s_nop 0
v_cvt_pk_bf16_f32 v106, v192, v193
v_add_f32 v163, v163, v192
v_add_f32 v163, v163, v193
v_exp_f32 v192, v54
v_exp_f32 v193, v55
s_nop 0
v_cvt_pk_bf16_f32 v107, v192, v193
v_add_f32 v163, v163, v192
v_add_f32 v163, v163, v193
v_exp_f32 v192, v56
v_exp_f32 v193, v57
s_nop 0
v_cvt_pk_bf16_f32 v108, v192, v193
v_add_f32 v163, v163, v192
v_add_f32 v163, v163, v193
v_exp_f32 v192, v58
v_exp_f32 v193, v59
s_nop 0
v_cvt_pk_bf16_f32 v109, v192, v193
v_add_f32 v163, v163, v192
v_add_f32 v163, v163, v193
v_exp_f32 v192, v60
v_exp_f32 v193, v61
s_nop 0
v_cvt_pk_bf16_f32 v110, v192, v193
v_add_f32 v163, v163, v192
v_add_f32 v163, v163, v193
v_exp_f32 v192, v62
v_exp_f32 v193, v63
s_nop 0
v_cvt_pk_bf16_f32 v111, v192, v193
v_add_f32 v163, v163, v192
v_add_f32 v163, v163, v193
v_ldexp_f32 v161, v161, v191
v_accvgpr_read_b32 v192, a16
v_accvgpr_read_b32 v193, a17
v_accvgpr_read_b32 v194, a18
v_accvgpr_read_b32 v195, a19
v_ldexp_f32 v192, v192, v191
v_ldexp_f32 v193, v193, v191
v_ldexp_f32 v194, v194, v191
v_ldexp_f32 v195, v195, v191
v_accvgpr_write_b32 a16, v192
v_accvgpr_write_b32 a17, v193
v_accvgpr_write_b32 a18, v194
v_accvgpr_write_b32 a19, v195
v_accvgpr_read_b32 v192, a20
v_accvgpr_read_b32 v193, a21
v_accvgpr_read_b32 v194, a22
v_accvgpr_read_b32 v195, a23
v_ldexp_f32 v192, v192, v191
v_ldexp_f32 v193, v193, v191
v_ldexp_f32 v194, v194, v191
v_ldexp_f32 v195, v195, v191
v_accvgpr_write_b32 a20, v192
v_accvgpr_write_b32 a21, v193
v_accvgpr_write_b32 a22, v194
v_accvgpr_write_b32 a23, v195
v_accvgpr_read_b32 v192, a24
v_accvgpr_read_b32 v193, a25
v_accvgpr_read_b32 v194, a26
v_accvgpr_read_b32 v195, a27
v_ldexp_f32 v192, v192, v191
v_ldexp_f32 v193, v193, v191
v_ldexp_f32 v194, v194, v191
v_ldexp_f32 v195, v195, v191
v_accvgpr_write_b32 a24, v192
v_accvgpr_write_b32 a25, v193
v_accvgpr_write_b32 a26, v194
v_accvgpr_write_b32 a27, v195
v_accvgpr_read_b32 v192, a28
v_accvgpr_read_b32 v193, a29
v_accvgpr_read_b32 v194, a30
v_accvgpr_read_b32 v195, a31
v_ldexp_f32 v192, v192, v191
v_ldexp_f32 v193, v193, v191
v_ldexp_f32 v194, v194, v191
v_ldexp_f32 v195, v195, v191
v_accvgpr_write_b32 a28, v192
v_accvgpr_write_b32 a29, v193
v_accvgpr_write_b32 a30, v194
v_accvgpr_write_b32 a31, v195
v_accvgpr_read_b32 v192, a48
v_accvgpr_read_b32 v193, a49
v_accvgpr_read_b32 v194, a50
v_accvgpr_read_b32 v195, a51
v_ldexp_f32 v192, v192, v191
v_ldexp_f32 v193, v193, v191
v_ldexp_f32 v194, v194, v191
v_ldexp_f32 v195, v195, v191
v_accvgpr_write_b32 a48, v192
v_accvgpr_write_b32 a49, v193
v_accvgpr_write_b32 a50, v194
v_accvgpr_write_b32 a51, v195
v_accvgpr_read_b32 v192, a52
v_accvgpr_read_b32 v193, a53
v_accvgpr_read_b32 v194, a54
v_accvgpr_read_b32 v195, a55
v_ldexp_f32 v192, v192, v191
v_ldexp_f32 v193, v193, v191
v_ldexp_f32 v194, v194, v191
v_ldexp_f32 v195, v195, v191
v_accvgpr_write_b32 a52, v192
v_accvgpr_write_b32 a53, v193
v_accvgpr_write_b32 a54, v194
v_accvgpr_write_b32 a55, v195
v_accvgpr_read_b32 v192, a56
v_accvgpr_read_b32 v193, a57
v_accvgpr_read_b32 v194, a58
v_accvgpr_read_b32 v195, a59
v_ldexp_f32 v192, v192, v191
v_ldexp_f32 v193, v193, v191
v_ldexp_f32 v194, v194, v191
v_ldexp_f32 v195, v195, v191
v_accvgpr_write_b32 a56, v192
v_accvgpr_write_b32 a57, v193
v_accvgpr_write_b32 a58, v194
v_accvgpr_write_b32 a59, v195
v_accvgpr_read_b32 v192, a60
v_accvgpr_read_b32 v193, a61
v_accvgpr_read_b32 v194, a62
v_accvgpr_read_b32 v195, a63
v_ldexp_f32 v192, v192, v191
v_ldexp_f32 v193, v193, v191
v_ldexp_f32 v194, v194, v191
v_ldexp_f32 v195, v195, v191
v_accvgpr_write_b32 a60, v192
v_accvgpr_write_b32 a61, v193
v_accvgpr_write_b32 a62, v194
v_accvgpr_write_b32 a63, v195
v_accvgpr_read_b32 v192, a80
v_accvgpr_read_b32 v193, a81
v_accvgpr_read_b32 v194, a82
v_accvgpr_read_b32 v195, a83
v_ldexp_f32 v192, v192, v191
v_ldexp_f32 v193, v193, v191
v_ldexp_f32 v194, v194, v191
v_ldexp_f32 v195, v195, v191
v_accvgpr_write_b32 a80, v192
v_accvgpr_write_b32 a81, v193
v_accvgpr_write_b32 a82, v194
v_accvgpr_write_b32 a83, v195
v_accvgpr_read_b32 v192, a84
v_accvgpr_read_b32 v193, a85
v_accvgpr_read_b32 v194, a86
v_accvgpr_read_b32 v195, a87
v_ldexp_f32 v192, v192, v191
v_ldexp_f32 v193, v193, v191
v_ldexp_f32 v194, v194, v191
v_ldexp_f32 v195, v195, v191
v_accvgpr_write_b32 a84, v192
v_accvgpr_write_b32 a85, v193
v_accvgpr_write_b32 a86, v194
v_accvgpr_write_b32 a87, v195
v_accvgpr_read_b32 v192, a88
v_accvgpr_read_b32 v193, a89
v_accvgpr_read_b32 v194, a90
v_accvgpr_read_b32 v195, a91
v_ldexp_f32 v192, v192, v191
v_ldexp_f32 v193, v193, v191
v_ldexp_f32 v194, v194, v191
v_ldexp_f32 v195, v195, v191
v_accvgpr_write_b32 a88, v192
v_accvgpr_write_b32 a89, v193
v_accvgpr_write_b32 a90, v194
v_accvgpr_write_b32 a91, v195
v_accvgpr_read_b32 v192, a92
v_accvgpr_read_b32 v193, a93
v_accvgpr_read_b32 v194, a94
v_accvgpr_read_b32 v195, a95
v_ldexp_f32 v192, v192, v191
v_ldexp_f32 v193, v193, v191
v_ldexp_f32 v194, v194, v191
v_ldexp_f32 v195, v195, v191
v_accvgpr_write_b32 a92, v192
v_accvgpr_write_b32 a93, v193
v_accvgpr_write_b32 a94, v194
v_accvgpr_write_b32 a95, v195
v_accvgpr_read_b32 v192, a112
v_accvgpr_read_b32 v193, a113
v_accvgpr_read_b32 v194, a114
v_accvgpr_read_b32 v195, a115
v_ldexp_f32 v192, v192, v191
v_ldexp_f32 v193, v193, v191
v_ldexp_f32 v194, v194, v191
v_ldexp_f32 v195, v195, v191
v_accvgpr_write_b32 a112, v192
v_accvgpr_write_b32 a113, v193
v_accvgpr_write_b32 a114, v194
v_accvgpr_write_b32 a115, v195
v_accvgpr_read_b32 v192, a116
v_accvgpr_read_b32 v193, a117
v_accvgpr_read_b32 v194, a118
v_accvgpr_read_b32 v195, a119
v_ldexp_f32 v192, v192, v191
v_ldexp_f32 v193, v193, v191
v_ldexp_f32 v194, v194, v191
v_ldexp_f32 v195, v195, v191
v_accvgpr_write_b32 a116, v192
v_accvgpr_write_b32 a117, v193
v_accvgpr_write_b32 a118, v194
v_accvgpr_write_b32 a119, v195
v_accvgpr_read_b32 v192, a120
v_accvgpr_read_b32 v193, a121
v_accvgpr_read_b32 v194, a122
v_accvgpr_read_b32 v195, a123
v_ldexp_f32 v192, v192, v191
v_ldexp_f32 v193, v193, v191
v_ldexp_f32 v194, v194, v191
v_ldexp_f32 v195, v195, v191
v_accvgpr_write_b32 a120, v192
v_accvgpr_write_b32 a121, v193
v_accvgpr_write_b32 a122, v194
v_accvgpr_write_b32 a123, v195
v_accvgpr_read_b32 v192, a124
v_accvgpr_read_b32 v193, a125
v_accvgpr_read_b32 v194, a126
v_accvgpr_read_b32 v195, a127
v_ldexp_f32 v192, v192, v191
v_ldexp_f32 v193, v193, v191
v_ldexp_f32 v194, v194, v191
v_ldexp_f32 v195, v195, v191
v_accvgpr_write_b32 a124, v192
v_accvgpr_write_b32 a125, v193
v_accvgpr_write_b32 a126, v194
v_accvgpr_write_b32 a127, v195
s_nop 1
s_setpc_b64 s[40:41]
attn_kernel_rare1:
s_nop 15
s_nop 15
v_max_f32 v189, v64, v65
v_max3_f32 v189, v189, v66, v67
v_max3_f32 v189, v189, v68, v69
v_max3_f32 v189, v189, v70, v71
v_max3_f32 v189, v189, v72, v73
v_max3_f32 v189, v189, v74, v75
v_max3_f32 v189, v189, v76, v77
v_max3_f32 v189, v189, v78, v79
v_mov_b32 v190, v189
s_nop 1
v_permlane32_swap_b32 v189, v190
v_max_f32 v189, v189, v190
v_ceil_f32 v189, v189
v_add_f32 v189, 0x42c00000, v189
v_max_f32 v189, 0, v189
v_cvt_i32_f32 v191, v189
v_sub_u32 v191, 0, v191
v_sub_f32 v128, v128, v189
v_mov_b32 v129, v128
v_mov_b32 v130, v128
v_mov_b32 v131, v128
v_mov_b32 v132, v128
v_mov_b32 v133, v128
v_mov_b32 v134, v128
v_mov_b32 v135, v128
v_mov_b32 v136, v128
v_mov_b32 v137, v128
v_mov_b32 v138, v128
v_mov_b32 v139, v128
v_mov_b32 v140, v128
v_mov_b32 v141, v128
v_mov_b32 v142, v128
v_mov_b32 v143, v128
v_sub_f32 v32, v32, v189
v_sub_f32 v33, v33, v189
v_sub_f32 v34, v34, v189
v_sub_f32 v35, v35, v189
v_sub_f32 v36, v36, v189
v_sub_f32 v37, v37, v189
v_sub_f32 v38, v38, v189
v_sub_f32 v39, v39, v189
v_sub_f32 v40, v40, v189
v_sub_f32 v41, v41, v189
v_sub_f32 v42, v42, v189
v_sub_f32 v43, v43, v189
v_sub_f32 v44, v44, v189
v_sub_f32 v45, v45, v189
v_sub_f32 v46, v46, v189
v_sub_f32 v47, v47, v189
v_sub_f32 v64, v64, v189
v_sub_f32 v65, v65, v189
v_sub_f32 v66, v66, v189
v_sub_f32 v67, v67, v189
v_sub_f32 v68, v68, v189
v_sub_f32 v69, v69, v189
v_sub_f32 v70, v70, v189
v_sub_f32 v71, v71, v189
v_sub_f32 v72, v72, v189
v_sub_f32 v73, v73, v189
v_sub_f32 v74, v74, v189
v_sub_f32 v75, v75, v189
v_sub_f32 v76, v76, v189
v_sub_f32 v77, v77, v189
v_sub_f32 v78, v78, v189
v_sub_f32 v79, v79, v189
v_mov_b32 v162, 0
v_exp_f32 v192, v64
v_exp_f32 v193, v65
s_nop 0
v_cvt_pk_bf16_f32 v112, v192, v193
v_add_f32 v162, v162, v192
v_add_f32 v162, v162, v193
v_exp_f32 v192, v66
v_exp_f32 v193, v67
s_nop 0
v_cvt_pk_bf16_f32 v113, v192, v193
v_add_f32 v162, v162, v192
v_add_f32 v162, v162, v193
v_exp_f32 v192, v68
v_exp_f32 v193, v69
s_nop 0
v_cvt_pk_bf16_f32 v114, v192, v193
v_add_f32 v162, v162, v192
v_add_f32 v162, v162, v193
v_exp_f32 v192, v70
v_exp_f32 v193, v71
s_nop 0
v_cvt_pk_bf16_f32 v115, v192, v193
v_add_f32 v162, v162, v192
v_add_f32 v162, v162, v193
v_exp_f32 v192, v72
v_exp_f32 v193, v73
s_nop 0
v_cvt_pk_bf16_f32 v116, v192, v193
v_add_f32 v162, v162, v192
v_add_f32 v162, v162, v193
v_exp_f32 v192, v74
v_exp_f32 v193, v75
s_nop 0
v_cvt_pk_bf16_f32 v117, v192, v193
v_add_f32 v162, v162, v192
v_add_f32 v162, v162, v193
v_exp_f32 v192, v76
v_exp_f32 v193, v77
s_nop 0
v_cvt_pk_bf16_f32 v118, v192, v193
v_add_f32 v162, v162, v192
v_add_f32 v162, v162, v193
v_exp_f32 v192, v78
v_exp_f32 v193, v79
s_nop 0
v_cvt_pk_bf16_f32 v119, v192, v193
v_add_f32 v162, v162, v192
v_add_f32 v162, v162, v193
v_ldexp_f32 v160, v160, v191
v_accvgpr_read_b32 v192, a0
v_accvgpr_read_b32 v193, a1
v_accvgpr_read_b32 v194, a2
v_accvgpr_read_b32 v195, a3
v_ldexp_f32 v192, v192, v191
v_ldexp_f32 v193, v193, v191
v_ldexp_f32 v194, v194, v191
v_ldexp_f32 v195, v195, v191
v_accvgpr_write_b32 a0, v192
v_accvgpr_write_b32 a1, v193
v_accvgpr_write_b32 a2, v194
v_accvgpr_write_b32 a3, v195
v_accvgpr_read_b32 v192, a4
v_accvgpr_read_b32 v193, a5
v_accvgpr_read_b32 v194, a6
v_accvgpr_read_b32 v195, a7
v_ldexp_f32 v192, v192, v191
v_ldexp_f32 v193, v193, v191
v_ldexp_f32 v194, v194, v191
v_ldexp_f32 v195, v195, v191
v_accvgpr_write_b32 a4, v192
v_accvgpr_write_b32 a5, v193
v_accvgpr_write_b32 a6, v194
v_accvgpr_write_b32 a7, v195
v_accvgpr_read_b32 v192, a8
v_accvgpr_read_b32 v193, a9
v_accvgpr_read_b32 v194, a10
v_accvgpr_read_b32 v195, a11
v_ldexp_f32 v192, v192, v191
v_ldexp_f32 v193, v193, v191
v_ldexp_f32 v194, v194, v191
v_ldexp_f32 v195, v195, v191
v_accvgpr_write_b32 a8, v192
v_accvgpr_write_b32 a9, v193
v_accvgpr_write_b32 a10, v194
v_accvgpr_write_b32 a11, v195
v_accvgpr_read_b32 v192, a12
v_accvgpr_read_b32 v193, a13
v_accvgpr_read_b32 v194, a14
v_accvgpr_read_b32 v195, a15
v_ldexp_f32 v192, v192, v191
v_ldexp_f32 v193, v193, v191
v_ldexp_f32 v194, v194, v191
v_ldexp_f32 v195, v195, v191
v_accvgpr_write_b32 a12, v192
v_accvgpr_write_b32 a13, v193
v_accvgpr_write_b32 a14, v194
v_accvgpr_write_b32 a15, v195
v_accvgpr_read_b32 v192, a32
v_accvgpr_read_b32 v193, a33
v_accvgpr_read_b32 v194, a34
v_accvgpr_read_b32 v195, a35
v_ldexp_f32 v192, v192, v191
v_ldexp_f32 v193, v193, v191
v_ldexp_f32 v194, v194, v191
v_ldexp_f32 v195, v195, v191
v_accvgpr_write_b32 a32, v192
v_accvgpr_write_b32 a33, v193
v_accvgpr_write_b32 a34, v194
v_accvgpr_write_b32 a35, v195
v_accvgpr_read_b32 v192, a36
v_accvgpr_read_b32 v193, a37
v_accvgpr_read_b32 v194, a38
v_accvgpr_read_b32 v195, a39
v_ldexp_f32 v192, v192, v191
v_ldexp_f32 v193, v193, v191
v_ldexp_f32 v194, v194, v191
v_ldexp_f32 v195, v195, v191
v_accvgpr_write_b32 a36, v192
v_accvgpr_write_b32 a37, v193
v_accvgpr_write_b32 a38, v194
v_accvgpr_write_b32 a39, v195
v_accvgpr_read_b32 v192, a40
v_accvgpr_read_b32 v193, a41
v_accvgpr_read_b32 v194, a42
v_accvgpr_read_b32 v195, a43
v_ldexp_f32 v192, v192, v191
v_ldexp_f32 v193, v193, v191
v_ldexp_f32 v194, v194, v191
v_ldexp_f32 v195, v195, v191
v_accvgpr_write_b32 a40, v192
v_accvgpr_write_b32 a41, v193
v_accvgpr_write_b32 a42, v194
v_accvgpr_write_b32 a43, v195
v_accvgpr_read_b32 v192, a44
v_accvgpr_read_b32 v193, a45
v_accvgpr_read_b32 v194, a46
v_accvgpr_read_b32 v195, a47
v_ldexp_f32 v192, v192, v191
v_ldexp_f32 v193, v193, v191
v_ldexp_f32 v194, v194, v191
v_ldexp_f32 v195, v195, v191
v_accvgpr_write_b32 a44, v192
v_accvgpr_write_b32 a45, v193
v_accvgpr_write_b32 a46, v194
v_accvgpr_write_b32 a47, v195
v_accvgpr_read_b32 v192, a64
v_accvgpr_read_b32 v193, a65
v_accvgpr_read_b32 v194, a66
v_accvgpr_read_b32 v195, a67
v_ldexp_f32 v192, v192, v191
v_ldexp_f32 v193, v193, v191
v_ldexp_f32 v194, v194, v191
v_ldexp_f32 v195, v195, v191
v_accvgpr_write_b32 a64, v192
v_accvgpr_write_b32 a65, v193
v_accvgpr_write_b32 a66, v194
v_accvgpr_write_b32 a67, v195
v_accvgpr_read_b32 v192, a68
v_accvgpr_read_b32 v193, a69
v_accvgpr_read_b32 v194, a70
v_accvgpr_read_b32 v195, a71
v_ldexp_f32 v192, v192, v191
v_ldexp_f32 v193, v193, v191
v_ldexp_f32 v194, v194, v191
v_ldexp_f32 v195, v195, v191
v_accvgpr_write_b32 a68, v192
v_accvgpr_write_b32 a69, v193
v_accvgpr_write_b32 a70, v194
v_accvgpr_write_b32 a71, v195
v_accvgpr_read_b32 v192, a72
v_accvgpr_read_b32 v193, a73
v_accvgpr_read_b32 v194, a74
v_accvgpr_read_b32 v195, a75
v_ldexp_f32 v192, v192, v191
v_ldexp_f32 v193, v193, v191
v_ldexp_f32 v194, v194, v191
v_ldexp_f32 v195, v195, v191
v_accvgpr_write_b32 a72, v192
v_accvgpr_write_b32 a73, v193
v_accvgpr_write_b32 a74, v194
v_accvgpr_write_b32 a75, v195
v_accvgpr_read_b32 v192, a76
v_accvgpr_read_b32 v193, a77
v_accvgpr_read_b32 v194, a78
v_accvgpr_read_b32 v195, a79
v_ldexp_f32 v192, v192, v191
v_ldexp_f32 v193, v193, v191
v_ldexp_f32 v194, v194, v191
v_ldexp_f32 v195, v195, v191
v_accvgpr_write_b32 a76, v192
v_accvgpr_write_b32 a77, v193
v_accvgpr_write_b32 a78, v194
v_accvgpr_write_b32 a79, v195
v_accvgpr_read_b32 v192, a96
v_accvgpr_read_b32 v193, a97
v_accvgpr_read_b32 v194, a98
v_accvgpr_read_b32 v195, a99
v_ldexp_f32 v192, v192, v191
v_ldexp_f32 v193, v193, v191
v_ldexp_f32 v194, v194, v191
v_ldexp_f32 v195, v195, v191
v_accvgpr_write_b32 a96, v192
v_accvgpr_write_b32 a97, v193
v_accvgpr_write_b32 a98, v194
v_accvgpr_write_b32 a99, v195
v_accvgpr_read_b32 v192, a100
v_accvgpr_read_b32 v193, a101
v_accvgpr_read_b32 v194, a102
v_accvgpr_read_b32 v195, a103
v_ldexp_f32 v192, v192, v191
v_ldexp_f32 v193, v193, v191
v_ldexp_f32 v194, v194, v191
v_ldexp_f32 v195, v195, v191
v_accvgpr_write_b32 a100, v192
v_accvgpr_write_b32 a101, v193
v_accvgpr_write_b32 a102, v194
v_accvgpr_write_b32 a103, v195
v_accvgpr_read_b32 v192, a104
v_accvgpr_read_b32 v193, a105
v_accvgpr_read_b32 v194, a106
v_accvgpr_read_b32 v195, a107
v_ldexp_f32 v192, v192, v191
v_ldexp_f32 v193, v193, v191
v_ldexp_f32 v194, v194, v191
v_ldexp_f32 v195, v195, v191
v_accvgpr_write_b32 a104, v192
v_accvgpr_write_b32 a105, v193
v_accvgpr_write_b32 a106, v194
v_accvgpr_write_b32 a107, v195
v_accvgpr_read_b32 v192, a108
v_accvgpr_read_b32 v193, a109
v_accvgpr_read_b32 v194, a110
v_accvgpr_read_b32 v195, a111
v_ldexp_f32 v192, v192, v191
v_ldexp_f32 v193, v193, v191
v_ldexp_f32 v194, v194, v191
v_ldexp_f32 v195, v195, v191
v_accvgpr_write_b32 a108, v192
v_accvgpr_write_b32 a109, v193
v_accvgpr_write_b32 a110, v194
v_accvgpr_write_b32 a111, v195
v_max_f32 v189, v80, v81
v_max3_f32 v189, v189, v82, v83
v_max3_f32 v189, v189, v84, v85
v_max3_f32 v189, v189, v86, v87
v_max3_f32 v189, v189, v88, v89
v_max3_f32 v189, v189, v90, v91
v_max3_f32 v189, v189, v92, v93
v_max3_f32 v189, v189, v94, v95
v_mov_b32 v190, v189
s_nop 1
v_permlane32_swap_b32 v189, v190
v_max_f32 v189, v189, v190
v_ceil_f32 v189, v189
v_add_f32 v189, 0x42c00000, v189
v_max_f32 v189, 0, v189
v_cvt_i32_f32 v191, v189
v_sub_u32 v191, 0, v191
v_sub_f32 v144, v144, v189
v_mov_b32 v145, v144
v_mov_b32 v146, v144
v_mov_b32 v147, v144
v_mov_b32 v148, v144
v_mov_b32 v149, v144
v_mov_b32 v150, v144
v_mov_b32 v151, v144
v_mov_b32 v152, v144
v_mov_b32 v153, v144
v_mov_b32 v154, v144
v_mov_b32 v155, v144
v_mov_b32 v156, v144
v_mov_b32 v157, v144
v_mov_b32 v158, v144
v_mov_b32 v159, v144
v_sub_f32 v48, v48, v189
v_sub_f32 v49, v49, v189
v_sub_f32 v50, v50, v189
v_sub_f32 v51, v51, v189
v_sub_f32 v52, v52, v189
v_sub_f32 v53, v53, v189
v_sub_f32 v54, v54, v189
v_sub_f32 v55, v55, v189
v_sub_f32 v56, v56, v189
v_sub_f32 v57, v57, v189
v_sub_f32 v58, v58, v189
v_sub_f32 v59, v59, v189
v_sub_f32 v60, v60, v189
v_sub_f32 v61, v61, v189
v_sub_f32 v62, v62, v189
v_sub_f32 v63, v63, v189
v_sub_f32 v80, v80, v189
v_sub_f32 v81, v81, v189
v_sub_f32 v82, v82, v189
v_sub_f32 v83, v83, v189
v_sub_f32 v84, v84, v189
v_sub_f32 v85, v85, v189
v_sub_f32 v86, v86, v189
v_sub_f32 v87, v87, v189
v_sub_f32 v88, v88, v189
v_sub_f32 v89, v89, v189
v_sub_f32 v90, v90, v189
v_sub_f32 v91, v91, v189
v_sub_f32 v92, v92, v189
v_sub_f32 v93, v93, v189
v_sub_f32 v94, v94, v189
v_sub_f32 v95, v95, v189
v_mov_b32 v163, 0
v_exp_f32 v192, v80
v_exp_f32 v193, v81
s_nop 0
v_cvt_pk_bf16_f32 v120, v192, v193
v_add_f32 v163, v163, v192
v_add_f32 v163, v163, v193
v_exp_f32 v192, v82
v_exp_f32 v193, v83
s_nop 0
v_cvt_pk_bf16_f32 v121, v192, v193
v_add_f32 v163, v163, v192
v_add_f32 v163, v163, v193
v_exp_f32 v192, v84
v_exp_f32 v193, v85
s_nop 0
v_cvt_pk_bf16_f32 v122, v192, v193
v_add_f32 v163, v163, v192
v_add_f32 v163, v163, v193
v_exp_f32 v192, v86
v_exp_f32 v193, v87
s_nop 0
v_cvt_pk_bf16_f32 v123, v192, v193
v_add_f32 v163, v163, v192
v_add_f32 v163, v163, v193
v_exp_f32 v192, v88
v_exp_f32 v193, v89
s_nop 0
v_cvt_pk_bf16_f32 v124, v192, v193
v_add_f32 v163, v163, v192
v_add_f32 v163, v163, v193
v_exp_f32 v192, v90
v_exp_f32 v193, v91
s_nop 0
v_cvt_pk_bf16_f32 v125, v192, v193
v_add_f32 v163, v163, v192
v_add_f32 v163, v163, v193
v_exp_f32 v192, v92
v_exp_f32 v193, v93
s_nop 0
v_cvt_pk_bf16_f32 v126, v192, v193
v_add_f32 v163, v163, v192
v_add_f32 v163, v163, v193
v_exp_f32 v192, v94
v_exp_f32 v193, v95
s_nop 0
v_cvt_pk_bf16_f32 v127, v192, v193
v_add_f32 v163, v163, v192
v_add_f32 v163, v163, v193
v_ldexp_f32 v161, v161, v191
v_accvgpr_read_b32 v192, a16
v_accvgpr_read_b32 v193, a17
v_accvgpr_read_b32 v194, a18
v_accvgpr_read_b32 v195, a19
v_ldexp_f32 v192, v192, v191
v_ldexp_f32 v193, v193, v191
v_ldexp_f32 v194, v194, v191
v_ldexp_f32 v195, v195, v191
v_accvgpr_write_b32 a16, v192
v_accvgpr_write_b32 a17, v193
v_accvgpr_write_b32 a18, v194
v_accvgpr_write_b32 a19, v195
v_accvgpr_read_b32 v192, a20
v_accvgpr_read_b32 v193, a21
v_accvgpr_read_b32 v194, a22
v_accvgpr_read_b32 v195, a23
v_ldexp_f32 v192, v192, v191
v_ldexp_f32 v193, v193, v191
v_ldexp_f32 v194, v194, v191
v_ldexp_f32 v195, v195, v191
v_accvgpr_write_b32 a20, v192
v_accvgpr_write_b32 a21, v193
v_accvgpr_write_b32 a22, v194
v_accvgpr_write_b32 a23, v195
v_accvgpr_read_b32 v192, a24
v_accvgpr_read_b32 v193, a25
v_accvgpr_read_b32 v194, a26
v_accvgpr_read_b32 v195, a27
v_ldexp_f32 v192, v192, v191
v_ldexp_f32 v193, v193, v191
v_ldexp_f32 v194, v194, v191
v_ldexp_f32 v195, v195, v191
v_accvgpr_write_b32 a24, v192
v_accvgpr_write_b32 a25, v193
v_accvgpr_write_b32 a26, v194
v_accvgpr_write_b32 a27, v195
v_accvgpr_read_b32 v192, a28
v_accvgpr_read_b32 v193, a29
v_accvgpr_read_b32 v194, a30
v_accvgpr_read_b32 v195, a31
v_ldexp_f32 v192, v192, v191
v_ldexp_f32 v193, v193, v191
v_ldexp_f32 v194, v194, v191
v_ldexp_f32 v195, v195, v191
v_accvgpr_write_b32 a28, v192
v_accvgpr_write_b32 a29, v193
v_accvgpr_write_b32 a30, v194
v_accvgpr_write_b32 a31, v195
v_accvgpr_read_b32 v192, a48
v_accvgpr_read_b32 v193, a49
v_accvgpr_read_b32 v194, a50
v_accvgpr_read_b32 v195, a51
v_ldexp_f32 v192, v192, v191
v_ldexp_f32 v193, v193, v191
v_ldexp_f32 v194, v194, v191
v_ldexp_f32 v195, v195, v191
v_accvgpr_write_b32 a48, v192
v_accvgpr_write_b32 a49, v193
v_accvgpr_write_b32 a50, v194
v_accvgpr_write_b32 a51, v195
v_accvgpr_read_b32 v192, a52
v_accvgpr_read_b32 v193, a53
v_accvgpr_read_b32 v194, a54
v_accvgpr_read_b32 v195, a55
v_ldexp_f32 v192, v192, v191
v_ldexp_f32 v193, v193, v191
v_ldexp_f32 v194, v194, v191
v_ldexp_f32 v195, v195, v191
v_accvgpr_write_b32 a52, v192
v_accvgpr_write_b32 a53, v193
v_accvgpr_write_b32 a54, v194
v_accvgpr_write_b32 a55, v195
v_accvgpr_read_b32 v192, a56
v_accvgpr_read_b32 v193, a57
v_accvgpr_read_b32 v194, a58
v_accvgpr_read_b32 v195, a59
v_ldexp_f32 v192, v192, v191
v_ldexp_f32 v193, v193, v191
v_ldexp_f32 v194, v194, v191
v_ldexp_f32 v195, v195, v191
v_accvgpr_write_b32 a56, v192
v_accvgpr_write_b32 a57, v193
v_accvgpr_write_b32 a58, v194
v_accvgpr_write_b32 a59, v195
v_accvgpr_read_b32 v192, a60
v_accvgpr_read_b32 v193, a61
v_accvgpr_read_b32 v194, a62
v_accvgpr_read_b32 v195, a63
v_ldexp_f32 v192, v192, v191
v_ldexp_f32 v193, v193, v191
v_ldexp_f32 v194, v194, v191
v_ldexp_f32 v195, v195, v191
v_accvgpr_write_b32 a60, v192
v_accvgpr_write_b32 a61, v193
v_accvgpr_write_b32 a62, v194
v_accvgpr_write_b32 a63, v195
v_accvgpr_read_b32 v192, a80
v_accvgpr_read_b32 v193, a81
v_accvgpr_read_b32 v194, a82
v_accvgpr_read_b32 v195, a83
v_ldexp_f32 v192, v192, v191
v_ldexp_f32 v193, v193, v191
v_ldexp_f32 v194, v194, v191
v_ldexp_f32 v195, v195, v191
v_accvgpr_write_b32 a80, v192
v_accvgpr_write_b32 a81, v193
v_accvgpr_write_b32 a82, v194
v_accvgpr_write_b32 a83, v195
v_accvgpr_read_b32 v192, a84
v_accvgpr_read_b32 v193, a85
v_accvgpr_read_b32 v194, a86
v_accvgpr_read_b32 v195, a87
v_ldexp_f32 v192, v192, v191
v_ldexp_f32 v193, v193, v191
v_ldexp_f32 v194, v194, v191
v_ldexp_f32 v195, v195, v191
v_accvgpr_write_b32 a84, v192
v_accvgpr_write_b32 a85, v193
v_accvgpr_write_b32 a86, v194
v_accvgpr_write_b32 a87, v195
v_accvgpr_read_b32 v192, a88
v_accvgpr_read_b32 v193, a89
v_accvgpr_read_b32 v194, a90
v_accvgpr_read_b32 v195, a91
v_ldexp_f32 v192, v192, v191
v_ldexp_f32 v193, v193, v191
v_ldexp_f32 v194, v194, v191
v_ldexp_f32 v195, v195, v191
v_accvgpr_write_b32 a88, v192
v_accvgpr_write_b32 a89, v193
v_accvgpr_write_b32 a90, v194
v_accvgpr_write_b32 a91, v195
v_accvgpr_read_b32 v192, a92
v_accvgpr_read_b32 v193, a93
v_accvgpr_read_b32 v194, a94
v_accvgpr_read_b32 v195, a95
v_ldexp_f32 v192, v192, v191
v_ldexp_f32 v193, v193, v191
v_ldexp_f32 v194, v194, v191
v_ldexp_f32 v195, v195, v191
v_accvgpr_write_b32 a92, v192
v_accvgpr_write_b32 a93, v193
v_accvgpr_write_b32 a94, v194
v_accvgpr_write_b32 a95, v195
v_accvgpr_read_b32 v192, a112
v_accvgpr_read_b32 v193, a113
v_accvgpr_read_b32 v194, a114
v_accvgpr_read_b32 v195, a115
v_ldexp_f32 v192, v192, v191
v_ldexp_f32 v193, v193, v191
v_ldexp_f32 v194, v194, v191
v_ldexp_f32 v195, v195, v191
v_accvgpr_write_b32 a112, v192
v_accvgpr_write_b32 a113, v193
v_accvgpr_write_b32 a114, v194
v_accvgpr_write_b32 a115, v195
v_accvgpr_read_b32 v192, a116
v_accvgpr_read_b32 v193, a117
v_accvgpr_read_b32 v194, a118
v_accvgpr_read_b32 v195, a119
v_ldexp_f32 v192, v192, v191
v_ldexp_f32 v193, v193, v191
v_ldexp_f32 v194, v194, v191
v_ldexp_f32 v195, v195, v191
v_accvgpr_write_b32 a116, v192
v_accvgpr_write_b32 a117, v193
v_accvgpr_write_b32 a118, v194
v_accvgpr_write_b32 a119, v195
v_accvgpr_read_b32 v192, a120
v_accvgpr_read_b32 v193, a121
v_accvgpr_read_b32 v194, a122
v_accvgpr_read_b32 v195, a123
v_ldexp_f32 v192, v192, v191
v_ldexp_f32 v193, v193, v191
v_ldexp_f32 v194, v194, v191
v_ldexp_f32 v195, v195, v191
v_accvgpr_write_b32 a120, v192
v_accvgpr_write_b32 a121, v193
v_accvgpr_write_b32 a122, v194
v_accvgpr_write_b32 a123, v195
v_accvgpr_read_b32 v192, a124
v_accvgpr_read_b32 v193, a125
v_accvgpr_read_b32 v194, a126
v_accvgpr_read_b32 v195, a127
v_ldexp_f32 v192, v192, v191
v_ldexp_f32 v193, v193, v191
v_ldexp_f32 v194, v194, v191
v_ldexp_f32 v195, v195, v191
v_accvgpr_write_b32 a124, v192
v_accvgpr_write_b32 a125, v193
v_accvgpr_write_b32 a126, v194
v_accvgpr_write_b32 a127, v195
s_nop 1
s_setpc_b64 s[40:41]
.globl wo_kernel
.p2align 8
.type wo_kernel,@function
wo_kernel:
s_cmp_ge_u32 s2, 256
s_cbranch_scc1 wo_kernel_done
s_load_dwordx2 s[48:49], s[0:1], 32
s_load_dwordx2 s[50:51], s[0:1], 104
s_load_dwordx4 s[52:55], s[0:1], 48
v_lshrrev_b32 v1, 6, v0
v_and_b32 v2, 63, v0
v_readfirstlane_b32 s28, v1
s_and_b32 s32, s2, 7
s_lshr_b32 s33, s2, 3
s_lshr_b32 s31, s32, 1
s_and_b32 s32, s32, 1
s_lshl_b32 s29, s32, 3
s_and_b32 s32, s33, 7
s_add_u32 s29, s29, s32
s_lshr_b32 s30, s33, 3
v_lshrrev_b32 v3, 4, v2
v_and_b32 v4, 15, v2
v_lshlrev_b32 v5, 2, v3
v_xor_b32 v5, v5, v4
s_lshl_b32 s32, s28, 4
v_add_u32 v6, s32, v3
v_lshlrev_b32 v6, 10, v6
v_lshl_add_u32 v10, v5, 4, v6
s_lshl_b32 s32, s30, 8
v_add_u32 v10, s32, v10
v_lshlrev_b32 v11, 4, v2
s_lshl_b32 s34, s31, 20
s_lshl_b32 s32, s29, 2
s_add_u32 s32, s32, s28
s_lshl_b32 s35, s32, 18
s_lshl_b32 s33, s31, 16
s_add_u32 s35, s35, s33
s_lshl_b32 s36, s28, 12
s_add_u32 s37, s36, 16384
s_waitcnt lgkmcnt(0)
s_mov_b32 s8, s48
s_and_b32 s9, s49, 0xffff
s_mov_b32 s10, 4194304
s_mov_b32 s11, 0x00020000
s_add_u32 s12, s50, 4194304
s_addc_u32 s13, s51, 0
s_and_b32 s13, s13, 0xffff
s_mov_b32 s14, 16777216
s_mov_b32 s15, 0x00020000
s_add_u32 m0, s37, 0
s_add_u32 s33, s35, 0
buffer_load_dwordx4 v11, s[12:15], s33 offen offset:0 lds
buffer_load_dwordx4 v11, s[12:15], s33 offen offset:1024 lds
buffer_load_dwordx4 v11, s[12:15], s33 offen offset:2048 lds
buffer_load_dwordx4 v11, s[12:15], s33 offen offset:3072 lds
s_add_u32 m0, s36, 0
s_add_u32 s32, s34, 0
buffer_load_dwordx4 v10, s[8:11], s32 offen lds
s_add_u32 m0, s36, 1024
s_add_u32 s32, s34, 4096
buffer_load_dwordx4 v10, s[8:11], s32 offen lds
s_add_u32 m0, s36, 2048
s_add_u32 s32, s34, 8192
buffer_load_dwordx4 v10, s[8:11], s32 offen lds
s_add_u32 m0, s36, 3072
s_add_u32 s32, s34, 12288
buffer_load_dwordx4 v10, s[8:11], s32 offen lds
s_add_u32 m0, s37, 32768
s_add_u32 s33, s35, 4096
buffer_load_dwordx4 v11, s[12:15], s33 offen offset:0 lds
buffer_load_dwordx4 v11, s[12:15], s33 offen offset:1024 lds
buffer_load_dwordx4 v11, s[12:15], s33 offen offset:2048 lds
buffer_load_dwordx4 v11, s[12:15], s33 offen offset:3072 lds
s_add_u32 m0, s36, 32768
s_add_u32 s32, s34, 65536
buffer_load_dwordx4 v10, s[8:11], s32 offen lds
s_add_u32 m0, s36, 33792
s_add_u32 s32, s34, 69632
buffer_load_dwordx4 v10, s[8:11], s32 offen lds
s_add_u32 m0, s36, 34816
s_add_u32 s32, s34, 73728
buffer_load_dwordx4 v10, s[8:11], s32 offen lds
s_add_u32 m0, s36, 35840
s_add_u32 s32, s34, 77824
buffer_load_dwordx4 v10, s[8:11], s32 offen lds
v_lshrrev_b32 v5, 2, v4
v_and_b32 v6, 3, v2
v_lshrrev_b32 v7, 1, v3
v_and_b32 v8, 1, v3
v_lshl_add_u32 v7, v7, 2, v5
v_lshlrev_b32 v7, 8, v7
v_lshl_add_u32 v7, v8, 5, v7
v_lshl_add_u32 v7, v6, 3, v7
s_and_b32 s32, s28, 1
s_lshl_b32 s32, s32, 1
s_add_u32 s33, s32, 0
v_xor_b32 v9, s33, v5
v_lshl_add_u32 v12, v9, 6, v7
v_add_u32 v16, 0x10000, v12
s_add_u32 s33, s32, 1
v_xor_b32 v9, s33, v5
v_lshl_add_u32 v13, v9, 6, v7
v_add_u32 v17, 0x10000, v13
s_lshr_b32 s32, s28, 1
s_lshl_b32 s32, s32, 13
s_add_u32 s32, s32, 16384
v_add_u32 v14, s32, v11
v_add_u32 v18, 0x10000, v14
s_add_u32 s16, s50, 41943040
s_addc_u32 s17, s51, 0
s_and_b32 s17, s17, 0xffff
s_mov_b32 s18, 16777216
s_mov_b32 s19, 0x00020000
s_lshl_b32 s32, s29, 2
s_lshr_b32 s33, s28, 1
s_lshl_b32 s33, s33, 1
s_add_u32 s32, s32, s33
s_lshl_b32 s32, s32, 4
s_lshl_b32 s33, s30, 2
s_add_u32 s32, s32, s33
s_and_b32 s33, s28, 1
s_lshl_b32 s33, s33, 1
s_add_u32 s32, s32, s33
s_lshl_b32 s32, s32, 11
s_lshl_b32 s33, s31, 21
s_add_u32 s38, s32, s33
s_add_u32 s39, s38, 2048
s_add_u32 s40, s38, 32768
s_add_u32 s41, s40, 2048
v_min_u32 v19, 880, v11
s_lshr_b32 s57, s2, 3
s_lshl_b32 s57, s57, 4
s_lshl_b32 s56, s28, 2
s_add_u32 s57, s57, s56
s_mul_i32 s57, s57, 3584
s_bfe_u32 s56, s2, 0x20001
s_mul_i32 s56, s56, 896
s_add_u32 s57, s57, s56
s_mov_b32 s60, s52
s_and_b32 s61, s53, 0xffff
s_mov_b32 s62, 1835008
s_mov_b32 s63, 0x00020000
s_mov_b32 s44, s54
s_and_b32 s45, s55, 0xffff
s_mov_b32 s46, 1835008
s_mov_b32 s47, 0x00020000
s_waitcnt vmcnt(8)
s_barrier
ds_read_b128 a[8:11], v14 offset:0
ds_read_b128 a[12:15], v14 offset:4096
ds_read_b64_tr_b16 a[0:1], v12 offset:0
ds_read_b64_tr_b16 a[2:3], v12 offset:2048
ds_read_b64_tr_b16 a[4:5], v13 offset:0
ds_read_b64_tr_b16 a[6:7], v13 offset:2048
s_waitcnt lgkmcnt(0)
v_mfma_f32_32x32x16_bf16 v[32:47], a[0:3], a[8:11], 0
ds_read_b128 a[24:27], v14 offset:1024
s_add_u32 m0, s37, 65536
s_add_u32 s33, s35, 8192
ds_read_b128 a[28:31], v14 offset:5120
buffer_load_dwordx4 v11, s[12:15], s33 offen offset:0 lds
v_mfma_f32_32x32x16_bf16 v[64:79], a[0:3], a[12:15], 0
ds_read_b64_tr_b16 a[16:17], v12 offset:4096
ds_read_b64_tr_b16 a[18:19], v12 offset:6144
buffer_load_dwordx4 v11, s[12:15], s33 offen offset:1024 lds
v_mfma_f32_32x32x16_bf16 v[48:63], a[4:7], a[8:11], 0
ds_read_b64_tr_b16 a[20:21], v13 offset:4096
ds_read_b64_tr_b16 a[22:23], v13 offset:6144
buffer_load_dwordx4 v11, s[12:15], s33 offen offset:2048 lds
v_mfma_f32_32x32x16_bf16 v[80:95], a[4:7], a[12:15], 0
buffer_load_dwordx4 v11, s[12:15], s33 offen offset:3072 lds
s_waitcnt lgkmcnt(0)
v_mfma_f32_32x32x16_bf16 v[32:47], a[16:19], a[24:27], v[32:47]
ds_read_b128 a[8:11], v14 offset:2048
s_add_u32 m0, s36, 65536
s_add_u32 s32, s34, 131072
ds_read_b128 a[12:15], v14 offset:6144
buffer_load_dwordx4 v10, s[8:11], s32 offen lds
v_mfma_f32_32x32x16_bf16 v[64:79], a[16:19], a[28:31], v[64:79]
ds_read_b64_tr_b16 a[0:1], v12 offset:8192
s_add_u32 m0, s36, 66560
s_add_u32 s32, s34, 135168
ds_read_b64_tr_b16 a[2:3], v12 offset:10240
buffer_load_dwordx4 v10, s[8:11], s32 offen lds
v_mfma_f32_32x32x16_bf16 v[48:63], a[20:23], a[24:27], v[48:63]
ds_read_b64_tr_b16 a[4:5], v13 offset:8192
ds_read_b64_tr_b16 a[6:7], v13 offset:10240
s_add_u32 m0, s36, 67584
s_add_u32 s32, s34, 139264
buffer_load_dwordx4 v10, s[8:11], s32 offen lds
v_mfma_f32_32x32x16_bf16 v[80:95], a[20:23], a[28:31], v[80:95]
s_add_u32 m0, s36, 68608
s_add_u32 s32, s34, 143360
buffer_load_dwordx4 v10, s[8:11], s32 offen lds
s_waitcnt lgkmcnt(0)
v_mfma_f32_32x32x16_bf16 v[32:47], a[0:3], a[8:11], v[32:47]
ds_read_b128 a[24:27], v14 offset:3072
s_add_u32 m0, s37, 98304
s_add_u32 s33, s35, 12288
ds_read_b128 a[28:31], v14 offset:7168
buffer_load_dwordx4 v11, s[12:15], s33 offen offset:0 lds
v_mfma_f32_32x32x16_bf16 v[64:79], a[0:3], a[12:15], v[64:79]
ds_read_b64_tr_b16 a[16:17], v12 offset:12288
ds_read_b64_tr_b16 a[18:19], v12 offset:14336
buffer_load_dwordx4 v11, s[12:15], s33 offen offset:1024 lds
v_mfma_f32_32x32x16_bf16 v[48:63], a[4:7], a[8:11], v[48:63]
ds_read_b64_tr_b16 a[20:21], v13 offset:12288
ds_read_b64_tr_b16 a[22:23], v13 offset:14336
buffer_load_dwordx4 v11, s[12:15], s33 offen offset:2048 lds
v_mfma_f32_32x32x16_bf16 v[80:95], a[4:7], a[12:15], v[80:95]
buffer_load_dwordx4 v11, s[12:15], s33 offen offset:3072 lds
s_waitcnt lgkmcnt(0)
s_waitcnt vmcnt(12)
s_barrier
v_mfma_f32_32x32x16_bf16 v[32:47], a[16:19], a[24:27], v[32:47]
ds_read_b128 a[8:11], v14 offset:32768
s_add_u32 m0, s36, 98304
s_add_u32 s32, s34, 196608
ds_read_b128 a[12:15], v14 offset:36864
buffer_load_dwordx4 v10, s[8:11], s32 offen lds
v_mfma_f32_32x32x16_bf16 v[64:79], a[16:19], a[28:31], v[64:79]
ds_read_b64_tr_b16 a[0:1], v12 offset:32768
s_add_u32 m0, s36, 99328
s_add_u32 s32, s34, 200704
ds_read_b64_tr_b16 a[2:3], v12 offset:34816
buffer_load_dwordx4 v10, s[8:11], s32 offen lds
v_mfma_f32_32x32x16_bf16 v[48:63], a[20:23], a[24:27], v[48:63]
ds_read_b64_tr_b16 a[4:5], v13 offset:32768
ds_read_b64_tr_b16 a[6:7], v13 offset:34816
s_add_u32 m0, s36, 100352
s_add_u32 s32, s34, 204800
buffer_load_dwordx4 v10, s[8:11], s32 offen lds
v_mfma_f32_32x32x16_bf16 v[80:95], a[20:23], a[28:31], v[80:95]
s_add_u32 m0, s36, 101376
s_add_u32 s32, s34, 208896
buffer_load_dwordx4 v10, s[8:11], s32 offen lds
s_waitcnt lgkmcnt(0)
v_mfma_f32_32x32x16_bf16 v[32:47], a[0:3], a[8:11], v[32:47]
ds_read_b128 a[24:27], v14 offset:33792
s_add_u32 m0, s37, 0
ds_read_b128 a[28:31], v14 offset:37888
s_add_u32 s33, s35, 16384
buffer_load_dwordx4 v11, s[12:15], s33 offen offset:0 lds
v_mfma_f32_32x32x16_bf16 v[64:79], a[0:3], a[12:15], v[64:79]
ds_read_b64_tr_b16 a[16:17], v12 offset:36864
ds_read_b64_tr_b16 a[18:19], v12 offset:38912
v_mfma_f32_32x32x16_bf16 v[48:63], a[4:7], a[8:11], v[48:63]
ds_read_b64_tr_b16 a[20:21], v13 offset:36864
ds_read_b64_tr_b16 a[22:23], v13 offset:38912
buffer_load_dwordx4 v11, s[12:15], s33 offen offset:1024 lds
v_mfma_f32_32x32x16_bf16 v[80:95], a[4:7], a[12:15], v[80:95]
s_waitcnt lgkmcnt(0)
v_mfma_f32_32x32x16_bf16 v[32:47], a[16:19], a[24:27], v[32:47]
ds_read_b128 a[8:11], v14 offset:34816
buffer_load_dwordx4 v11, s[12:15], s33 offen offset:2048 lds
ds_read_b128 a[12:15], v14 offset:38912
v_mfma_f32_32x32x16_bf16 v[64:79], a[16:19], a[28:31], v[64:79]
ds_read_b64_tr_b16 a[0:1], v12 offset:40960
ds_read_b64_tr_b16 a[2:3], v12 offset:43008
v_mfma_f32_32x32x16_bf16 v[48:63], a[20:23], a[24:27], v[48:63]
ds_read_b64_tr_b16 a[4:5], v13 offset:40960
ds_read_b64_tr_b16 a[6:7], v13 offset:43008
buffer_load_dwordx4 v11, s[12:15], s33 offen offset:3072 lds
v_mfma_f32_32x32x16_bf16 v[80:95], a[20:23], a[28:31], v[80:95]
s_waitcnt lgkmcnt(0)
v_mfma_f32_32x32x16_bf16 v[32:47], a[0:3], a[8:11], v[32:47]
ds_read_b128 a[24:27], v14 offset:35840
s_add_u32 m0, s36, 0
ds_read_b128 a[28:31], v14 offset:39936
s_add_u32 s32, s34, 262144
buffer_load_dwordx4 v10, s[8:11], s32 offen lds
v_mfma_f32_32x32x16_bf16 v[64:79], a[0:3], a[12:15], v[64:79]
ds_read_b64_tr_b16 a[16:17], v12 offset:45056
ds_read_b64_tr_b16 a[18:19], v12 offset:47104
v_mfma_f32_32x32x16_bf16 v[48:63], a[4:7], a[8:11], v[48:63]
ds_read_b64_tr_b16 a[20:21], v13 offset:45056
ds_read_b64_tr_b16 a[22:23], v13 offset:47104
s_add_u32 m0, s36, 1024
s_add_u32 s32, s34, 266240
buffer_load_dwordx4 v10, s[8:11], s32 offen lds
v_mfma_f32_32x32x16_bf16 v[80:95], a[4:7], a[12:15], v[80:95]
s_waitcnt lgkmcnt(0)
s_waitcnt vmcnt(14)
s_barrier
v_mfma_f32_32x32x16_bf16 v[32:47], a[16:19], a[24:27], v[32:47]
ds_read_b128 a[8:11], v18 offset:0
s_add_u32 m0, s36, 2048
ds_read_b128 a[12:15], v18 offset:4096
s_add_u32 s32, s34, 270336
buffer_load_dwordx4 v10, s[8:11], s32 offen lds
v_mfma_f32_32x32x16_bf16 v[64:79], a[16:19], a[28:31], v[64:79]
ds_read_b64_tr_b16 a[0:1], v16 offset:0
ds_read_b64_tr_b16 a[2:3], v16 offset:2048
v_mfma_f32_32x32x16_bf16 v[48:63], a[20:23], a[24:27], v[48:63]
ds_read_b64_tr_b16 a[4:5], v17 offset:0
ds_read_b64_tr_b16 a[6:7], v17 offset:2048
s_add_u32 m0, s36, 3072
s_add_u32 s32, s34, 274432
buffer_load_dwordx4 v10, s[8:11], s32 offen lds
v_mfma_f32_32x32x16_bf16 v[80:95], a[20:23], a[28:31], v[80:95]
s_waitcnt lgkmcnt(0)
v_mfma_f32_32x32x16_bf16 v[32:47], a[0:3], a[8:11], v[32:47]
ds_read_b128 a[24:27], v18 offset:1024
s_add_u32 m0, s37, 32768
ds_read_b128 a[28:31], v18 offset:5120
s_add_u32 s33, s35, 20480
buffer_load_dwordx4 v11, s[12:15], s33 offen offset:0 lds
v_mfma_f32_32x32x16_bf16 v[64:79], a[0:3], a[12:15], v[64:79]
ds_read_b64_tr_b16 a[16:17], v16 offset:4096
ds_read_b64_tr_b16 a[18:19], v16 offset:6144
v_mfma_f32_32x32x16_bf16 v[48:63], a[4:7], a[8:11], v[48:63]
ds_read_b64_tr_b16 a[20:21], v17 offset:4096
ds_read_b64_tr_b16 a[22:23], v17 offset:6144
buffer_load_dwordx4 v11, s[12:15], s33 offen offset:1024 lds
v_mfma_f32_32x32x16_bf16 v[80:95], a[4:7], a[12:15], v[80:95]
s_waitcnt lgkmcnt(0)
v_mfma_f32_32x32x16_bf16 v[32:47], a[16:19], a[24:27], v[32:47]
ds_read_b128 a[8:11], v18 offset:2048
buffer_load_dwordx4 v11, s[12:15], s33 offen offset:2048 lds
ds_read_b128 a[12:15], v18 offset:6144
v_mfma_f32_32x32x16_bf16 v[64:79], a[16:19], a[28:31], v[64:79]
ds_read_b64_tr_b16 a[0:1], v16 offset:8192
ds_read_b64_tr_b16 a[2:3], v16 offset:10240
v_mfma_f32_32x32x16_bf16 v[48:63], a[20:23], a[24:27], v[48:63]
ds_read_b64_tr_b16 a[4:5], v17 offset:8192
ds_read_b64_tr_b16 a[6:7], v17 offset:10240
buffer_load_dwordx4 v11, s[12:15], s33 offen offset:3072 lds
v_mfma_f32_32x32x16_bf16 v[80:95], a[20:23], a[28:31], v[80:95]
s_waitcnt lgkmcnt(0)
v_mfma_f32_32x32x16_bf16 v[32:47], a[0:3], a[8:11], v[32:47]
ds_read_b128 a[24:27], v18 offset:3072
s_add_u32 m0, s36, 32768
ds_read_b128 a[28:31], v18 offset:7168
s_add_u32 s32, s34, 327680
buffer_load_dwordx4 v10, s[8:11], s32 offen lds
v_mfma_f32_32x32x16_bf16 v[64:79], a[0:3], a[12:15], v[64:79]
ds_read_b64_tr_b16 a[16:17], v16 offset:12288
ds_read_b64_tr_b16 a[18:19], v16 offset:14336
v_mfma_f32_32x32x16_bf16 v[48:63], a[4:7], a[8:11], v[48:63]
ds_read_b64_tr_b16 a[20:21], v17 offset:12288
ds_read_b64_tr_b16 a[22:23], v17 offset:14336
s_add_u32 m0, s36, 33792
s_add_u32 s32, s34, 331776
buffer_load_dwordx4 v10, s[8:11], s32 offen lds
v_mfma_f32_32x32x16_bf16 v[80:95], a[4:7], a[12:15], v[80:95]
s_waitcnt lgkmcnt(0)
s_waitcnt vmcnt(14)
s_barrier
v_mfma_f32_32x32x16_bf16 v[32:47], a[16:19], a[24:27], v[32:47]
ds_read_b128 a[8:11], v18 offset:32768
s_add_u32 m0, s36, 34816
ds_read_b128 a[12:15], v18 offset:36864
s_add_u32 s32, s34, 335872
buffer_load_dwordx4 v10, s[8:11], s32 offen lds
v_mfma_f32_32x32x16_bf16 v[64:79], a[16:19], a[28:31], v[64:79]
ds_read_b64_tr_b16 a[0:1], v16 offset:32768
ds_read_b64_tr_b16 a[2:3], v16 offset:34816
v_mfma_f32_32x32x16_bf16 v[48:63], a[20:23], a[24:27], v[48:63]
ds_read_b64_tr_b16 a[4:5], v17 offset:32768
ds_read_b64_tr_b16 a[6:7], v17 offset:34816
s_add_u32 m0, s36, 35840
s_add_u32 s32, s34, 339968
buffer_load_dwordx4 v10, s[8:11], s32 offen lds
v_mfma_f32_32x32x16_bf16 v[80:95], a[20:23], a[28:31], v[80:95]
s_waitcnt lgkmcnt(0)
v_mfma_f32_32x32x16_bf16 v[32:47], a[0:3], a[8:11], v[32:47]
ds_read_b128 a[24:27], v18 offset:33792
s_add_u32 m0, s37, 65536
ds_read_b128 a[28:31], v18 offset:37888
s_add_u32 s33, s35, 24576
buffer_load_dwordx4 v11, s[12:15], s33 offen offset:0 lds
v_mfma_f32_32x32x16_bf16 v[64:79], a[0:3], a[12:15], v[64:79]
ds_read_b64_tr_b16 a[16:17], v16 offset:36864
ds_read_b64_tr_b16 a[18:19], v16 offset:38912
v_mfma_f32_32x32x16_bf16 v[48:63], a[4:7], a[8:11], v[48:63]
ds_read_b64_tr_b16 a[20:21], v17 offset:36864
ds_read_b64_tr_b16 a[22:23], v17 offset:38912
buffer_load_dwordx4 v11, s[12:15], s33 offen offset:1024 lds
v_mfma_f32_32x32x16_bf16 v[80:95], a[4:7], a[12:15], v[80:95]
s_waitcnt lgkmcnt(0)
v_mfma_f32_32x32x16_bf16 v[32:47], a[16:19], a[24:27], v[32:47]
ds_read_b128 a[8:11], v18 offset:34816
buffer_load_dwordx4 v11, s[12:15], s33 offen offset:2048 lds
ds_read_b128 a[12:15], v18 offset:38912
v_mfma_f32_32x32x16_bf16 v[64:79], a[16:19], a[28:31], v[64:79]
ds_read_b64_tr_b16 a[0:1], v16 offset:40960
ds_read_b64_tr_b16 a[2:3], v16 offset:43008
v_mfma_f32_32x32x16_bf16 v[48:63], a[20:23], a[24:27], v[48:63]
ds_read_b64_tr_b16 a[4:5], v17 offset:40960
ds_read_b64_tr_b16 a[6:7], v17 offset:43008
buffer_load_dwordx4 v11, s[12:15], s33 offen offset:3072 lds
v_mfma_f32_32x32x16_bf16 v[80:95], a[20:23], a[28:31], v[80:95]
s_waitcnt lgkmcnt(0)
v_mfma_f32_32x32x16_bf16 v[32:47], a[0:3], a[8:11], v[32:47]
ds_read_b128 a[24:27], v18 offset:35840
s_add_u32 m0, s36, 65536
ds_read_b128 a[28:31], v18 offset:39936
s_add_u32 s32, s34, 393216
buffer_load_dwordx4 v10, s[8:11], s32 offen lds
v_mfma_f32_32x32x16_bf16 v[64:79], a[0:3], a[12:15], v[64:79]
ds_read_b64_tr_b16 a[16:17], v16 offset:45056
ds_read_b64_tr_b16 a[18:19], v16 offset:47104
v_mfma_f32_32x32x16_bf16 v[48:63], a[4:7], a[8:11], v[48:63]
ds_read_b64_tr_b16 a[20:21], v17 offset:45056
ds_read_b64_tr_b16 a[22:23], v17 offset:47104
s_add_u32 m0, s36, 66560
s_add_u32 s32, s34, 397312
buffer_load_dwordx4 v10, s[8:11], s32 offen lds
v_mfma_f32_32x32x16_bf16 v[80:95], a[4:7], a[12:15], v[80:95]
s_waitcnt lgkmcnt(0)
s_waitcnt vmcnt(14)
s_barrier
v_mfma_f32_32x32x16_bf16 v[32:47], a[16:19], a[24:27], v[32:47]
ds_read_b128 a[8:11], v14 offset:0
s_add_u32 m0, s36, 67584
ds_read_b128 a[12:15], v14 offset:4096
s_add_u32 s32, s34, 401408
buffer_load_dwordx4 v10, s[8:11], s32 offen lds
v_mfma_f32_32x32x16_bf16 v[64:79], a[16:19], a[28:31], v[64:79]
ds_read_b64_tr_b16 a[0:1], v12 offset:0
ds_read_b64_tr_b16 a[2:3], v12 offset:2048
v_mfma_f32_32x32x16_bf16 v[48:63], a[20:23], a[24:27], v[48:63]
ds_read_b64_tr_b16 a[4:5], v13 offset:0
ds_read_b64_tr_b16 a[6:7], v13 offset:2048
s_add_u32 m0, s36, 68608
s_add_u32 s32, s34, 405504
buffer_load_dwordx4 v10, s[8:11], s32 offen lds
v_mfma_f32_32x32x16_bf16 v[80:95], a[20:23], a[28:31], v[80:95]
s_waitcnt lgkmcnt(0)
v_mfma_f32_32x32x16_bf16 v[32:47], a[0:3], a[8:11], v[32:47]
ds_read_b128 a[24:27], v14 offset:1024
s_add_u32 m0, s37, 98304
ds_read_b128 a[28:31], v14 offset:5120
s_add_u32 s33, s35, 28672
buffer_load_dwordx4 v11, s[12:15], s33 offen offset:0 lds
v_mfma_f32_32x32x16_bf16 v[64:79], a[0:3], a[12:15], v[64:79]
ds_read_b64_tr_b16 a[16:17], v12 offset:4096
ds_read_b64_tr_b16 a[18:19], v12 offset:6144
v_mfma_f32_32x32x16_bf16 v[48:63], a[4:7], a[8:11], v[48:63]
ds_read_b64_tr_b16 a[20:21], v13 offset:4096
ds_read_b64_tr_b16 a[22:23], v13 offset:6144
buffer_load_dwordx4 v11, s[12:15], s33 offen offset:1024 lds
v_mfma_f32_32x32x16_bf16 v[80:95], a[4:7], a[12:15], v[80:95]
s_waitcnt lgkmcnt(0)
v_mfma_f32_32x32x16_bf16 v[32:47], a[16:19], a[24:27], v[32:47]
ds_read_b128 a[8:11], v14 offset:2048
buffer_load_dwordx4 v11, s[12:15], s33 offen offset:2048 lds
ds_read_b128 a[12:15], v14 offset:6144
v_mfma_f32_32x32x16_bf16 v[64:79], a[16:19], a[28:31], v[64:79]
ds_read_b64_tr_b16 a[0:1], v12 offset:8192
ds_read_b64_tr_b16 a[2:3], v12 offset:10240
v_mfma_f32_32x32x16_bf16 v[48:63], a[20:23], a[24:27], v[48:63]
ds_read_b64_tr_b16 a[4:5], v13 offset:8192
ds_read_b64_tr_b16 a[6:7], v13 offset:10240
buffer_load_dwordx4 v11, s[12:15], s33 offen offset:3072 lds
v_mfma_f32_32x32x16_bf16 v[80:95], a[20:23], a[28:31], v[80:95]
s_waitcnt lgkmcnt(0)
v_mfma_f32_32x32x16_bf16 v[32:47], a[0:3], a[8:11], v[32:47]
ds_read_b128 a[24:27], v14 offset:3072
s_add_u32 m0, s36, 98304
ds_read_b128 a[28:31], v14 offset:7168
s_add_u32 s32, s34, 458752
buffer_load_dwordx4 v10, s[8:11], s32 offen lds
v_mfma_f32_32x32x16_bf16 v[64:79], a[0:3], a[12:15], v[64:79]
ds_read_b64_tr_b16 a[16:17], v12 offset:12288
ds_read_b64_tr_b16 a[18:19], v12 offset:14336
v_mfma_f32_32x32x16_bf16 v[48:63], a[4:7], a[8:11], v[48:63]
ds_read_b64_tr_b16 a[20:21], v13 offset:12288
ds_read_b64_tr_b16 a[22:23], v13 offset:14336
s_add_u32 m0, s36, 99328
s_add_u32 s32, s34, 462848
buffer_load_dwordx4 v10, s[8:11], s32 offen lds
v_mfma_f32_32x32x16_bf16 v[80:95], a[4:7], a[12:15], v[80:95]
s_waitcnt lgkmcnt(0)
s_waitcnt vmcnt(14)
s_barrier
v_mfma_f32_32x32x16_bf16 v[32:47], a[16:19], a[24:27], v[32:47]
ds_read_b128 a[8:11], v14 offset:32768
s_add_u32 m0, s36, 100352
ds_read_b128 a[12:15], v14 offset:36864
s_add_u32 s32, s34, 466944
buffer_load_dwordx4 v10, s[8:11], s32 offen lds
v_mfma_f32_32x32x16_bf16 v[64:79], a[16:19], a[28:31], v[64:79]
ds_read_b64_tr_b16 a[0:1], v12 offset:32768
ds_read_b64_tr_b16 a[2:3], v12 offset:34816
v_mfma_f32_32x32x16_bf16 v[48:63], a[20:23], a[24:27], v[48:63]
ds_read_b64_tr_b16 a[4:5], v13 offset:32768
ds_read_b64_tr_b16 a[6:7], v13 offset:34816
s_add_u32 m0, s36, 101376
s_add_u32 s32, s34, 471040
buffer_load_dwordx4 v10, s[8:11], s32 offen lds
v_mfma_f32_32x32x16_bf16 v[80:95], a[20:23], a[28:31], v[80:95]
s_waitcnt lgkmcnt(0)
v_mfma_f32_32x32x16_bf16 v[32:47], a[0:3], a[8:11], v[32:47]
ds_read_b128 a[24:27], v14 offset:33792
s_add_u32 m0, s37, 0
ds_read_b128 a[28:31], v14 offset:37888
s_add_u32 s33, s35, 32768
buffer_load_dwordx4 v11, s[12:15], s33 offen offset:0 lds
v_mfma_f32_32x32x16_bf16 v[64:79], a[0:3], a[12:15], v[64:79]
ds_read_b64_tr_b16 a[16:17], v12 offset:36864
ds_read_b64_tr_b16 a[18:19], v12 offset:38912
v_mfma_f32_32x32x16_bf16 v[48:63], a[4:7], a[8:11], v[48:63]
ds_read_b64_tr_b16 a[20:21], v13 offset:36864
ds_read_b64_tr_b16 a[22:23], v13 offset:38912
buffer_load_dwordx4 v11, s[12:15], s33 offen offset:1024 lds
v_mfma_f32_32x32x16_bf16 v[80:95], a[4:7], a[12:15], v[80:95]
s_waitcnt lgkmcnt(0)
v_mfma_f32_32x32x16_bf16 v[32:47], a[16:19], a[24:27], v[32:47]
ds_read_b128 a[8:11], v14 offset:34816
buffer_load_dwordx4 v11, s[12:15], s33 offen offset:2048 lds
ds_read_b128 a[12:15], v14 offset:38912
v_mfma_f32_32x32x16_bf16 v[64:79], a[16:19], a[28:31], v[64:79]
ds_read_b64_tr_b16 a[0:1], v12 offset:40960
ds_read_b64_tr_b16 a[2:3], v12 offset:43008
v_mfma_f32_32x32x16_bf16 v[48:63], a[20:23], a[24:27], v[48:63]
ds_read_b64_tr_b16 a[4:5], v13 offset:40960
ds_read_b64_tr_b16 a[6:7], v13 offset:43008
buffer_load_dwordx4 v11, s[12:15], s33 offen offset:3072 lds
v_mfma_f32_32x32x16_bf16 v[80:95], a[20:23], a[28:31], v[80:95]
s_waitcnt lgkmcnt(0)
v_mfma_f32_32x32x16_bf16 v[32:47], a[0:3], a[8:11], v[32:47]
ds_read_b128 a[24:27], v14 offset:35840
s_add_u32 m0, s36, 0
ds_read_b128 a[28:31], v14 offset:39936
s_add_u32 s32, s34, 524288
buffer_load_dwordx4 v10, s[8:11], s32 offen lds
v_mfma_f32_32x32x16_bf16 v[64:79], a[0:3], a[12:15], v[64:79]
ds_read_b64_tr_b16 a[16:17], v12 offset:45056
ds_read_b64_tr_b16 a[18:19], v12 offset:47104
v_mfma_f32_32x32x16_bf16 v[48:63], a[4:7], a[8:11], v[48:63]
ds_read_b64_tr_b16 a[20:21], v13 offset:45056
ds_read_b64_tr_b16 a[22:23], v13 offset:47104
s_add_u32 m0, s36, 1024
s_add_u32 s32, s34, 528384
buffer_load_dwordx4 v10, s[8:11], s32 offen lds
v_mfma_f32_32x32x16_bf16 v[80:95], a[4:7], a[12:15], v[80:95]
s_waitcnt lgkmcnt(0)
s_waitcnt vmcnt(14)
s_barrier
v_mfma_f32_32x32x16_bf16 v[32:47], a[16:19], a[24:27], v[32:47]
ds_read_b128 a[8:11], v18 offset:0
s_add_u32 m0, s36, 2048
ds_read_b128 a[12:15], v18 offset:4096
s_add_u32 s32, s34, 532480
buffer_load_dwordx4 v10, s[8:11], s32 offen lds
v_mfma_f32_32x32x16_bf16 v[64:79], a[16:19], a[28:31], v[64:79]
ds_read_b64_tr_b16 a[0:1], v16 offset:0
ds_read_b64_tr_b16 a[2:3], v16 offset:2048
v_mfma_f32_32x32x16_bf16 v[48:63], a[20:23], a[24:27], v[48:63]
ds_read_b64_tr_b16 a[4:5], v17 offset:0
ds_read_b64_tr_b16 a[6:7], v17 offset:2048
s_add_u32 m0, s36, 3072
s_add_u32 s32, s34, 536576
buffer_load_dwordx4 v10, s[8:11], s32 offen lds
v_mfma_f32_32x32x16_bf16 v[80:95], a[20:23], a[28:31], v[80:95]
s_waitcnt lgkmcnt(0)
v_mfma_f32_32x32x16_bf16 v[32:47], a[0:3], a[8:11], v[32:47]
ds_read_b128 a[24:27], v18 offset:1024
s_add_u32 m0, s37, 32768
ds_read_b128 a[28:31], v18 offset:5120
s_add_u32 s33, s35, 36864
buffer_load_dwordx4 v11, s[12:15], s33 offen offset:0 lds
v_mfma_f32_32x32x16_bf16 v[64:79], a[0:3], a[12:15], v[64:79]
ds_read_b64_tr_b16 a[16:17], v16 offset:4096
ds_read_b64_tr_b16 a[18:19], v16 offset:6144
v_mfma_f32_32x32x16_bf16 v[48:63], a[4:7], a[8:11], v[48:63]
ds_read_b64_tr_b16 a[20:21], v17 offset:4096
ds_read_b64_tr_b16 a[22:23], v17 offset:6144
buffer_load_dwordx4 v11, s[12:15], s33 offen offset:1024 lds
v_mfma_f32_32x32x16_bf16 v[80:95], a[4:7], a[12:15], v[80:95]
s_waitcnt lgkmcnt(0)
v_mfma_f32_32x32x16_bf16 v[32:47], a[16:19], a[24:27], v[32:47]
ds_read_b128 a[8:11], v18 offset:2048
buffer_load_dwordx4 v11, s[12:15], s33 offen offset:2048 lds
ds_read_b128 a[12:15], v18 offset:6144
v_mfma_f32_32x32x16_bf16 v[64:79], a[16:19], a[28:31], v[64:79]
ds_read_b64_tr_b16 a[0:1], v16 offset:8192
ds_read_b64_tr_b16 a[2:3], v16 offset:10240
v_mfma_f32_32x32x16_bf16 v[48:63], a[20:23], a[24:27], v[48:63]
ds_read_b64_tr_b16 a[4:5], v17 offset:8192
ds_read_b64_tr_b16 a[6:7], v17 offset:10240
buffer_load_dwordx4 v11, s[12:15], s33 offen offset:3072 lds
v_mfma_f32_32x32x16_bf16 v[80:95], a[20:23], a[28:31], v[80:95]
s_waitcnt lgkmcnt(0)
v_mfma_f32_32x32x16_bf16 v[32:47], a[0:3], a[8:11], v[32:47]
ds_read_b128 a[24:27], v18 offset:3072
s_add_u32 m0, s36, 32768
ds_read_b128 a[28:31], v18 offset:7168
s_add_u32 s32, s34, 589824
buffer_load_dwordx4 v10, s[8:11], s32 offen lds
v_mfma_f32_32x32x16_bf16 v[64:79], a[0:3], a[12:15], v[64:79]
ds_read_b64_tr_b16 a[16:17], v16 offset:12288
ds_read_b64_tr_b16 a[18:19], v16 offset:14336
v_mfma_f32_32x32x16_bf16 v[48:63], a[4:7], a[8:11], v[48:63]
ds_read_b64_tr_b16 a[20:21], v17 offset:12288
ds_read_b64_tr_b16 a[22:23], v17 offset:14336
s_add_u32 m0, s36, 33792
s_add_u32 s32, s34, 593920
buffer_load_dwordx4 v10, s[8:11], s32 offen lds
v_mfma_f32_32x32x16_bf16 v[80:95], a[4:7], a[12:15], v[80:95]
s_waitcnt lgkmcnt(0)
s_waitcnt vmcnt(14)
s_barrier
v_mfma_f32_32x32x16_bf16 v[32:47], a[16:19], a[24:27], v[32:47]
ds_read_b128 a[8:11], v18 offset:32768
s_add_u32 m0, s36, 34816
ds_read_b128 a[12:15], v18 offset:36864
s_add_u32 s32, s34, 598016
buffer_load_dwordx4 v10, s[8:11], s32 offen lds
v_mfma_f32_32x32x16_bf16 v[64:79], a[16:19], a[28:31], v[64:79]
ds_read_b64_tr_b16 a[0:1], v16 offset:32768
ds_read_b64_tr_b16 a[2:3], v16 offset:34816
v_mfma_f32_32x32x16_bf16 v[48:63], a[20:23], a[24:27], v[48:63]
ds_read_b64_tr_b16 a[4:5], v17 offset:32768
ds_read_b64_tr_b16 a[6:7], v17 offset:34816
s_add_u32 m0, s36, 35840
s_add_u32 s32, s34, 602112
buffer_load_dwordx4 v10, s[8:11], s32 offen lds
v_mfma_f32_32x32x16_bf16 v[80:95], a[20:23], a[28:31], v[80:95]
s_waitcnt lgkmcnt(0)
v_mfma_f32_32x32x16_bf16 v[32:47], a[0:3], a[8:11], v[32:47]
ds_read_b128 a[24:27], v18 offset:33792
s_add_u32 m0, s37, 65536
ds_read_b128 a[28:31], v18 offset:37888
s_add_u32 s33, s35, 40960
buffer_load_dwordx4 v11, s[12:15], s33 offen offset:0 lds
v_mfma_f32_32x32x16_bf16 v[64:79], a[0:3], a[12:15], v[64:79]
ds_read_b64_tr_b16 a[16:17], v16 offset:36864
ds_read_b64_tr_b16 a[18:19], v16 offset:38912
v_mfma_f32_32x32x16_bf16 v[48:63], a[4:7], a[8:11], v[48:63]
ds_read_b64_tr_b16 a[20:21], v17 offset:36864
ds_read_b64_tr_b16 a[22:23], v17 offset:38912
buffer_load_dwordx4 v11, s[12:15], s33 offen offset:1024 lds
v_mfma_f32_32x32x16_bf16 v[80:95], a[4:7], a[12:15], v[80:95]
s_waitcnt lgkmcnt(0)
v_mfma_f32_32x32x16_bf16 v[32:47], a[16:19], a[24:27], v[32:47]
ds_read_b128 a[8:11], v18 offset:34816
buffer_load_dwordx4 v11, s[12:15], s33 offen offset:2048 lds
ds_read_b128 a[12:15], v18 offset:38912
v_mfma_f32_32x32x16_bf16 v[64:79], a[16:19], a[28:31], v[64:79]
ds_read_b64_tr_b16 a[0:1], v16 offset:40960
ds_read_b64_tr_b16 a[2:3], v16 offset:43008
v_mfma_f32_32x32x16_bf16 v[48:63], a[20:23], a[24:27], v[48:63]
ds_read_b64_tr_b16 a[4:5], v17 offset:40960
ds_read_b64_tr_b16 a[6:7], v17 offset:43008
buffer_load_dwordx4 v11, s[12:15], s33 offen offset:3072 lds
v_mfma_f32_32x32x16_bf16 v[80:95], a[20:23], a[28:31], v[80:95]
s_waitcnt lgkmcnt(0)
v_mfma_f32_32x32x16_bf16 v[32:47], a[0:3], a[8:11], v[32:47]
ds_read_b128 a[24:27], v18 offset:35840
s_add_u32 m0, s36, 65536
ds_read_b128 a[28:31], v18 offset:39936
s_add_u32 s32, s34, 655360
buffer_load_dwordx4 v10, s[8:11], s32 offen lds
v_mfma_f32_32x32x16_bf16 v[64:79], a[0:3], a[12:15], v[64:79]
ds_read_b64_tr_b16 a[16:17], v16 offset:45056
ds_read_b64_tr_b16 a[18:19], v16 offset:47104
v_mfma_f32_32x32x16_bf16 v[48:63], a[4:7], a[8:11], v[48:63]
ds_read_b64_tr_b16 a[20:21], v17 offset:45056
ds_read_b64_tr_b16 a[22:23], v17 offset:47104
s_add_u32 m0, s36, 66560
s_add_u32 s32, s34, 659456
buffer_load_dwordx4 v10, s[8:11], s32 offen lds
v_mfma_f32_32x32x16_bf16 v[80:95], a[4:7], a[12:15], v[80:95]
s_waitcnt lgkmcnt(0)
s_waitcnt vmcnt(14)
s_barrier
v_mfma_f32_32x32x16_bf16 v[32:47], a[16:19], a[24:27], v[32:47]
ds_read_b128 a[8:11], v14 offset:0
s_add_u32 m0, s36, 67584
ds_read_b128 a[12:15], v14 offset:4096
s_add_u32 s32, s34, 663552
buffer_load_dwordx4 v10, s[8:11], s32 offen lds
v_mfma_f32_32x32x16_bf16 v[64:79], a[16:19], a[28:31], v[64:79]
ds_read_b64_tr_b16 a[0:1], v12 offset:0
ds_read_b64_tr_b16 a[2:3], v12 offset:2048
v_mfma_f32_32x32x16_bf16 v[48:63], a[20:23], a[24:27], v[48:63]
ds_read_b64_tr_b16 a[4:5], v13 offset:0
ds_read_b64_tr_b16 a[6:7], v13 offset:2048
s_add_u32 m0, s36, 68608
s_add_u32 s32, s34, 667648
buffer_load_dwordx4 v10, s[8:11], s32 offen lds
v_mfma_f32_32x32x16_bf16 v[80:95], a[20:23], a[28:31], v[80:95]
s_waitcnt lgkmcnt(0)
v_mfma_f32_32x32x16_bf16 v[32:47], a[0:3], a[8:11], v[32:47]
ds_read_b128 a[24:27], v14 offset:1024
s_add_u32 m0, s37, 98304
ds_read_b128 a[28:31], v14 offset:5120
s_add_u32 s33, s35, 45056
buffer_load_dwordx4 v11, s[12:15], s33 offen offset:0 lds
v_mfma_f32_32x32x16_bf16 v[64:79], a[0:3], a[12:15], v[64:79]
ds_read_b64_tr_b16 a[16:17], v12 offset:4096
ds_read_b64_tr_b16 a[18:19], v12 offset:6144
v_mfma_f32_32x32x16_bf16 v[48:63], a[4:7], a[8:11], v[48:63]
ds_read_b64_tr_b16 a[20:21], v13 offset:4096
ds_read_b64_tr_b16 a[22:23], v13 offset:6144
buffer_load_dwordx4 v11, s[12:15], s33 offen offset:1024 lds
v_mfma_f32_32x32x16_bf16 v[80:95], a[4:7], a[12:15], v[80:95]
s_waitcnt lgkmcnt(0)
v_mfma_f32_32x32x16_bf16 v[32:47], a[16:19], a[24:27], v[32:47]
ds_read_b128 a[8:11], v14 offset:2048
buffer_load_dwordx4 v11, s[12:15], s33 offen offset:2048 lds
ds_read_b128 a[12:15], v14 offset:6144
v_mfma_f32_32x32x16_bf16 v[64:79], a[16:19], a[28:31], v[64:79]
ds_read_b64_tr_b16 a[0:1], v12 offset:8192
ds_read_b64_tr_b16 a[2:3], v12 offset:10240
v_mfma_f32_32x32x16_bf16 v[48:63], a[20:23], a[24:27], v[48:63]
ds_read_b64_tr_b16 a[4:5], v13 offset:8192
ds_read_b64_tr_b16 a[6:7], v13 offset:10240
buffer_load_dwordx4 v11, s[12:15], s33 offen offset:3072 lds
v_mfma_f32_32x32x16_bf16 v[80:95], a[20:23], a[28:31], v[80:95]
s_waitcnt lgkmcnt(0)
v_mfma_f32_32x32x16_bf16 v[32:47], a[0:3], a[8:11], v[32:47]
ds_read_b128 a[24:27], v14 offset:3072
s_add_u32 m0, s36, 98304
ds_read_b128 a[28:31], v14 offset:7168
s_add_u32 s32, s34, 720896
buffer_load_dwordx4 v10, s[8:11], s32 offen lds
v_mfma_f32_32x32x16_bf16 v[64:79], a[0:3], a[12:15], v[64:79]
ds_read_b64_tr_b16 a[16:17], v12 offset:12288
ds_read_b64_tr_b16 a[18:19], v12 offset:14336
v_mfma_f32_32x32x16_bf16 v[48:63], a[4:7], a[8:11], v[48:63]
ds_read_b64_tr_b16 a[20:21], v13 offset:12288
ds_read_b64_tr_b16 a[22:23], v13 offset:14336
s_add_u32 m0, s36, 99328
s_add_u32 s32, s34, 724992
buffer_load_dwordx4 v10, s[8:11], s32 offen lds
v_mfma_f32_32x32x16_bf16 v[80:95], a[4:7], a[12:15], v[80:95]
s_waitcnt lgkmcnt(0)
s_waitcnt vmcnt(14)
s_barrier
v_mfma_f32_32x32x16_bf16 v[32:47], a[16:19], a[24:27], v[32:47]
ds_read_b128 a[8:11], v14 offset:32768
s_add_u32 m0, s36, 100352
ds_read_b128 a[12:15], v14 offset:36864
s_add_u32 s32, s34, 729088
buffer_load_dwordx4 v10, s[8:11], s32 offen lds
v_mfma_f32_32x32x16_bf16 v[64:79], a[16:19], a[28:31], v[64:79]
ds_read_b64_tr_b16 a[0:1], v12 offset:32768
ds_read_b64_tr_b16 a[2:3], v12 offset:34816
v_mfma_f32_32x32x16_bf16 v[48:63], a[20:23], a[24:27], v[48:63]
ds_read_b64_tr_b16 a[4:5], v13 offset:32768
ds_read_b64_tr_b16 a[6:7], v13 offset:34816
s_add_u32 m0, s36, 101376
s_add_u32 s32, s34, 733184
buffer_load_dwordx4 v10, s[8:11], s32 offen lds
v_mfma_f32_32x32x16_bf16 v[80:95], a[20:23], a[28:31], v[80:95]
s_waitcnt lgkmcnt(0)
v_mfma_f32_32x32x16_bf16 v[32:47], a[0:3], a[8:11], v[32:47]
ds_read_b128 a[24:27], v14 offset:33792
s_add_u32 m0, s37, 0
ds_read_b128 a[28:31], v14 offset:37888
s_add_u32 s33, s35, 49152
buffer_load_dwordx4 v11, s[12:15], s33 offen offset:0 lds
v_mfma_f32_32x32x16_bf16 v[64:79], a[0:3], a[12:15], v[64:79]
ds_read_b64_tr_b16 a[16:17], v12 offset:36864
ds_read_b64_tr_b16 a[18:19], v12 offset:38912
v_mfma_f32_32x32x16_bf16 v[48:63], a[4:7], a[8:11], v[48:63]
ds_read_b64_tr_b16 a[20:21], v13 offset:36864
ds_read_b64_tr_b16 a[22:23], v13 offset:38912
buffer_load_dwordx4 v11, s[12:15], s33 offen offset:1024 lds
v_mfma_f32_32x32x16_bf16 v[80:95], a[4:7], a[12:15], v[80:95]
s_waitcnt lgkmcnt(0)
v_mfma_f32_32x32x16_bf16 v[32:47], a[16:19], a[24:27], v[32:47]
ds_read_b128 a[8:11], v14 offset:34816
buffer_load_dwordx4 v11, s[12:15], s33 offen offset:2048 lds
ds_read_b128 a[12:15], v14 offset:38912
v_mfma_f32_32x32x16_bf16 v[64:79], a[16:19], a[28:31], v[64:79]
ds_read_b64_tr_b16 a[0:1], v12 offset:40960
ds_read_b64_tr_b16 a[2:3], v12 offset:43008
v_mfma_f32_32x32x16_bf16 v[48:63], a[20:23], a[24:27], v[48:63]
ds_read_b64_tr_b16 a[4:5], v13 offset:40960
ds_read_b64_tr_b16 a[6:7], v13 offset:43008
buffer_load_dwordx4 v11, s[12:15], s33 offen offset:3072 lds
v_mfma_f32_32x32x16_bf16 v[80:95], a[20:23], a[28:31], v[80:95]
s_waitcnt lgkmcnt(0)
v_mfma_f32_32x32x16_bf16 v[32:47], a[0:3], a[8:11], v[32:47]
ds_read_b128 a[24:27], v14 offset:35840
s_add_u32 m0, s36, 0
ds_read_b128 a[28:31], v14 offset:39936
s_add_u32 s32, s34, 786432
buffer_load_dwordx4 v10, s[8:11], s32 offen lds
v_mfma_f32_32x32x16_bf16 v[64:79], a[0:3], a[12:15], v[64:79]
ds_read_b64_tr_b16 a[16:17], v12 offset:45056
ds_read_b64_tr_b16 a[18:19], v12 offset:47104
v_mfma_f32_32x32x16_bf16 v[48:63], a[4:7], a[8:11], v[48:63]
ds_read_b64_tr_b16 a[20:21], v13 offset:45056
ds_read_b64_tr_b16 a[22:23], v13 offset:47104
s_add_u32 m0, s36, 1024
s_add_u32 s32, s34, 790528
buffer_load_dwordx4 v10, s[8:11], s32 offen lds
v_mfma_f32_32x32x16_bf16 v[80:95], a[4:7], a[12:15], v[80:95]
s_waitcnt lgkmcnt(0)
s_waitcnt vmcnt(14)
s_barrier
v_mfma_f32_32x32x16_bf16 v[32:47], a[16:19], a[24:27], v[32:47]
ds_read_b128 a[8:11], v18 offset:0
s_add_u32 m0, s36, 2048
ds_read_b128 a[12:15], v18 offset:4096
s_add_u32 s32, s34, 794624
buffer_load_dwordx4 v10, s[8:11], s32 offen lds
v_mfma_f32_32x32x16_bf16 v[64:79], a[16:19], a[28:31], v[64:79]
ds_read_b64_tr_b16 a[0:1], v16 offset:0
ds_read_b64_tr_b16 a[2:3], v16 offset:2048
v_mfma_f32_32x32x16_bf16 v[48:63], a[20:23], a[24:27], v[48:63]
ds_read_b64_tr_b16 a[4:5], v17 offset:0
ds_read_b64_tr_b16 a[6:7], v17 offset:2048
s_add_u32 m0, s36, 3072
s_add_u32 s32, s34, 798720
buffer_load_dwordx4 v10, s[8:11], s32 offen lds
v_mfma_f32_32x32x16_bf16 v[80:95], a[20:23], a[28:31], v[80:95]
s_waitcnt lgkmcnt(0)
v_mfma_f32_32x32x16_bf16 v[32:47], a[0:3], a[8:11], v[32:47]
ds_read_b128 a[24:27], v18 offset:1024
s_add_u32 m0, s37, 32768
ds_read_b128 a[28:31], v18 offset:5120
s_add_u32 s33, s35, 53248
buffer_load_dwordx4 v11, s[12:15], s33 offen offset:0 lds
v_mfma_f32_32x32x16_bf16 v[64:79], a[0:3], a[12:15], v[64:79]
ds_read_b64_tr_b16 a[16:17], v16 offset:4096
ds_read_b64_tr_b16 a[18:19], v16 offset:6144
v_mfma_f32_32x32x16_bf16 v[48:63], a[4:7], a[8:11], v[48:63]
ds_read_b64_tr_b16 a[20:21], v17 offset:4096
ds_read_b64_tr_b16 a[22:23], v17 offset:6144
buffer_load_dwordx4 v11, s[12:15], s33 offen offset:1024 lds
v_mfma_f32_32x32x16_bf16 v[80:95], a[4:7], a[12:15], v[80:95]
s_waitcnt lgkmcnt(0)
v_mfma_f32_32x32x16_bf16 v[32:47], a[16:19], a[24:27], v[32:47]
ds_read_b128 a[8:11], v18 offset:2048
buffer_load_dwordx4 v11, s[12:15], s33 offen offset:2048 lds
ds_read_b128 a[12:15], v18 offset:6144
v_mfma_f32_32x32x16_bf16 v[64:79], a[16:19], a[28:31], v[64:79]
ds_read_b64_tr_b16 a[0:1], v16 offset:8192
ds_read_b64_tr_b16 a[2:3], v16 offset:10240
v_mfma_f32_32x32x16_bf16 v[48:63], a[20:23], a[24:27], v[48:63]
ds_read_b64_tr_b16 a[4:5], v17 offset:8192
ds_read_b64_tr_b16 a[6:7], v17 offset:10240
buffer_load_dwordx4 v11, s[12:15], s33 offen offset:3072 lds
v_mfma_f32_32x32x16_bf16 v[80:95], a[20:23], a[28:31], v[80:95]
s_waitcnt lgkmcnt(0)
v_mfma_f32_32x32x16_bf16 v[32:47], a[0:3], a[8:11], v[32:47]
ds_read_b128 a[24:27], v18 offset:3072
s_add_u32 m0, s36, 32768
ds_read_b128 a[28:31], v18 offset:7168
s_add_u32 s32, s34, 851968
buffer_load_dwordx4 v10, s[8:11], s32 offen lds
v_mfma_f32_32x32x16_bf16 v[64:79], a[0:3], a[12:15], v[64:79]
ds_read_b64_tr_b16 a[16:17], v16 offset:12288
ds_read_b64_tr_b16 a[18:19], v16 offset:14336
v_mfma_f32_32x32x16_bf16 v[48:63], a[4:7], a[8:11], v[48:63]
ds_read_b64_tr_b16 a[20:21], v17 offset:12288
ds_read_b64_tr_b16 a[22:23], v17 offset:14336
s_add_u32 m0, s36, 33792
s_add_u32 s32, s34, 856064
buffer_load_dwordx4 v10, s[8:11], s32 offen lds
v_mfma_f32_32x32x16_bf16 v[80:95], a[4:7], a[12:15], v[80:95]
s_waitcnt lgkmcnt(0)
s_waitcnt vmcnt(14)
s_barrier
v_mfma_f32_32x32x16_bf16 v[32:47], a[16:19], a[24:27], v[32:47]
ds_read_b128 a[8:11], v18 offset:32768
s_add_u32 m0, s36, 34816
ds_read_b128 a[12:15], v18 offset:36864
s_add_u32 s32, s34, 860160
buffer_load_dwordx4 v10, s[8:11], s32 offen lds
v_mfma_f32_32x32x16_bf16 v[64:79], a[16:19], a[28:31], v[64:79]
ds_read_b64_tr_b16 a[0:1], v16 offset:32768
ds_read_b64_tr_b16 a[2:3], v16 offset:34816
v_mfma_f32_32x32x16_bf16 v[48:63], a[20:23], a[24:27], v[48:63]
ds_read_b64_tr_b16 a[4:5], v17 offset:32768
ds_read_b64_tr_b16 a[6:7], v17 offset:34816
s_add_u32 m0, s36, 35840
s_add_u32 s32, s34, 864256
buffer_load_dwordx4 v10, s[8:11], s32 offen lds
v_mfma_f32_32x32x16_bf16 v[80:95], a[20:23], a[28:31], v[80:95]
s_waitcnt lgkmcnt(0)
v_mfma_f32_32x32x16_bf16 v[32:47], a[0:3], a[8:11], v[32:47]
ds_read_b128 a[24:27], v18 offset:33792
s_add_u32 m0, s37, 65536
ds_read_b128 a[28:31], v18 offset:37888
s_add_u32 s33, s35, 57344
buffer_load_dwordx4 v11, s[12:15], s33 offen offset:0 lds
v_mfma_f32_32x32x16_bf16 v[64:79], a[0:3], a[12:15], v[64:79]
ds_read_b64_tr_b16 a[16:17], v16 offset:36864
ds_read_b64_tr_b16 a[18:19], v16 offset:38912
v_mfma_f32_32x32x16_bf16 v[48:63], a[4:7], a[8:11], v[48:63]
ds_read_b64_tr_b16 a[20:21], v17 offset:36864
ds_read_b64_tr_b16 a[22:23], v17 offset:38912
buffer_load_dwordx4 v11, s[12:15], s33 offen offset:1024 lds
v_mfma_f32_32x32x16_bf16 v[80:95], a[4:7], a[12:15], v[80:95]
s_waitcnt lgkmcnt(0)
v_mfma_f32_32x32x16_bf16 v[32:47], a[16:19], a[24:27], v[32:47]
ds_read_b128 a[8:11], v18 offset:34816
buffer_load_dwordx4 v11, s[12:15], s33 offen offset:2048 lds
ds_read_b128 a[12:15], v18 offset:38912
v_mfma_f32_32x32x16_bf16 v[64:79], a[16:19], a[28:31], v[64:79]
ds_read_b64_tr_b16 a[0:1], v16 offset:40960
ds_read_b64_tr_b16 a[2:3], v16 offset:43008
v_mfma_f32_32x32x16_bf16 v[48:63], a[20:23], a[24:27], v[48:63]
ds_read_b64_tr_b16 a[4:5], v17 offset:40960
ds_read_b64_tr_b16 a[6:7], v17 offset:43008
buffer_load_dwordx4 v11, s[12:15], s33 offen offset:3072 lds
v_mfma_f32_32x32x16_bf16 v[80:95], a[20:23], a[28:31], v[80:95]
s_waitcnt lgkmcnt(0)
v_mfma_f32_32x32x16_bf16 v[32:47], a[0:3], a[8:11], v[32:47]
ds_read_b128 a[24:27], v18 offset:35840
s_add_u32 m0, s36, 65536
ds_read_b128 a[28:31], v18 offset:39936
s_add_u32 s32, s34, 917504
buffer_load_dwordx4 v10, s[8:11], s32 offen lds
v_mfma_f32_32x32x16_bf16 v[64:79], a[0:3], a[12:15], v[64:79]
ds_read_b64_tr_b16 a[16:17], v16 offset:45056
ds_read_b64_tr_b16 a[18:19], v16 offset:47104
v_mfma_f32_32x32x16_bf16 v[48:63], a[4:7], a[8:11], v[48:63]
ds_read_b64_tr_b16 a[20:21], v17 offset:45056
ds_read_b64_tr_b16 a[22:23], v17 offset:47104
s_add_u32 m0, s36, 66560
s_add_u32 s32, s34, 921600
buffer_load_dwordx4 v10, s[8:11], s32 offen lds
v_mfma_f32_32x32x16_bf16 v[80:95], a[4:7], a[12:15], v[80:95]
s_waitcnt lgkmcnt(0)
s_waitcnt vmcnt(14)
s_barrier
v_mfma_f32_32x32x16_bf16 v[32:47], a[16:19], a[24:27], v[32:47]
ds_read_b128 a[8:11], v14 offset:0
s_add_u32 m0, s36, 67584
ds_read_b128 a[12:15], v14 offset:4096
s_add_u32 s32, s34, 925696
buffer_load_dwordx4 v10, s[8:11], s32 offen lds
v_mfma_f32_32x32x16_bf16 v[64:79], a[16:19], a[28:31], v[64:79]
ds_read_b64_tr_b16 a[0:1], v12 offset:0
ds_read_b64_tr_b16 a[2:3], v12 offset:2048
v_mfma_f32_32x32x16_bf16 v[48:63], a[20:23], a[24:27], v[48:63]
ds_read_b64_tr_b16 a[4:5], v13 offset:0
ds_read_b64_tr_b16 a[6:7], v13 offset:2048
s_add_u32 m0, s36, 68608
s_add_u32 s32, s34, 929792
buffer_load_dwordx4 v10, s[8:11], s32 offen lds
v_mfma_f32_32x32x16_bf16 v[80:95], a[20:23], a[28:31], v[80:95]
s_waitcnt lgkmcnt(0)
v_mfma_f32_32x32x16_bf16 v[32:47], a[0:3], a[8:11], v[32:47]
ds_read_b128 a[24:27], v14 offset:1024
s_add_u32 m0, s37, 98304
ds_read_b128 a[28:31], v14 offset:5120
s_add_u32 s33, s35, 61440
buffer_load_dwordx4 v11, s[12:15], s33 offen offset:0 lds
v_mfma_f32_32x32x16_bf16 v[64:79], a[0:3], a[12:15], v[64:79]
ds_read_b64_tr_b16 a[16:17], v12 offset:4096
ds_read_b64_tr_b16 a[18:19], v12 offset:6144
v_mfma_f32_32x32x16_bf16 v[48:63], a[4:7], a[8:11], v[48:63]
ds_read_b64_tr_b16 a[20:21], v13 offset:4096
ds_read_b64_tr_b16 a[22:23], v13 offset:6144
buffer_load_dwordx4 v11, s[12:15], s33 offen offset:1024 lds
v_mfma_f32_32x32x16_bf16 v[80:95], a[4:7], a[12:15], v[80:95]
s_waitcnt lgkmcnt(0)
v_mfma_f32_32x32x16_bf16 v[32:47], a[16:19], a[24:27], v[32:47]
ds_read_b128 a[8:11], v14 offset:2048
buffer_load_dwordx4 v11, s[12:15], s33 offen offset:2048 lds
ds_read_b128 a[12:15], v14 offset:6144
v_mfma_f32_32x32x16_bf16 v[64:79], a[16:19], a[28:31], v[64:79]
ds_read_b64_tr_b16 a[0:1], v12 offset:8192
ds_read_b64_tr_b16 a[2:3], v12 offset:10240
v_mfma_f32_32x32x16_bf16 v[48:63], a[20:23], a[24:27], v[48:63]
ds_read_b64_tr_b16 a[4:5], v13 offset:8192
ds_read_b64_tr_b16 a[6:7], v13 offset:10240
buffer_load_dwordx4 v11, s[12:15], s33 offen offset:3072 lds
v_mfma_f32_32x32x16_bf16 v[80:95], a[20:23], a[28:31], v[80:95]
s_waitcnt lgkmcnt(0)
v_mfma_f32_32x32x16_bf16 v[32:47], a[0:3], a[8:11], v[32:47]
ds_read_b128 a[24:27], v14 offset:3072
s_add_u32 m0, s36, 98304
ds_read_b128 a[28:31], v14 offset:7168
s_add_u32 s32, s34, 983040
buffer_load_dwordx4 v10, s[8:11], s32 offen lds
v_mfma_f32_32x32x16_bf16 v[64:79], a[0:3], a[12:15], v[64:79]
ds_read_b64_tr_b16 a[16:17], v12 offset:12288
ds_read_b64_tr_b16 a[18:19], v12 offset:14336
v_mfma_f32_32x32x16_bf16 v[48:63], a[4:7], a[8:11], v[48:63]
ds_read_b64_tr_b16 a[20:21], v13 offset:12288
ds_read_b64_tr_b16 a[22:23], v13 offset:14336
s_add_u32 m0, s36, 99328
s_add_u32 s32, s34, 987136
buffer_load_dwordx4 v10, s[8:11], s32 offen lds
v_mfma_f32_32x32x16_bf16 v[80:95], a[4:7], a[12:15], v[80:95]
s_waitcnt lgkmcnt(0)
s_waitcnt vmcnt(14)
s_barrier
v_mfma_f32_32x32x16_bf16 v[32:47], a[16:19], a[24:27], v[32:47]
ds_read_b128 a[8:11], v14 offset:32768
s_add_u32 m0, s36, 100352
ds_read_b128 a[12:15], v14 offset:36864
s_add_u32 s32, s34, 991232
buffer_load_dwordx4 v10, s[8:11], s32 offen lds
v_mfma_f32_32x32x16_bf16 v[64:79], a[16:19], a[28:31], v[64:79]
ds_read_b64_tr_b16 a[0:1], v12 offset:32768
ds_read_b64_tr_b16 a[2:3], v12 offset:34816
v_mfma_f32_32x32x16_bf16 v[48:63], a[20:23], a[24:27], v[48:63]
ds_read_b64_tr_b16 a[4:5], v13 offset:32768
ds_read_b64_tr_b16 a[6:7], v13 offset:34816
s_add_u32 m0, s36, 101376
s_add_u32 s32, s34, 995328
buffer_load_dwordx4 v10, s[8:11], s32 offen lds
v_mfma_f32_32x32x16_bf16 v[80:95], a[20:23], a[28:31], v[80:95]
s_waitcnt lgkmcnt(0)
v_mfma_f32_32x32x16_bf16 v[32:47], a[0:3], a[8:11], v[32:47]
ds_read_b128 a[24:27], v14 offset:33792
buffer_load_dwordx4 v[28:31], v19, s[60:63], s57 offen
ds_read_b128 a[28:31], v14 offset:37888
v_mfma_f32_32x32x16_bf16 v[64:79], a[0:3], a[12:15], v[64:79]
ds_read_b64_tr_b16 a[16:17], v12 offset:36864
ds_read_b64_tr_b16 a[18:19], v12 offset:38912
v_mfma_f32_32x32x16_bf16 v[48:63], a[4:7], a[8:11], v[48:63]
ds_read_b64_tr_b16 a[20:21], v13 offset:36864
ds_read_b64_tr_b16 a[22:23], v13 offset:38912
buffer_load_dwordx4 v[28:31], v19, s[44:47], s57 offen
v_mfma_f32_32x32x16_bf16 v[80:95], a[4:7], a[12:15], v[80:95]
s_waitcnt lgkmcnt(0)
v_mfma_f32_32x32x16_bf16 v[32:47], a[16:19], a[24:27], v[32:47]
ds_read_b128 a[8:11], v14 offset:34816
s_add_u32 s57, s57, 3584
ds_read_b128 a[12:15], v14 offset:38912
buffer_load_dwordx4 v[28:31], v19, s[60:63], s57 offen
v_mfma_f32_32x32x16_bf16 v[64:79], a[16:19], a[28:31], v[64:79]
ds_read_b64_tr_b16 a[0:1], v12 offset:40960
ds_read_b64_tr_b16 a[2:3], v12 offset:43008
v_mfma_f32_32x32x16_bf16 v[48:63], a[20:23], a[24:27], v[48:63]
ds_read_b64_tr_b16 a[4:5], v13 offset:40960
ds_read_b64_tr_b16 a[6:7], v13 offset:43008
buffer_load_dwordx4 v[28:31], v19, s[44:47], s57 offen
v_mfma_f32_32x32x16_bf16 v[80:95], a[20:23], a[28:31], v[80:95]
s_waitcnt lgkmcnt(0)
v_mfma_f32_32x32x16_bf16 v[32:47], a[0:3], a[8:11], v[32:47]
ds_read_b128 a[24:27], v14 offset:35840
s_add_u32 s57, s57, 3584
ds_read_b128 a[28:31], v14 offset:39936
buffer_load_dwordx4 v[28:31], v19, s[60:63], s57 offen
v_mfma_f32_32x32x16_bf16 v[64:79], a[0:3], a[12:15], v[64:79]
ds_read_b64_tr_b16 a[16:17], v12 offset:45056
ds_read_b64_tr_b16 a[18:19], v12 offset:47104
v_mfma_f32_32x32x16_bf16 v[48:63], a[4:7], a[8:11], v[48:63]
ds_read_b64_tr_b16 a[20:21], v13 offset:45056
ds_read_b64_tr_b16 a[22:23], v13 offset:47104
buffer_load_dwordx4 v[28:31], v19, s[44:47], s57 offen
v_mfma_f32_32x32x16_bf16 v[80:95], a[4:7], a[12:15], v[80:95]
s_waitcnt lgkmcnt(0)
s_waitcnt vmcnt(14)
s_barrier
v_mfma_f32_32x32x16_bf16 v[32:47], a[16:19], a[24:27], v[32:47]
ds_read_b128 a[8:11], v18 offset:0
s_add_u32 s57, s57, 3584
ds_read_b128 a[12:15], v18 offset:4096
buffer_load_dwordx4 v[28:31], v19, s[60:63], s57 offen
v_mfma_f32_32x32x16_bf16 v[64:79], a[16:19], a[28:31], v[64:79]
ds_read_b64_tr_b16 a[0:1], v16 offset:0
ds_read_b64_tr_b16 a[2:3], v16 offset:2048
v_mfma_f32_32x32x16_bf16 v[48:63], a[20:23], a[24:27], v[48:63]
ds_read_b64_tr_b16 a[4:5], v17 offset:0
ds_read_b64_tr_b16 a[6:7], v17 offset:2048
buffer_load_dwordx4 v[28:31], v19, s[44:47], s57 offen
v_mfma_f32_32x32x16_bf16 v[80:95], a[20:23], a[28:31], v[80:95]
s_waitcnt lgkmcnt(0)
v_mfma_f32_32x32x16_bf16 v[32:47], a[0:3], a[8:11], v[32:47]
ds_read_b128 a[24:27], v18 offset:1024
s_add_u32 s57, s57, 3584
ds_read_b128 a[28:31], v18 offset:5120
v_mfma_f32_32x32x16_bf16 v[64:79], a[0:3], a[12:15], v[64:79]
ds_read_b64_tr_b16 a[16:17], v16 offset:4096
ds_read_b64_tr_b16 a[18:19], v16 offset:6144
v_mfma_f32_32x32x16_bf16 v[48:63], a[4:7], a[8:11], v[48:63]
ds_read_b64_tr_b16 a[20:21], v17 offset:4096
ds_read_b64_tr_b16 a[22:23], v17 offset:6144
v_mfma_f32_32x32x16_bf16 v[80:95], a[4:7], a[12:15], v[80:95]
s_waitcnt lgkmcnt(0)
v_mfma_f32_32x32x16_bf16 v[32:47], a[16:19], a[24:27], v[32:47]
ds_read_b128 a[8:11], v18 offset:2048
ds_read_b128 a[12:15], v18 offset:6144
v_mfma_f32_32x32x16_bf16 v[64:79], a[16:19], a[28:31], v[64:79]
ds_read_b64_tr_b16 a[0:1], v16 offset:8192
ds_read_b64_tr_b16 a[2:3], v16 offset:10240
v_mfma_f32_32x32x16_bf16 v[48:63], a[20:23], a[24:27], v[48:63]
ds_read_b64_tr_b16 a[4:5], v17 offset:8192
ds_read_b64_tr_b16 a[6:7], v17 offset:10240
v_mfma_f32_32x32x16_bf16 v[80:95], a[20:23], a[28:31], v[80:95]
s_waitcnt lgkmcnt(0)
v_mfma_f32_32x32x16_bf16 v[32:47], a[0:3], a[8:11], v[32:47]
ds_read_b128 a[24:27], v18 offset:3072
ds_read_b128 a[28:31], v18 offset:7168
v_mfma_f32_32x32x16_bf16 v[64:79], a[0:3], a[12:15], v[64:79]
ds_read_b64_tr_b16 a[16:17], v16 offset:12288
ds_read_b64_tr_b16 a[18:19], v16 offset:14336
v_mfma_f32_32x32x16_bf16 v[48:63], a[4:7], a[8:11], v[48:63]
ds_read_b64_tr_b16 a[20:21], v17 offset:12288
ds_read_b64_tr_b16 a[22:23], v17 offset:14336
v_mfma_f32_32x32x16_bf16 v[80:95], a[4:7], a[12:15], v[80:95]
s_waitcnt lgkmcnt(0)
s_waitcnt vmcnt(8)
s_barrier
v_mfma_f32_32x32x16_bf16 v[32:47], a[16:19], a[24:27], v[32:47]
ds_read_b128 a[8:11], v18 offset:32768
ds_read_b128 a[12:15], v18 offset:36864
v_mfma_f32_32x32x16_bf16 v[64:79], a[16:19], a[28:31], v[64:79]
ds_read_b64_tr_b16 a[0:1], v16 offset:32768
ds_read_b64_tr_b16 a[2:3], v16 offset:34816
v_mfma_f32_32x32x16_bf16 v[48:63], a[20:23], a[24:27], v[48:63]
ds_read_b64_tr_b16 a[4:5], v17 offset:32768
ds_read_b64_tr_b16 a[6:7], v17 offset:34816
v_mfma_f32_32x32x16_bf16 v[80:95], a[20:23], a[28:31], v[80:95]
s_waitcnt lgkmcnt(0)
v_mfma_f32_32x32x16_bf16 v[32:47], a[0:3], a[8:11], v[32:47]
ds_read_b128 a[24:27], v18 offset:33792
ds_read_b128 a[28:31], v18 offset:37888
v_mfma_f32_32x32x16_bf16 v[64:79], a[0:3], a[12:15], v[64:79]
ds_read_b64_tr_b16 a[16:17], v16 offset:36864
ds_read_b64_tr_b16 a[18:19], v16 offset:38912
v_mfma_f32_32x32x16_bf16 v[48:63], a[4:7], a[8:11], v[48:63]
ds_read_b64_tr_b16 a[20:21], v17 offset:36864
ds_read_b64_tr_b16 a[22:23], v17 offset:38912
v_mfma_f32_32x32x16_bf16 v[80:95], a[4:7], a[12:15], v[80:95]
s_waitcnt lgkmcnt(0)
v_mfma_f32_32x32x16_bf16 v[32:47], a[16:19], a[24:27], v[32:47]
ds_read_b128 a[8:11], v18 offset:34816
ds_read_b128 a[12:15], v18 offset:38912
v_mfma_f32_32x32x16_bf16 v[64:79], a[16:19], a[28:31], v[64:79]
ds_read_b64_tr_b16 a[0:1], v16 offset:40960
ds_read_b64_tr_b16 a[2:3], v16 offset:43008
v_mfma_f32_32x32x16_bf16 v[48:63], a[20:23], a[24:27], v[48:63]
ds_read_b64_tr_b16 a[4:5], v17 offset:40960
ds_read_b64_tr_b16 a[6:7], v17 offset:43008
v_mfma_f32_32x32x16_bf16 v[80:95], a[20:23], a[28:31], v[80:95]
s_waitcnt lgkmcnt(0)
v_mfma_f32_32x32x16_bf16 v[32:47], a[0:3], a[8:11], v[32:47]
ds_read_b128 a[24:27], v18 offset:35840
ds_read_b128 a[28:31], v18 offset:39936
v_mfma_f32_32x32x16_bf16 v[64:79], a[0:3], a[12:15], v[64:79]
ds_read_b64_tr_b16 a[16:17], v16 offset:45056
ds_read_b64_tr_b16 a[18:19], v16 offset:47104
v_mfma_f32_32x32x16_bf16 v[48:63], a[4:7], a[8:11], v[48:63]
ds_read_b64_tr_b16 a[20:21], v17 offset:45056
ds_read_b64_tr_b16 a[22:23], v17 offset:47104
v_mfma_f32_32x32x16_bf16 v[80:95], a[4:7], a[12:15], v[80:95]
s_waitcnt lgkmcnt(0)
v_mfma_f32_32x32x16_bf16 v[32:47], a[16:19], a[24:27], v[32:47]
v_mfma_f32_32x32x16_bf16 v[64:79], a[16:19], a[28:31], v[64:79]
v_mfma_f32_32x32x16_bf16 v[48:63], a[20:23], a[24:27], v[48:63]
v_mfma_f32_32x32x16_bf16 v[80:95], a[20:23], a[28:31], v[80:95]
s_getpc_b64 s[60:61]
cpf_wo:
s_add_u32 s60, s60, ln2_kernel-cpf_wo
s_addc_u32 s61, s61, (ln2_kernel-cpf_wo)>>31
s_lshr_b32 s62, s2, 3
s_mul_i32 s62, s62, 4096
v_lshrrev_b32 v18, 6, v0
v_mul_u32_u24 v18, 0, v18
v_lshl_add_u32 v18, v0, 4, v18
v_add_u32 v18, s62, v18
v_min_u32 v19, down_kernel-ln2_kernel-16, v18
global_load_dwordx4 v[28:31], v19, s[60:61]
s_nop 11
v_cvt_pk_bf16_f32 v20, v32, v33
v_cvt_pk_bf16_f32 v21, v34, v35
v_cvt_pk_bf16_f32 v22, v36, v37
v_cvt_pk_bf16_f32 v23, v38, v39
buffer_store_dwordx4 v[20:23], v11, s[16:19], s38 offen offset:0
v_cvt_pk_bf16_f32 v24, v40, v41
v_cvt_pk_bf16_f32 v25, v42, v43
v_cvt_pk_bf16_f32 v26, v44, v45
v_cvt_pk_bf16_f32 v27, v46, v47
buffer_store_dwordx4 v[24:27], v11, s[16:19], s38 offen offset:1024
s_nop 0
v_cvt_pk_bf16_f32 v20, v48, v49
v_cvt_pk_bf16_f32 v21, v50, v51
v_cvt_pk_bf16_f32 v22, v52, v53
v_cvt_pk_bf16_f32 v23, v54, v55
buffer_store_dwordx4 v[20:23], v11, s[16:19], s39 offen offset:0
v_cvt_pk_bf16_f32 v24, v56, v57
v_cvt_pk_bf16_f32 v25, v58, v59
v_cvt_pk_bf16_f32 v26, v60, v61
v_cvt_pk_bf16_f32 v27, v62, v63
buffer_store_dwordx4 v[24:27], v11, s[16:19], s39 offen offset:1024
s_nop 0
v_cvt_pk_bf16_f32 v20, v64, v65
v_cvt_pk_bf16_f32 v21, v66, v67
v_cvt_pk_bf16_f32 v22, v68, v69
v_cvt_pk_bf16_f32 v23, v70, v71
buffer_store_dwordx4 v[20:23], v11, s[16:19], s40 offen offset:0
v_cvt_pk_bf16_f32 v24, v72, v73
v_cvt_pk_bf16_f32 v25, v74, v75
v_cvt_pk_bf16_f32 v26, v76, v77
v_cvt_pk_bf16_f32 v27, v78, v79
buffer_store_dwordx4 v[24:27], v11, s[16:19], s40 offen offset:1024
s_nop 0
v_cvt_pk_bf16_f32 v20, v80, v81
v_cvt_pk_bf16_f32 v21, v82, v83
v_cvt_pk_bf16_f32 v22, v84, v85
v_cvt_pk_bf16_f32 v23, v86, v87
buffer_store_dwordx4 v[20:23], v11, s[16:19], s41 offen offset:0
v_cvt_pk_bf16_f32 v24, v88, v89
v_cvt_pk_bf16_f32 v25, v90, v91
v_cvt_pk_bf16_f32 v26, v92, v93
v_cvt_pk_bf16_f32 v27, v94, v95
buffer_store_dwordx4 v[24:27], v11, s[16:19], s41 offen offset:1024
s_nop 0
wo_kernel_done:
s_endpgm
.globl ln2_kernel
.p2align 8
.type ln2_kernel,@function
ln2_kernel:
s_cmp_ge_u32 s2, 256
s_cbranch_scc1 ln2_kernel_done
s_load_dwordx2 s[4:5], s[0:1], 0
s_load_dwordx2 s[6:7], s[0:1], 104
v_and_b32 v1, 63, v0
v_lshrrev_b32 v2, 6, v0
v_and_b32 v3, 7, v1
v_bfe_u32 v4, v1, 3, 1
v_bfe_u32 v5, v1, 4, 1
v_lshrrev_b32 v6, 5, v1
v_lshl_add_u32 v7, v2, 2, v6
s_and_b32 s38, s2, 1
s_lshl_b32 s38, s38, 7
s_bfe_u32 s39, s2, 0x20001
s_lshl_b32 s39, s39, 5
s_add_u32 s38, s38, s39
s_lshr_b32 s39, s2, 3
s_add_u32 s38, s38, s39
s_and_b32 s3, s38, 3
s_lshl_b32 s3, s3, 3
v_add_u32 v8, s3, v3
s_lshr_b32 s28, s38, 2
v_lshl_add_u32 v9, v4, 5, v8
v_lshlrev_b32 v9, 4, v9
v_lshl_add_u32 v9, v5, 10, v9
v_lshl_add_u32 v9, v7, 11, v9
v_add_u32 v10, 4096, v9
s_lshl_b32 s29, s28, 15
s_add_u32 s30, s29, 2097152
s_add_u32 s31, s30, 2097152
s_add_u32 s32, s31, 2097152
v_lshlrev_b32 v11, 6, v7
v_lshl_add_u32 v11, v5, 5, v11
v_lshl_add_u32 v11, v4, 3, v11
v_lshl_add_u32 v12, v3, 10, v11
s_lshl_b32 s33, s38, 13
s_waitcnt lgkmcnt(0)
s_add_u32 s8, s6, 41943040
s_addc_u32 s9, s7, 0
s_and_b32 s9, s9, 0xffff
s_mov_b32 s10, 16777216
s_mov_b32 s11, 0x00020000
s_mov_b32 s12, s4
s_and_b32 s13, s5, 0xffff
s_mov_b32 s14, 2097152
s_mov_b32 s15, 0x00020000
s_add_u32 s16, s6, 0
s_addc_u32 s17, s7, 0
s_and_b32 s17, s17, 0xffff
s_mov_b32 s18, 6144
s_mov_b32 s19, 0x00020000
s_add_u32 s20, s6, 23068672
s_addc_u32 s21, s7, 0
s_and_b32 s21, s21, 0xffff
s_mov_b32 s22, 2097152
s_mov_b32 s23, 0x00020000
s_add_u32 s24, s6, 20971520
s_addc_u32 s25, s7, 0
s_and_b32 s25, s25, 0xffff
s_mov_b32 s26, 2097152
s_mov_b32 s27, 0x00020000
buffer_load_dwordx4 v[64:67], v9, s[8:11], s29 offen
buffer_load_dwordx4 v[68:71], v10, s[8:11], s29 offen
buffer_load_dwordx4 v[72:75], v9, s[8:11], s30 offen
buffer_load_dwordx4 v[76:79], v10, s[8:11], s30 offen
buffer_load_dwordx4 v[80:83], v9, s[8:11], s31 offen
buffer_load_dwordx4 v[84:87], v10, s[8:11], s31 offen
buffer_load_dwordx4 v[88:91], v9, s[8:11], s32 offen
buffer_load_dwordx4 v[92:95], v10, s[8:11], s32 offen
buffer_load_dwordx2 v[96:97], v12, s[12:15], s33 offen offset:0
buffer_load_dwordx2 v[98:99], v12, s[12:15], s33 offen offset:16
buffer_load_dwordx2 v[100:101], v12, s[12:15], s33 offen offset:128
buffer_load_dwordx2 v[102:103], v12, s[12:15], s33 offen offset:144
s_movk_i32 s34, 4096
buffer_load_dwordx2 v[104:105], v11, s[16:19], 0 offen offset:2048
buffer_load_dwordx2 v[106:107], v11, s[16:19], 0 offen offset:2064
buffer_load_dwordx2 v[108:109], v11, s[16:19], 0 offen offset:2176
buffer_load_dwordx2 v[110:111], v11, s[16:19], 0 offen offset:2192
buffer_load_dwordx2 v[112:113], v11, s[16:19], 0 offen offset:3072
buffer_load_dwordx2 v[114:115], v11, s[16:19], 0 offen offset:3088
buffer_load_dwordx2 v[116:117], v11, s[16:19], 0 offen offset:3200
buffer_load_dwordx2 v[118:119], v11, s[16:19], 0 offen offset:3216
buffer_load_dwordx2 v[120:121], v11, s[16:19], s34 offen offset:0
buffer_load_dwordx2 v[122:123], v11, s[16:19], s34 offen offset:16
buffer_load_dwordx2 v[124:125], v11, s[16:19], s34 offen offset:128
buffer_load_dwordx2 v[126:127], v11, s[16:19], s34 offen offset:144
v_lshrrev_b32 v13, 3, v1
v_lshl_add_u32 v13, v2, 3, v13
v_lshlrev_b32 v13, 2, v13
v_lshl_add_u32 v13, v3, 7, v13
v_lshlrev_b32 v14, 7, v3
s_waitcnt vmcnt(16)
v_lshlrev_b32 v32, 16, v64
v_and_b32 v33, 0xffff0000, v64
v_lshlrev_b32 v34, 16, v65
v_and_b32 v35, 0xffff0000, v65
v_lshlrev_b32 v36, 16, v66
v_and_b32 v37, 0xffff0000, v66
v_lshlrev_b32 v38, 16, v67
v_and_b32 v39, 0xffff0000, v67
v_lshlrev_b32 v40, 16, v68
v_and_b32 v41, 0xffff0000, v68
v_lshlrev_b32 v42, 16, v69
v_and_b32 v43, 0xffff0000, v69
v_lshlrev_b32 v44, 16, v70
v_and_b32 v45, 0xffff0000, v70
v_lshlrev_b32 v46, 16, v71
v_and_b32 v47, 0xffff0000, v71
v_lshlrev_b32 v16, 16, v72
v_and_b32 v17, 0xffff0000, v72
v_add_f32 v32, v32, v16
v_add_f32 v33, v33, v17
v_lshlrev_b32 v16, 16, v73
v_and_b32 v17, 0xffff0000, v73
v_add_f32 v34, v34, v16
v_add_f32 v35, v35, v17
v_lshlrev_b32 v16, 16, v74
v_and_b32 v17, 0xffff0000, v74
v_add_f32 v36, v36, v16
v_add_f32 v37, v37, v17
v_lshlrev_b32 v16, 16, v75
v_and_b32 v17, 0xffff0000, v75
v_add_f32 v38, v38, v16
v_add_f32 v39, v39, v17
v_lshlrev_b32 v16, 16, v76
v_and_b32 v17, 0xffff0000, v76
v_add_f32 v40, v40, v16
v_add_f32 v41, v41, v17
v_lshlrev_b32 v16, 16, v77
v_and_b32 v17, 0xffff0000, v77
v_add_f32 v42, v42, v16
v_add_f32 v43, v43, v17
v_lshlrev_b32 v16, 16, v78
v_and_b32 v17, 0xffff0000, v78
v_add_f32 v44, v44, v16
v_add_f32 v45, v45, v17
v_lshlrev_b32 v16, 16, v79
v_and_b32 v17, 0xffff0000, v79
v_add_f32 v46, v46, v16
v_add_f32 v47, v47, v17
v_lshlrev_b32 v16, 16, v80
v_and_b32 v17, 0xffff0000, v80
v_add_f32 v32, v32, v16
v_add_f32 v33, v33, v17
v_lshlrev_b32 v16, 16, v81
v_and_b32 v17, 0xffff0000, v81
v_add_f32 v34, v34, v16
v_add_f32 v35, v35, v17
v_lshlrev_b32 v16, 16, v82
v_and_b32 v17, 0xffff0000, v82
v_add_f32 v36, v36, v16
v_add_f32 v37, v37, v17
v_lshlrev_b32 v16, 16, v83
v_and_b32 v17, 0xffff0000, v83
v_add_f32 v38, v38, v16
v_add_f32 v39, v39, v17
v_lshlrev_b32 v16, 16, v84
v_and_b32 v17, 0xffff0000, v84
v_add_f32 v40, v40, v16
v_add_f32 v41, v41, v17
v_lshlrev_b32 v16, 16, v85
v_and_b32 v17, 0xffff0000, v85
v_add_f32 v42, v42, v16
v_add_f32 v43, v43, v17
v_lshlrev_b32 v16, 16, v86
v_and_b32 v17, 0xffff0000, v86
v_add_f32 v44, v44, v16
v_add_f32 v45, v45, v17
v_lshlrev_b32 v16, 16, v87
v_and_b32 v17, 0xffff0000, v87
v_add_f32 v46, v46, v16
v_add_f32 v47, v47, v17
v_lshlrev_b32 v16, 16, v88
v_and_b32 v17, 0xffff0000, v88
v_add_f32 v32, v32, v16
v_add_f32 v33, v33, v17
v_lshlrev_b32 v16, 16, v89
v_and_b32 v17, 0xffff0000, v89
v_add_f32 v34, v34, v16
v_add_f32 v35, v35, v17
v_lshlrev_b32 v16, 16, v90
v_and_b32 v17, 0xffff0000, v90
v_add_f32 v36, v36, v16
v_add_f32 v37, v37, v17
v_lshlrev_b32 v16, 16, v91
v_and_b32 v17, 0xffff0000, v91
v_add_f32 v38, v38, v16
v_add_f32 v39, v39, v17
v_lshlrev_b32 v16, 16, v92
v_and_b32 v17, 0xffff0000, v92
v_add_f32 v40, v40, v16
v_add_f32 v41, v41, v17
v_lshlrev_b32 v16, 16, v93
v_and_b32 v17, 0xffff0000, v93
v_add_f32 v42, v42, v16
v_add_f32 v43, v43, v17
v_lshlrev_b32 v16, 16, v94
v_and_b32 v17, 0xffff0000, v94
v_add_f32 v44, v44, v16
v_add_f32 v45, v45, v17
v_lshlrev_b32 v16, 16, v95
v_and_b32 v17, 0xffff0000, v95
v_add_f32 v46, v46, v16
v_add_f32 v47, v47, v17
s_waitcnt vmcnt(8)
v_cvt_pk_bf16_f32 v15, v32, v33
v_lshlrev_b32 v32, 16, v15
v_and_b32 v33, 0xffff0000, v15
v_lshlrev_b32 v16, 16, v104
v_and_b32 v17, 0xffff0000, v104
v_mul_f32 v32, v32, v16
v_mul_f32 v33, v33, v17
v_cvt_pk_bf16_f32 v15, v32, v33
v_lshlrev_b32 v32, 16, v15
v_and_b32 v33, 0xffff0000, v15
v_lshlrev_b32 v16, 16, v96
v_and_b32 v17, 0xffff0000, v96
v_add_f32 v32, v32, v16
v_add_f32 v33, v33, v17
v_cvt_pk_bf16_f32 v48, v32, v33
v_lshlrev_b32 v32, 16, v48
v_and_b32 v33, 0xffff0000, v48
v_cvt_pk_bf16_f32 v15, v34, v35
v_lshlrev_b32 v34, 16, v15
v_and_b32 v35, 0xffff0000, v15
v_lshlrev_b32 v16, 16, v105
v_and_b32 v17, 0xffff0000, v105
v_mul_f32 v34, v34, v16
v_mul_f32 v35, v35, v17
v_cvt_pk_bf16_f32 v15, v34, v35
v_lshlrev_b32 v34, 16, v15
v_and_b32 v35, 0xffff0000, v15
v_lshlrev_b32 v16, 16, v97
v_and_b32 v17, 0xffff0000, v97
v_add_f32 v34, v34, v16
v_add_f32 v35, v35, v17
v_cvt_pk_bf16_f32 v49, v34, v35
v_lshlrev_b32 v34, 16, v49
v_and_b32 v35, 0xffff0000, v49
v_cvt_pk_bf16_f32 v15, v36, v37
v_lshlrev_b32 v36, 16, v15
v_and_b32 v37, 0xffff0000, v15
v_lshlrev_b32 v16, 16, v106
v_and_b32 v17, 0xffff0000, v106
v_mul_f32 v36, v36, v16
v_mul_f32 v37, v37, v17
v_cvt_pk_bf16_f32 v15, v36, v37
v_lshlrev_b32 v36, 16, v15
v_and_b32 v37, 0xffff0000, v15
v_lshlrev_b32 v16, 16, v98
v_and_b32 v17, 0xffff0000, v98
v_add_f32 v36, v36, v16
v_add_f32 v37, v37, v17
v_cvt_pk_bf16_f32 v50, v36, v37
v_lshlrev_b32 v36, 16, v50
v_and_b32 v37, 0xffff0000, v50
v_cvt_pk_bf16_f32 v15, v38, v39
v_lshlrev_b32 v38, 16, v15
v_and_b32 v39, 0xffff0000, v15
v_lshlrev_b32 v16, 16, v107
v_and_b32 v17, 0xffff0000, v107
v_mul_f32 v38, v38, v16
v_mul_f32 v39, v39, v17
v_cvt_pk_bf16_f32 v15, v38, v39
v_lshlrev_b32 v38, 16, v15
v_and_b32 v39, 0xffff0000, v15
v_lshlrev_b32 v16, 16, v99
v_and_b32 v17, 0xffff0000, v99
v_add_f32 v38, v38, v16
v_add_f32 v39, v39, v17
v_cvt_pk_bf16_f32 v51, v38, v39
v_lshlrev_b32 v38, 16, v51
v_and_b32 v39, 0xffff0000, v51
v_cvt_pk_bf16_f32 v15, v40, v41
v_lshlrev_b32 v40, 16, v15
v_and_b32 v41, 0xffff0000, v15
v_lshlrev_b32 v16, 16, v108
v_and_b32 v17, 0xffff0000, v108
v_mul_f32 v40, v40, v16
v_mul_f32 v41, v41, v17
v_cvt_pk_bf16_f32 v15, v40, v41
v_lshlrev_b32 v40, 16, v15
v_and_b32 v41, 0xffff0000, v15
v_lshlrev_b32 v16, 16, v100
v_and_b32 v17, 0xffff0000, v100
v_add_f32 v40, v40, v16
v_add_f32 v41, v41, v17
v_cvt_pk_bf16_f32 v52, v40, v41
v_lshlrev_b32 v40, 16, v52
v_and_b32 v41, 0xffff0000, v52
v_cvt_pk_bf16_f32 v15, v42, v43
v_lshlrev_b32 v42, 16, v15
v_and_b32 v43, 0xffff0000, v15
v_lshlrev_b32 v16, 16, v109
v_and_b32 v17, 0xffff0000, v109
v_mul_f32 v42, v42, v16
v_mul_f32 v43, v43, v17
v_cvt_pk_bf16_f32 v15, v42, v43
v_lshlrev_b32 v42, 16, v15
v_and_b32 v43, 0xffff0000, v15
v_lshlrev_b32 v16, 16, v101
v_and_b32 v17, 0xffff0000, v101
v_add_f32 v42, v42, v16
v_add_f32 v43, v43, v17
v_cvt_pk_bf16_f32 v53, v42, v43
v_lshlrev_b32 v42, 16, v53
v_and_b32 v43, 0xffff0000, v53
v_cvt_pk_bf16_f32 v15, v44, v45
v_lshlrev_b32 v44, 16, v15
v_and_b32 v45, 0xffff0000, v15
v_lshlrev_b32 v16, 16, v110
v_and_b32 v17, 0xffff0000, v110
v_mul_f32 v44, v44, v16
v_mul_f32 v45, v45, v17
v_cvt_pk_bf16_f32 v15, v44, v45
v_lshlrev_b32 v44, 16, v15
v_and_b32 v45, 0xffff0000, v15
v_lshlrev_b32 v16, 16, v102
v_and_b32 v17, 0xffff0000, v102
v_add_f32 v44, v44, v16
v_add_f32 v45, v45, v17
v_cvt_pk_bf16_f32 v54, v44, v45
v_lshlrev_b32 v44, 16, v54
v_and_b32 v45, 0xffff0000, v54
v_cvt_pk_bf16_f32 v15, v46, v47
v_lshlrev_b32 v46, 16, v15
v_and_b32 v47, 0xffff0000, v15
v_lshlrev_b32 v16, 16, v111
v_and_b32 v17, 0xffff0000, v111
v_mul_f32 v46, v46, v16
v_mul_f32 v47, v47, v17
v_cvt_pk_bf16_f32 v15, v46, v47
v_lshlrev_b32 v46, 16, v15
v_and_b32 v47, 0xffff0000, v15
v_lshlrev_b32 v16, 16, v103
v_and_b32 v17, 0xffff0000, v103
v_add_f32 v46, v46, v16
v_add_f32 v47, v47, v17
v_cvt_pk_bf16_f32 v55, v46, v47
v_lshlrev_b32 v46, 16, v55
v_and_b32 v47, 0xffff0000, v55
v_and_b32 v18, 15, v8
v_lshl_add_u32 v19, v5, 1, v4
v_lshl_add_u32 v18, v19, 4, v18
v_lshlrev_b32 v18, 4, v18
v_lshl_add_u32 v18, v7, 10, v18
s_lshr_b32 s35, s38, 1
s_lshl_b32 s35, s35, 14
buffer_store_dwordx4 v[48:51], v18, s[24:27], s35 offen
buffer_store_dwordx4 v[52:55], v18, s[24:27], s35 offen offset:2048
v_add_f32 v20, v32, v33
v_mul_f32 v21, v32, v32
v_add_f32 v22, v34, v35
v_mul_f32 v23, v33, v33
v_fmac_f32 v21, v34, v34
v_fmac_f32 v23, v35, v35
v_add_f32 v20, v20, v36
v_add_f32 v22, v22, v37
v_fmac_f32 v21, v36, v36
v_fmac_f32 v23, v37, v37
v_add_f32 v20, v20, v38
v_add_f32 v22, v22, v39
v_fmac_f32 v21, v38, v38
v_fmac_f32 v23, v39, v39
v_add_f32 v20, v20, v40
v_add_f32 v22, v22, v41
v_fmac_f32 v21, v40, v40
v_fmac_f32 v23, v41, v41
v_add_f32 v20, v20, v42
v_add_f32 v22, v22, v43
v_fmac_f32 v21, v42, v42
v_fmac_f32 v23, v43, v43
v_add_f32 v20, v20, v44
v_add_f32 v22, v22, v45
v_fmac_f32 v21, v44, v44
v_fmac_f32 v23, v45, v45
v_add_f32 v20, v20, v46
v_add_f32 v22, v22, v47
v_fmac_f32 v21, v46, v46
v_fmac_f32 v23, v47, v47
v_add_f32 v20, v20, v22
v_add_f32 v21, v21, v23
s_nop 1
v_add_f32_dpp v22, v20, v20 row_ror:8 row_mask:0xf bank_mask:0xf
v_add_f32_dpp v23, v21, v21 row_ror:8 row_mask:0xf bank_mask:0xf
v_mov_b32 v20, v22
v_mov_b32 v21, v23
s_nop 1
v_permlane16_swap_b32 v20, v22
v_permlane16_swap_b32 v21, v23
v_add_f32 v20, v20, v22
v_add_f32 v21, v21, v23
v_mov_b32 v22, v20
v_mov_b32 v23, v21
s_nop 1
v_permlane32_swap_b32 v20, v22
v_permlane32_swap_b32 v21, v23
v_add_f32 v20, v20, v22
v_add_f32 v21, v21, v23
v_lshlrev_b32 v13, 5, v3
v_lshl_add_u32 v14, v2, 3, v13
ds_write_b64 v14, v[20:21]
s_waitcnt lgkmcnt(0)
s_barrier
ds_read_b128 v[64:67], v13
ds_read_b128 v[68:71], v13 offset:16
s_waitcnt lgkmcnt(0)
v_add_f32 v64, v64, v66
v_add_f32 v65, v65, v67
v_add_f32 v68, v68, v70
v_add_f32 v69, v69, v71
v_add_f32 v64, v64, v68
v_add_f32 v65, v65, v69
v_mul_f32 v20, 0x3b000000, v64
v_mul_f32 v21, 0x3b000000, v65
v_fma_f32 v21, -v20, v20, v21
v_max_f32 v21, 0, v21
v_cvt_pk_bf16_f32 v15, v20, v21
v_lshlrev_b32 v20, 16, v15
v_and_b32 v21, 0xffff0000, v15
v_add_f32 v21, 0x3727c5ac, v21
v_cvt_pk_bf16_f32 v21, v21, v21
v_lshlrev_b32 v21, 16, v21
v_sqrt_f32 v21, v21
s_nop 0
v_cvt_pk_bf16_f32 v21, v21, v21
v_lshlrev_b32 v21, 16, v21
v_rcp_f32 v21, v21
s_waitcnt vmcnt(2)
v_sub_f32 v32, v32, v20
v_sub_f32 v33, v33, v20
v_cvt_pk_bf16_f32 v15, v32, v33
v_lshlrev_b32 v32, 16, v15
v_and_b32 v33, 0xffff0000, v15
v_mul_f32 v32, v32, v21
v_mul_f32 v33, v33, v21
v_cvt_pk_bf16_f32 v15, v32, v33
v_lshlrev_b32 v32, 16, v15
v_and_b32 v33, 0xffff0000, v15
v_lshlrev_b32 v16, 16, v120
v_and_b32 v17, 0xffff0000, v120
v_add_f32 v16, 1.0, v16
v_add_f32 v17, 1.0, v17
v_cvt_pk_bf16_f32 v15, v16, v17
v_lshlrev_b32 v16, 16, v15
v_and_b32 v17, 0xffff0000, v15
v_mul_f32 v32, v32, v16
v_mul_f32 v33, v33, v17
v_cvt_pk_bf16_f32 v15, v32, v33
v_lshlrev_b32 v32, 16, v15
v_and_b32 v33, 0xffff0000, v15
v_lshlrev_b32 v16, 16, v112
v_and_b32 v17, 0xffff0000, v112
v_add_f32 v32, v32, v16
v_add_f32 v33, v33, v17
v_cvt_pk_bf16_f32 v56, v32, v33
v_sub_f32 v34, v34, v20
v_sub_f32 v35, v35, v20
v_cvt_pk_bf16_f32 v15, v34, v35
v_lshlrev_b32 v34, 16, v15
v_and_b32 v35, 0xffff0000, v15
v_mul_f32 v34, v34, v21
v_mul_f32 v35, v35, v21
v_cvt_pk_bf16_f32 v15, v34, v35
v_lshlrev_b32 v34, 16, v15
v_and_b32 v35, 0xffff0000, v15
v_lshlrev_b32 v16, 16, v121
v_and_b32 v17, 0xffff0000, v121
v_add_f32 v16, 1.0, v16
v_add_f32 v17, 1.0, v17
v_cvt_pk_bf16_f32 v15, v16, v17
v_lshlrev_b32 v16, 16, v15
v_and_b32 v17, 0xffff0000, v15
v_mul_f32 v34, v34, v16
v_mul_f32 v35, v35, v17
v_cvt_pk_bf16_f32 v15, v34, v35
v_lshlrev_b32 v34, 16, v15
v_and_b32 v35, 0xffff0000, v15
v_lshlrev_b32 v16, 16, v113
v_and_b32 v17, 0xffff0000, v113
v_add_f32 v34, v34, v16
v_add_f32 v35, v35, v17
v_cvt_pk_bf16_f32 v57, v34, v35
v_sub_f32 v36, v36, v20
v_sub_f32 v37, v37, v20
v_cvt_pk_bf16_f32 v15, v36, v37
v_lshlrev_b32 v36, 16, v15
v_and_b32 v37, 0xffff0000, v15
v_mul_f32 v36, v36, v21
v_mul_f32 v37, v37, v21
v_cvt_pk_bf16_f32 v15, v36, v37
v_lshlrev_b32 v36, 16, v15
v_and_b32 v37, 0xffff0000, v15
v_lshlrev_b32 v16, 16, v122
v_and_b32 v17, 0xffff0000, v122
v_add_f32 v16, 1.0, v16
v_add_f32 v17, 1.0, v17
v_cvt_pk_bf16_f32 v15, v16, v17
v_lshlrev_b32 v16, 16, v15
v_and_b32 v17, 0xffff0000, v15
v_mul_f32 v36, v36, v16
v_mul_f32 v37, v37, v17
v_cvt_pk_bf16_f32 v15, v36, v37
v_lshlrev_b32 v36, 16, v15
v_and_b32 v37, 0xffff0000, v15
v_lshlrev_b32 v16, 16, v114
v_and_b32 v17, 0xffff0000, v114
v_add_f32 v36, v36, v16
v_add_f32 v37, v37, v17
v_cvt_pk_bf16_f32 v58, v36, v37
v_sub_f32 v38, v38, v20
v_sub_f32 v39, v39, v20
v_cvt_pk_bf16_f32 v15, v38, v39
v_lshlrev_b32 v38, 16, v15
v_and_b32 v39, 0xffff0000, v15
v_mul_f32 v38, v38, v21
v_mul_f32 v39, v39, v21
v_cvt_pk_bf16_f32 v15, v38, v39
v_lshlrev_b32 v38, 16, v15
v_and_b32 v39, 0xffff0000, v15
v_lshlrev_b32 v16, 16, v123
v_and_b32 v17, 0xffff0000, v123
v_add_f32 v16, 1.0, v16
v_add_f32 v17, 1.0, v17
v_cvt_pk_bf16_f32 v15, v16, v17
v_lshlrev_b32 v16, 16, v15
v_and_b32 v17, 0xffff0000, v15
v_mul_f32 v38, v38, v16
v_mul_f32 v39, v39, v17
v_cvt_pk_bf16_f32 v15, v38, v39
v_lshlrev_b32 v38, 16, v15
v_and_b32 v39, 0xffff0000, v15
v_lshlrev_b32 v16, 16, v115
v_and_b32 v17, 0xffff0000, v115
v_add_f32 v38, v38, v16
v_add_f32 v39, v39, v17
v_cvt_pk_bf16_f32 v59, v38, v39
v_sub_f32 v40, v40, v20
v_sub_f32 v41, v41, v20
v_cvt_pk_bf16_f32 v15, v40, v41
v_lshlrev_b32 v40, 16, v15
v_and_b32 v41, 0xffff0000, v15
v_mul_f32 v40, v40, v21
v_mul_f32 v41, v41, v21
v_cvt_pk_bf16_f32 v15, v40, v41
v_lshlrev_b32 v40, 16, v15
v_and_b32 v41, 0xffff0000, v15
v_lshlrev_b32 v16, 16, v124
v_and_b32 v17, 0xffff0000, v124
v_add_f32 v16, 1.0, v16
v_add_f32 v17, 1.0, v17
v_cvt_pk_bf16_f32 v15, v16, v17
v_lshlrev_b32 v16, 16, v15
v_and_b32 v17, 0xffff0000, v15
v_mul_f32 v40, v40, v16
v_mul_f32 v41, v41, v17
v_cvt_pk_bf16_f32 v15, v40, v41
v_lshlrev_b32 v40, 16, v15
v_and_b32 v41, 0xffff0000, v15
v_lshlrev_b32 v16, 16, v116
v_and_b32 v17, 0xffff0000, v116
v_add_f32 v40, v40, v16
v_add_f32 v41, v41, v17
v_cvt_pk_bf16_f32 v60, v40, v41
v_sub_f32 v42, v42, v20
v_sub_f32 v43, v43, v20
v_cvt_pk_bf16_f32 v15, v42, v43
v_lshlrev_b32 v42, 16, v15
v_and_b32 v43, 0xffff0000, v15
v_mul_f32 v42, v42, v21
v_mul_f32 v43, v43, v21
v_cvt_pk_bf16_f32 v15, v42, v43
v_lshlrev_b32 v42, 16, v15
v_and_b32 v43, 0xffff0000, v15
v_lshlrev_b32 v16, 16, v125
v_and_b32 v17, 0xffff0000, v125
v_add_f32 v16, 1.0, v16
v_add_f32 v17, 1.0, v17
v_cvt_pk_bf16_f32 v15, v16, v17
v_lshlrev_b32 v16, 16, v15
v_and_b32 v17, 0xffff0000, v15
v_mul_f32 v42, v42, v16
v_mul_f32 v43, v43, v17
v_cvt_pk_bf16_f32 v15, v42, v43
v_lshlrev_b32 v42, 16, v15
v_and_b32 v43, 0xffff0000, v15
v_lshlrev_b32 v16, 16, v117
v_and_b32 v17, 0xffff0000, v117
v_add_f32 v42, v42, v16
v_add_f32 v43, v43, v17
v_cvt_pk_bf16_f32 v61, v42, v43
v_sub_f32 v44, v44, v20
v_sub_f32 v45, v45, v20
v_cvt_pk_bf16_f32 v15, v44, v45
v_lshlrev_b32 v44, 16, v15
v_and_b32 v45, 0xffff0000, v15
v_mul_f32 v44, v44, v21
v_mul_f32 v45, v45, v21
v_cvt_pk_bf16_f32 v15, v44, v45
v_lshlrev_b32 v44, 16, v15
v_and_b32 v45, 0xffff0000, v15
v_lshlrev_b32 v16, 16, v126
v_and_b32 v17, 0xffff0000, v126
v_add_f32 v16, 1.0, v16
v_add_f32 v17, 1.0, v17
v_cvt_pk_bf16_f32 v15, v16, v17
v_lshlrev_b32 v16, 16, v15
v_and_b32 v17, 0xffff0000, v15
v_mul_f32 v44, v44, v16
v_mul_f32 v45, v45, v17
v_cvt_pk_bf16_f32 v15, v44, v45
v_lshlrev_b32 v44, 16, v15
v_and_b32 v45, 0xffff0000, v15
v_lshlrev_b32 v16, 16, v118
v_and_b32 v17, 0xffff0000, v118
v_add_f32 v44, v44, v16
v_add_f32 v45, v45, v17
v_cvt_pk_bf16_f32 v62, v44, v45
v_sub_f32 v46, v46, v20
v_sub_f32 v47, v47, v20
v_cvt_pk_bf16_f32 v15, v46, v47
v_lshlrev_b32 v46, 16, v15
v_and_b32 v47, 0xffff0000, v15
v_mul_f32 v46, v46, v21
v_mul_f32 v47, v47, v21
v_cvt_pk_bf16_f32 v15, v46, v47
v_lshlrev_b32 v46, 16, v15
v_and_b32 v47, 0xffff0000, v15
v_lshlrev_b32 v16, 16, v127
v_and_b32 v17, 0xffff0000, v127
v_add_f32 v16, 1.0, v16
v_add_f32 v17, 1.0, v17
v_cvt_pk_bf16_f32 v15, v16, v17
v_lshlrev_b32 v16, 16, v15
v_and_b32 v17, 0xffff0000, v15
v_mul_f32 v46, v46, v16
v_mul_f32 v47, v47, v17
v_cvt_pk_bf16_f32 v15, v46, v47
v_lshlrev_b32 v46, 16, v15
v_and_b32 v47, 0xffff0000, v15
v_lshlrev_b32 v16, 16, v119
v_and_b32 v17, 0xffff0000, v119
v_add_f32 v46, v46, v16
v_add_f32 v47, v47, v17
v_cvt_pk_bf16_f32 v63, v46, v47
buffer_store_dwordx4 v[56:59], v18, s[20:23], s35 offen
buffer_store_dwordx4 v[60:63], v18, s[20:23], s35 offen offset:2048
ln2_kernel_done:
s_endpgm
.globl ffn1_kernel
.p2align 8
.type ffn1_kernel,@function
ffn1_kernel:
s_cmp_ge_u32 s2, 256
s_cbranch_scc1 ffn1_kernel_done
s_load_dwordx4 s[48:51], s[0:1], 48
s_load_dwordx2 s[52:53], s[0:1], 104
v_lshrrev_b32 v1, 6, v0
v_and_b32 v2, 63, v0
v_readfirstlane_b32 s28, v1
s_and_b32 s31, s2, 1
s_lshr_b32 s32, s2, 3
s_lshl_b32 s29, s31, 3
s_and_b32 s31, s32, 7
s_add_u32 s29, s29, s31
s_lshr_b32 s30, s32, 3
s_bfe_u32 s31, s2, 0x20001
s_lshl_b32 s31, s31, 2
s_add_u32 s30, s30, s31
s_mul_i32 s31, s30, 224
s_lshr_b32 s32, s28, 1
s_mul_i32 s33, s32, 114688
s_add_u32 s31, s31, s33
s_mov_b32 s42, 0x12492493
s_movk_i32 s43, 3584
v_add_u32 v3, 0, v2
v_mul_hi_u32 v4, v3, s42
v_mul_u32_u24 v5, 14, v4
v_sub_u32 v5, v3, v5
v_mul_lo_u32 v4, v4, s43
v_lshl_add_u32 v10, v5, 4, v4
v_add_u32 v10, s31, v10
v_add_u32 v3, 64, v2
v_mul_hi_u32 v4, v3, s42
v_mul_u32_u24 v5, 14, v4
v_sub_u32 v5, v3, v5
v_mul_lo_u32 v4, v4, s43
v_lshl_add_u32 v11, v5, 4, v4
v_add_u32 v11, s31, v11
v_subrev_u32 v11, 1024, v11
v_add_u32 v3, 128, v2
v_mul_hi_u32 v4, v3, s42
v_mul_u32_u24 v5, 14, v4
v_sub_u32 v5, v3, v5
v_mul_lo_u32 v4, v4, s43
v_lshl_add_u32 v12, v5, 4, v4
v_add_u32 v12, s31, v12
v_subrev_u32 v12, 2048, v12
v_add_u32 v3, 192, v2
v_mul_hi_u32 v4, v3, s42
v_mul_u32_u24 v5, 14, v4
v_sub_u32 v5, v3, v5
v_mul_lo_u32 v4, v4, s43
v_lshl_add_u32 v13, v5, 4, v4
v_add_u32 v13, s31, v13
v_subrev_u32 v13, 3072, v13
v_add_u32 v3, 256, v2
v_mul_hi_u32 v4, v3, s42
v_mul_u32_u24 v5, 14, v4
v_sub_u32 v5, v3, v5
v_mul_lo_u32 v4, v4, s43
v_lshl_add_u32 v14, v5, 4, v4
v_add_u32 v14, s31, v14
v_add_u32 v3, 320, v2
v_mul_hi_u32 v4, v3, s42
v_mul_u32_u24 v5, 14, v4
v_sub_u32 v5, v3, v5
v_mul_lo_u32 v4, v4, s43
v_lshl_add_u32 v15, v5, 4, v4
v_add_u32 v15, s31, v15
v_subrev_u32 v15, 1024, v15
v_add_u32 v3, 384, v2
v_mul_hi_u32 v4, v3, s42
v_mul_u32_u24 v5, 14, v4
v_sub_u32 v5, v3, v5
v_mul_lo_u32 v4, v4, s43
v_lshl_add_u32 v16, v5, 4, v4
v_add_u32 v16, s31, v16
v_subrev_u32 v16, 2048, v16
s_and_b32 s31, s28, 1
s_mul_i32 s34, s31, 14336
s_mul_i32 s32, s32, 7168
s_add_u32 s34, s34, s32
v_lshlrev_b32 v17, 4, v2
v_lshrrev_b32 v3, 4, v2
v_and_b32 v4, 15, v2
v_lshrrev_b32 v4, 2, v4
v_and_b32 v5, 3, v2
v_lshrrev_b32 v6, 1, v3
v_lshl_add_u32 v6, v6, 4, v4
v_and_b32 v7, 1, v3
v_lshl_add_u32 v6, v7, 2, v6
v_mul_u32_u24 v6, 224, v6
v_lshl_add_u32 v18, v5, 3, v6
v_add_u32 v19, 0xe000, v18
s_lshl_b32 s31, s29, 3
s_lshl_b32 s32, s28, 1
s_add_u32 s31, s31, s32
s_lshl_b32 s40, s31, 14
s_add_u32 s41, s40, 16384
s_waitcnt lgkmcnt(0)
s_mov_b32 s8, s48
s_and_b32 s9, s49, 0xffff
s_mov_b32 s10, 1835008
s_mov_b32 s11, 0x00020000
s_mov_b32 s12, s50
s_and_b32 s13, s51, 0xffff
s_mov_b32 s14, 1835008
s_mov_b32 s15, 0x00020000
s_add_u32 s16, s52, 23068672
s_addc_u32 s17, s53, 0
s_and_b32 s17, s17, 0xffff
s_mov_b32 s18, 2097152
s_mov_b32 s19, 0x00020000
s_add_u32 s20, s52, 25165824
s_addc_u32 s21, s53, 0
s_and_b32 s21, s21, 0xffff
s_mov_b32 s22, 7340032
s_mov_b32 s23, 0x00020000
s_and_b32 s31, s28, 1
s_cmp_eq_u32 s31, 0
s_cselect_b32 s36, s8, s12
s_cselect_b32 s37, s9, s13
s_mov_b32 s38, 1835008
s_mov_b32 s39, 0x00020000
s_add_u32 m0, s34, 0
s_mov_b32 s56, 0
buffer_load_dwordx4 v10, s[36:39], s56 offen offset:0 lds
buffer_load_dwordx4 v11, s[36:39], s56 offen offset:1024 lds
buffer_load_dwordx4 v12, s[36:39], s56 offen offset:2048 lds
buffer_load_dwordx4 v13, s[36:39], s56 offen offset:3072 lds
s_add_u32 m0, s34, 4096
s_nop 0
buffer_load_dwordx4 v14, s[36:39], s56 offen offset:0 lds
buffer_load_dwordx4 v15, s[36:39], s56 offen offset:1024 lds
buffer_load_dwordx4 v16, s[36:39], s56 offen offset:2048 lds
s_add_u32 s57, s40, 0
s_add_u32 s58, s41, 0
buffer_load_dwordx4 a[0:3], v17, s[16:19], s57 offen offset:0
buffer_load_dwordx4 a[4:7], v17, s[16:19], s58 offen offset:0
buffer_load_dwordx4 a[8:11], v17, s[16:19], s57 offen offset:1024
buffer_load_dwordx4 a[12:15], v17, s[16:19], s58 offen offset:1024
s_add_u32 m0, s34, 28672
s_mov_b32 s56, 229376
buffer_load_dwordx4 v10, s[36:39], s56 offen offset:0 lds
buffer_load_dwordx4 v11, s[36:39], s56 offen offset:1024 lds
buffer_load_dwordx4 v12, s[36:39], s56 offen offset:2048 lds
buffer_load_dwordx4 v13, s[36:39], s56 offen offset:3072 lds
s_add_u32 m0, s34, 32768
s_nop 0
buffer_load_dwordx4 v14, s[36:39], s56 offen offset:0 lds
buffer_load_dwordx4 v15, s[36:39], s56 offen offset:1024 lds
buffer_load_dwordx4 v16, s[36:39], s56 offen offset:2048 lds
s_waitcnt vmcnt(11)
s_barrier
ds_read_b64_tr_b16 a[128:129], v18 offset:0
ds_read_b64_tr_b16 a[130:131], v18 offset:1792
ds_read_b64_tr_b16 a[132:133], v18 offset:32
ds_read_b64_tr_b16 a[134:135], v18 offset:1824
ds_read_b64_tr_b16 a[136:137], v18 offset:64
ds_read_b64_tr_b16 a[138:139], v18 offset:1856
ds_read_b64_tr_b16 a[140:141], v18 offset:96
ds_read_b64_tr_b16 a[142:143], v18 offset:1888
ds_read_b64_tr_b16 a[144:145], v18 offset:128
ds_read_b64_tr_b16 a[146:147], v18 offset:1920
ds_read_b64_tr_b16 a[148:149], v18 offset:160
ds_read_b64_tr_b16 a[150:151], v18 offset:1952
ds_read_b64_tr_b16 a[152:153], v18 offset:192
ds_read_b64_tr_b16 a[154:155], v18 offset:1984
ds_read_b64_tr_b16 a[156:157], v18 offset:14336
ds_read_b64_tr_b16 a[158:159], v18 offset:16128
ds_read_b64_tr_b16 a[160:161], v18 offset:14368
ds_read_b64_tr_b16 a[162:163], v18 offset:16160
ds_read_b64_tr_b16 a[164:165], v18 offset:14400
ds_read_b64_tr_b16 a[166:167], v18 offset:16192
ds_read_b64_tr_b16 a[168:169], v18 offset:14432
ds_read_b64_tr_b16 a[170:171], v18 offset:16224
ds_read_b64_tr_b16 a[172:173], v18 offset:14464
ds_read_b64_tr_b16 a[174:175], v18 offset:16256
ds_read_b64_tr_b16 a[176:177], v18 offset:14496
ds_read_b64_tr_b16 a[178:179], v18 offset:16288
ds_read_b64_tr_b16 a[180:181], v18 offset:14528
ds_read_b64_tr_b16 a[182:183], v18 offset:16320
s_waitcnt vmcnt(7)
s_waitcnt lgkmcnt(0)
v_mfma_f32_16x16x32_bf16 v[32:35], a[128:131], a[0:3], 0
ds_read_b64_tr_b16 a[184:185], v18 offset:7168
ds_read_b64_tr_b16 a[186:187], v18 offset:8960
v_mfma_f32_16x16x32_bf16 v[36:39], a[128:131], a[4:7], 0
buffer_load_dwordx4 a[16:19], v17, s[16:19], s57 offen offset:2048
v_mfma_f32_16x16x32_bf16 v[88:91], a[156:159], a[0:3], 0
ds_read_b64_tr_b16 a[188:189], v18 offset:7200
ds_read_b64_tr_b16 a[190:191], v18 offset:8992
v_mfma_f32_16x16x32_bf16 v[92:95], a[156:159], a[4:7], 0
ds_read_b64_tr_b16 a[192:193], v18 offset:7232
v_mfma_f32_16x16x32_bf16 v[40:43], a[132:135], a[0:3], 0
ds_read_b64_tr_b16 a[194:195], v18 offset:9024
ds_read_b64_tr_b16 a[196:197], v18 offset:7264
v_mfma_f32_16x16x32_bf16 v[44:47], a[132:135], a[4:7], 0
buffer_load_dwordx4 a[20:23], v17, s[16:19], s58 offen offset:2048
v_mfma_f32_16x16x32_bf16 v[96:99], a[160:163], a[0:3], 0
ds_read_b64_tr_b16 a[198:199], v18 offset:9056
ds_read_b64_tr_b16 a[200:201], v18 offset:7296
v_mfma_f32_16x16x32_bf16 v[100:103], a[160:163], a[4:7], 0
ds_read_b64_tr_b16 a[202:203], v18 offset:9088
v_mfma_f32_16x16x32_bf16 v[48:51], a[136:139], a[0:3], 0
ds_read_b64_tr_b16 a[204:205], v18 offset:7328
v_mfma_f32_16x16x32_bf16 v[52:55], a[136:139], a[4:7], 0
buffer_load_dwordx4 a[24:27], v17, s[16:19], s57 offen offset:3072
v_mfma_f32_16x16x32_bf16 v[104:107], a[164:167], a[0:3], 0
ds_read_b64_tr_b16 a[206:207], v18 offset:9120
ds_read_b64_tr_b16 a[208:209], v18 offset:7360
v_mfma_f32_16x16x32_bf16 v[108:111], a[164:167], a[4:7], 0
ds_read_b64_tr_b16 a[210:211], v18 offset:9152
ds_read_b64_tr_b16 a[212:213], v18 offset:21504
v_mfma_f32_16x16x32_bf16 v[56:59], a[140:143], a[0:3], 0
ds_read_b64_tr_b16 a[214:215], v18 offset:23296
v_mfma_f32_16x16x32_bf16 v[60:63], a[140:143], a[4:7], 0
buffer_load_dwordx4 a[28:31], v17, s[16:19], s58 offen offset:3072
v_mfma_f32_16x16x32_bf16 v[112:115], a[168:171], a[0:3], 0
ds_read_b64_tr_b16 a[216:217], v18 offset:21536
ds_read_b64_tr_b16 a[218:219], v18 offset:23328
v_mfma_f32_16x16x32_bf16 v[116:119], a[168:171], a[4:7], 0
ds_read_b64_tr_b16 a[220:221], v18 offset:21568
ds_read_b64_tr_b16 a[222:223], v18 offset:23360
v_mfma_f32_16x16x32_bf16 v[64:67], a[144:147], a[0:3], 0
ds_read_b64_tr_b16 a[224:225], v18 offset:21600
v_mfma_f32_16x16x32_bf16 v[68:71], a[144:147], a[4:7], 0
ds_read_b64_tr_b16 a[226:227], v18 offset:23392
s_add_u32 m0, s34, 57344
v_mfma_f32_16x16x32_bf16 v[120:123], a[172:175], a[0:3], 0
ds_read_b64_tr_b16 a[228:229], v18 offset:21632
s_mov_b32 s56, 458752
v_mfma_f32_16x16x32_bf16 v[124:127], a[172:175], a[4:7], 0
ds_read_b64_tr_b16 a[230:231], v18 offset:23424
ds_read_b64_tr_b16 a[232:233], v18 offset:21664
v_mfma_f32_16x16x32_bf16 v[72:75], a[148:151], a[0:3], 0
buffer_load_dwordx4 v10, s[36:39], s56 offen offset:0 lds
v_mfma_f32_16x16x32_bf16 v[76:79], a[148:151], a[4:7], 0
ds_read_b64_tr_b16 a[234:235], v18 offset:23456
ds_read_b64_tr_b16 a[236:237], v18 offset:21696
v_mfma_f32_16x16x32_bf16 v[128:131], a[176:179], a[0:3], 0
ds_read_b64_tr_b16 a[238:239], v18 offset:23488
v_mfma_f32_16x16x32_bf16 v[132:135], a[176:179], a[4:7], 0
buffer_load_dwordx4 v11, s[36:39], s56 offen offset:1024 lds
v_mfma_f32_16x16x32_bf16 v[80:83], a[152:155], a[0:3], 0
v_mfma_f32_16x16x32_bf16 v[84:87], a[152:155], a[4:7], 0
v_mfma_f32_16x16x32_bf16 v[136:139], a[180:183], a[0:3], 0
v_mfma_f32_16x16x32_bf16 v[140:143], a[180:183], a[4:7], 0
s_waitcnt lgkmcnt(0)
s_waitcnt vmcnt(6)
s_barrier
v_mfma_f32_16x16x32_bf16 v[32:35], a[184:187], a[8:11], v[32:35]
ds_read_b64_tr_b16 a[128:129], v18 offset:28672
ds_read_b64_tr_b16 a[130:131], v18 offset:30464
v_mfma_f32_16x16x32_bf16 v[36:39], a[184:187], a[12:15], v[36:39]
buffer_load_dwordx4 v12, s[36:39], s56 offen offset:2048 lds
v_mfma_f32_16x16x32_bf16 v[88:91], a[212:215], a[8:11], v[88:91]
ds_read_b64_tr_b16 a[132:133], v18 offset:28704
ds_read_b64_tr_b16 a[134:135], v18 offset:30496
v_mfma_f32_16x16x32_bf16 v[92:95], a[212:215], a[12:15], v[92:95]
ds_read_b64_tr_b16 a[136:137], v18 offset:28736
v_mfma_f32_16x16x32_bf16 v[40:43], a[188:191], a[8:11], v[40:43]
ds_read_b64_tr_b16 a[138:139], v18 offset:30528
ds_read_b64_tr_b16 a[140:141], v18 offset:28768
v_mfma_f32_16x16x32_bf16 v[44:47], a[188:191], a[12:15], v[44:47]
buffer_load_dwordx4 v13, s[36:39], s56 offen offset:3072 lds
v_mfma_f32_16x16x32_bf16 v[96:99], a[216:219], a[8:11], v[96:99]
ds_read_b64_tr_b16 a[142:143], v18 offset:30560
ds_read_b64_tr_b16 a[144:145], v18 offset:28800
v_mfma_f32_16x16x32_bf16 v[100:103], a[216:219], a[12:15], v[100:103]
ds_read_b64_tr_b16 a[146:147], v18 offset:30592
v_mfma_f32_16x16x32_bf16 v[48:51], a[192:195], a[8:11], v[48:51]
s_add_u32 m0, s34, 61440
ds_read_b64_tr_b16 a[148:149], v18 offset:28832
v_mfma_f32_16x16x32_bf16 v[52:55], a[192:195], a[12:15], v[52:55]
ds_read_b64_tr_b16 a[150:151], v18 offset:30624
s_nop 0
v_mfma_f32_16x16x32_bf16 v[104:107], a[220:223], a[8:11], v[104:107]
ds_read_b64_tr_b16 a[152:153], v18 offset:28864
ds_read_b64_tr_b16 a[154:155], v18 offset:30656
v_mfma_f32_16x16x32_bf16 v[108:111], a[220:223], a[12:15], v[108:111]
buffer_load_dwordx4 v14, s[36:39], s56 offen offset:0 lds
v_mfma_f32_16x16x32_bf16 v[56:59], a[196:199], a[8:11], v[56:59]
ds_read_b64_tr_b16 a[156:157], v18 offset:43008
ds_read_b64_tr_b16 a[158:159], v18 offset:44800
v_mfma_f32_16x16x32_bf16 v[60:63], a[196:199], a[12:15], v[60:63]
ds_read_b64_tr_b16 a[160:161], v18 offset:43040
ds_read_b64_tr_b16 a[162:163], v18 offset:44832
v_mfma_f32_16x16x32_bf16 v[112:115], a[224:227], a[8:11], v[112:115]
buffer_load_dwordx4 v15, s[36:39], s56 offen offset:1024 lds
v_mfma_f32_16x16x32_bf16 v[116:119], a[224:227], a[12:15], v[116:119]
ds_read_b64_tr_b16 a[164:165], v18 offset:43072
ds_read_b64_tr_b16 a[166:167], v18 offset:44864
v_mfma_f32_16x16x32_bf16 v[64:67], a[200:203], a[8:11], v[64:67]
ds_read_b64_tr_b16 a[168:169], v18 offset:43104
v_mfma_f32_16x16x32_bf16 v[68:71], a[200:203], a[12:15], v[68:71]
ds_read_b64_tr_b16 a[170:171], v18 offset:44896
v_mfma_f32_16x16x32_bf16 v[120:123], a[228:231], a[8:11], v[120:123]
ds_read_b64_tr_b16 a[172:173], v18 offset:43136
ds_read_b64_tr_b16 a[174:175], v18 offset:44928
v_mfma_f32_16x16x32_bf16 v[124:127], a[228:231], a[12:15], v[124:127]
buffer_load_dwordx4 v16, s[36:39], s56 offen offset:2048 lds
v_mfma_f32_16x16x32_bf16 v[72:75], a[204:207], a[8:11], v[72:75]
ds_read_b64_tr_b16 a[176:177], v18 offset:43168
ds_read_b64_tr_b16 a[178:179], v18 offset:44960
v_mfma_f32_16x16x32_bf16 v[76:79], a[204:207], a[12:15], v[76:79]
ds_read_b64_tr_b16 a[180:181], v18 offset:43200
v_mfma_f32_16x16x32_bf16 v[128:131], a[232:235], a[8:11], v[128:131]
ds_read_b64_tr_b16 a[182:183], v18 offset:44992
s_add_u32 s57, s40, 4096
v_mfma_f32_16x16x32_bf16 v[132:135], a[232:235], a[12:15], v[132:135]
s_add_u32 s58, s41, 4096
v_mfma_f32_16x16x32_bf16 v[80:83], a[208:211], a[8:11], v[80:83]
buffer_load_dwordx4 a[32:35], v17, s[16:19], s57 offen offset:0
v_mfma_f32_16x16x32_bf16 v[84:87], a[208:211], a[12:15], v[84:87]
v_mfma_f32_16x16x32_bf16 v[136:139], a[236:239], a[8:11], v[136:139]
v_mfma_f32_16x16x32_bf16 v[140:143], a[236:239], a[12:15], v[140:143]
s_waitcnt vmcnt(8)
s_waitcnt lgkmcnt(0)
v_mfma_f32_16x16x32_bf16 v[32:35], a[128:131], a[16:19], v[32:35]
ds_read_b64_tr_b16 a[184:185], v18 offset:35840
ds_read_b64_tr_b16 a[186:187], v18 offset:37632
v_mfma_f32_16x16x32_bf16 v[36:39], a[128:131], a[20:23], v[36:39]
buffer_load_dwordx4 a[36:39], v17, s[16:19], s58 offen offset:0
v_mfma_f32_16x16x32_bf16 v[88:91], a[156:159], a[16:19], v[88:91]
ds_read_b64_tr_b16 a[188:189], v18 offset:35872
ds_read_b64_tr_b16 a[190:191], v18 offset:37664
v_mfma_f32_16x16x32_bf16 v[92:95], a[156:159], a[20:23], v[92:95]
ds_read_b64_tr_b16 a[192:193], v18 offset:35904
v_mfma_f32_16x16x32_bf16 v[40:43], a[132:135], a[16:19], v[40:43]
ds_read_b64_tr_b16 a[194:195], v18 offset:37696
ds_read_b64_tr_b16 a[196:197], v18 offset:35936
v_mfma_f32_16x16x32_bf16 v[44:47], a[132:135], a[20:23], v[44:47]
buffer_load_dwordx4 a[40:43], v17, s[16:19], s57 offen offset:1024
v_mfma_f32_16x16x32_bf16 v[96:99], a[160:163], a[16:19], v[96:99]
ds_read_b64_tr_b16 a[198:199], v18 offset:37728
ds_read_b64_tr_b16 a[200:201], v18 offset:35968
v_mfma_f32_16x16x32_bf16 v[100:103], a[160:163], a[20:23], v[100:103]
ds_read_b64_tr_b16 a[202:203], v18 offset:37760
v_mfma_f32_16x16x32_bf16 v[48:51], a[136:139], a[16:19], v[48:51]
ds_read_b64_tr_b16 a[204:205], v18 offset:36000
v_mfma_f32_16x16x32_bf16 v[52:55], a[136:139], a[20:23], v[52:55]
buffer_load_dwordx4 a[44:47], v17, s[16:19], s58 offen offset:1024
v_mfma_f32_16x16x32_bf16 v[104:107], a[164:167], a[16:19], v[104:107]
ds_read_b64_tr_b16 a[206:207], v18 offset:37792
ds_read_b64_tr_b16 a[208:209], v18 offset:36032
v_mfma_f32_16x16x32_bf16 v[108:111], a[164:167], a[20:23], v[108:111]
ds_read_b64_tr_b16 a[210:211], v18 offset:37824
ds_read_b64_tr_b16 a[212:213], v18 offset:50176
v_mfma_f32_16x16x32_bf16 v[56:59], a[140:143], a[16:19], v[56:59]
ds_read_b64_tr_b16 a[214:215], v18 offset:51968
s_add_u32 m0, s34, 86016
v_mfma_f32_16x16x32_bf16 v[60:63], a[140:143], a[20:23], v[60:63]
ds_read_b64_tr_b16 a[216:217], v18 offset:50208
ds_read_b64_tr_b16 a[218:219], v18 offset:52000
v_mfma_f32_16x16x32_bf16 v[112:115], a[168:171], a[16:19], v[112:115]
s_mov_b32 s56, 688128
ds_read_b64_tr_b16 a[220:221], v18 offset:50240
v_mfma_f32_16x16x32_bf16 v[116:119], a[168:171], a[20:23], v[116:119]
buffer_load_dwordx4 v10, s[36:39], s56 offen offset:0 lds
v_mfma_f32_16x16x32_bf16 v[64:67], a[144:147], a[16:19], v[64:67]
ds_read_b64_tr_b16 a[222:223], v18 offset:52032
ds_read_b64_tr_b16 a[224:225], v18 offset:50272
v_mfma_f32_16x16x32_bf16 v[68:71], a[144:147], a[20:23], v[68:71]
ds_read_b64_tr_b16 a[226:227], v18 offset:52064
v_mfma_f32_16x16x32_bf16 v[120:123], a[172:175], a[16:19], v[120:123]
ds_read_b64_tr_b16 a[228:229], v18 offset:50304
ds_read_b64_tr_b16 a[230:231], v18 offset:52096
v_mfma_f32_16x16x32_bf16 v[124:127], a[172:175], a[20:23], v[124:127]
buffer_load_dwordx4 v11, s[36:39], s56 offen offset:1024 lds
v_mfma_f32_16x16x32_bf16 v[72:75], a[148:151], a[16:19], v[72:75]
ds_read_b64_tr_b16 a[232:233], v18 offset:50336
ds_read_b64_tr_b16 a[234:235], v18 offset:52128
v_mfma_f32_16x16x32_bf16 v[76:79], a[148:151], a[20:23], v[76:79]
ds_read_b64_tr_b16 a[236:237], v18 offset:50368
v_mfma_f32_16x16x32_bf16 v[128:131], a[176:179], a[16:19], v[128:131]
ds_read_b64_tr_b16 a[238:239], v18 offset:52160
v_mfma_f32_16x16x32_bf16 v[132:135], a[176:179], a[20:23], v[132:135]
buffer_load_dwordx4 v12, s[36:39], s56 offen offset:2048 lds
v_mfma_f32_16x16x32_bf16 v[80:83], a[152:155], a[16:19], v[80:83]
v_mfma_f32_16x16x32_bf16 v[84:87], a[152:155], a[20:23], v[84:87]
v_mfma_f32_16x16x32_bf16 v[136:139], a[180:183], a[16:19], v[136:139]
v_mfma_f32_16x16x32_bf16 v[140:143], a[180:183], a[20:23], v[140:143]
s_waitcnt lgkmcnt(0)
s_waitcnt vmcnt(7)
s_barrier
v_mfma_f32_16x16x32_bf16 v[32:35], a[184:187], a[24:27], v[32:35]
ds_read_b64_tr_b16 a[128:129], v19 offset:0
ds_read_b64_tr_b16 a[130:131], v19 offset:1792
v_mfma_f32_16x16x32_bf16 v[36:39], a[184:187], a[28:31], v[36:39]
buffer_load_dwordx4 v13, s[36:39], s56 offen offset:3072 lds
v_mfma_f32_16x16x32_bf16 v[88:91], a[212:215], a[24:27], v[88:91]
ds_read_b64_tr_b16 a[132:133], v19 offset:32
ds_read_b64_tr_b16 a[134:135], v19 offset:1824
v_mfma_f32_16x16x32_bf16 v[92:95], a[212:215], a[28:31], v[92:95]
ds_read_b64_tr_b16 a[136:137], v19 offset:64
v_mfma_f32_16x16x32_bf16 v[40:43], a[188:191], a[24:27], v[40:43]
ds_read_b64_tr_b16 a[138:139], v19 offset:1856
s_add_u32 m0, s34, 90112
v_mfma_f32_16x16x32_bf16 v[44:47], a[188:191], a[28:31], v[44:47]
ds_read_b64_tr_b16 a[140:141], v19 offset:96
s_nop 0
v_mfma_f32_16x16x32_bf16 v[96:99], a[216:219], a[24:27], v[96:99]
ds_read_b64_tr_b16 a[142:143], v19 offset:1888
ds_read_b64_tr_b16 a[144:145], v19 offset:128
v_mfma_f32_16x16x32_bf16 v[100:103], a[216:219], a[28:31], v[100:103]
buffer_load_dwordx4 v14, s[36:39], s56 offen offset:0 lds
v_mfma_f32_16x16x32_bf16 v[48:51], a[192:195], a[24:27], v[48:51]
ds_read_b64_tr_b16 a[146:147], v19 offset:1920
ds_read_b64_tr_b16 a[148:149], v19 offset:160
v_mfma_f32_16x16x32_bf16 v[52:55], a[192:195], a[28:31], v[52:55]
ds_read_b64_tr_b16 a[150:151], v19 offset:1952
ds_read_b64_tr_b16 a[152:153], v19 offset:192
v_mfma_f32_16x16x32_bf16 v[104:107], a[220:223], a[24:27], v[104:107]
ds_read_b64_tr_b16 a[154:155], v19 offset:1984
v_mfma_f32_16x16x32_bf16 v[108:111], a[220:223], a[28:31], v[108:111]
buffer_load_dwordx4 v15, s[36:39], s56 offen offset:1024 lds
v_mfma_f32_16x16x32_bf16 v[56:59], a[196:199], a[24:27], v[56:59]
ds_read_b64_tr_b16 a[156:157], v19 offset:14336
ds_read_b64_tr_b16 a[158:159], v19 offset:16128
v_mfma_f32_16x16x32_bf16 v[60:63], a[196:199], a[28:31], v[60:63]
ds_read_b64_tr_b16 a[160:161], v19 offset:14368
ds_read_b64_tr_b16 a[162:163], v19 offset:16160
v_mfma_f32_16x16x32_bf16 v[112:115], a[224:227], a[24:27], v[112:115]
ds_read_b64_tr_b16 a[164:165], v19 offset:14400
v_mfma_f32_16x16x32_bf16 v[116:119], a[224:227], a[28:31], v[116:119]
buffer_load_dwordx4 v16, s[36:39], s56 offen offset:2048 lds
v_mfma_f32_16x16x32_bf16 v[64:67], a[200:203], a[24:27], v[64:67]
ds_read_b64_tr_b16 a[166:167], v19 offset:16192
ds_read_b64_tr_b16 a[168:169], v19 offset:14432
v_mfma_f32_16x16x32_bf16 v[68:71], a[200:203], a[28:31], v[68:71]
ds_read_b64_tr_b16 a[170:171], v19 offset:16224
v_mfma_f32_16x16x32_bf16 v[120:123], a[228:231], a[24:27], v[120:123]
ds_read_b64_tr_b16 a[172:173], v19 offset:14464
ds_read_b64_tr_b16 a[174:175], v19 offset:16256
v_mfma_f32_16x16x32_bf16 v[124:127], a[228:231], a[28:31], v[124:127]
buffer_load_dwordx4 a[48:51], v17, s[16:19], s57 offen offset:2048
v_mfma_f32_16x16x32_bf16 v[72:75], a[204:207], a[24:27], v[72:75]
ds_read_b64_tr_b16 a[176:177], v19 offset:14496
ds_read_b64_tr_b16 a[178:179], v19 offset:16288
v_mfma_f32_16x16x32_bf16 v[76:79], a[204:207], a[28:31], v[76:79]
ds_read_b64_tr_b16 a[180:181], v19 offset:14528
v_mfma_f32_16x16x32_bf16 v[128:131], a[232:235], a[24:27], v[128:131]
ds_read_b64_tr_b16 a[182:183], v19 offset:16320
v_mfma_f32_16x16x32_bf16 v[132:135], a[232:235], a[28:31], v[132:135]
buffer_load_dwordx4 a[52:55], v17, s[16:19], s58 offen offset:2048
v_mfma_f32_16x16x32_bf16 v[80:83], a[208:211], a[24:27], v[80:83]
v_mfma_f32_16x16x32_bf16 v[84:87], a[208:211], a[28:31], v[84:87]
v_mfma_f32_16x16x32_bf16 v[136:139], a[236:239], a[24:27], v[136:139]
v_mfma_f32_16x16x32_bf16 v[140:143], a[236:239], a[28:31], v[140:143]
s_waitcnt vmcnt(9)
s_waitcnt lgkmcnt(0)
v_mfma_f32_16x16x32_bf16 v[32:35], a[128:131], a[32:35], v[32:35]
ds_read_b64_tr_b16 a[184:185], v19 offset:7168
ds_read_b64_tr_b16 a[186:187], v19 offset:8960
v_mfma_f32_16x16x32_bf16 v[36:39], a[128:131], a[36:39], v[36:39]
buffer_load_dwordx4 a[56:59], v17, s[16:19], s57 offen offset:3072
v_mfma_f32_16x16x32_bf16 v[88:91], a[156:159], a[32:35], v[88:91]
ds_read_b64_tr_b16 a[188:189], v19 offset:7200
ds_read_b64_tr_b16 a[190:191], v19 offset:8992
v_mfma_f32_16x16x32_bf16 v[92:95], a[156:159], a[36:39], v[92:95]
ds_read_b64_tr_b16 a[192:193], v19 offset:7232
v_mfma_f32_16x16x32_bf16 v[40:43], a[132:135], a[32:35], v[40:43]
ds_read_b64_tr_b16 a[194:195], v19 offset:9024
ds_read_b64_tr_b16 a[196:197], v19 offset:7264
v_mfma_f32_16x16x32_bf16 v[44:47], a[132:135], a[36:39], v[44:47]
buffer_load_dwordx4 a[60:63], v17, s[16:19], s58 offen offset:3072
v_mfma_f32_16x16x32_bf16 v[96:99], a[160:163], a[32:35], v[96:99]
ds_read_b64_tr_b16 a[198:199], v19 offset:9056
ds_read_b64_tr_b16 a[200:201], v19 offset:7296
v_mfma_f32_16x16x32_bf16 v[100:103], a[160:163], a[36:39], v[100:103]
ds_read_b64_tr_b16 a[202:203], v19 offset:9088
v_mfma_f32_16x16x32_bf16 v[48:51], a[136:139], a[32:35], v[48:51]
ds_read_b64_tr_b16 a[204:205], v19 offset:7328
s_add_u32 m0, s34, 0
v_mfma_f32_16x16x32_bf16 v[52:55], a[136:139], a[36:39], v[52:55]
ds_read_b64_tr_b16 a[206:207], v19 offset:9120
s_mov_b32 s56, 917504
v_mfma_f32_16x16x32_bf16 v[104:107], a[164:167], a[32:35], v[104:107]
ds_read_b64_tr_b16 a[208:209], v19 offset:7360
ds_read_b64_tr_b16 a[210:211], v19 offset:9152
v_mfma_f32_16x16x32_bf16 v[108:111], a[164:167], a[36:39], v[108:111]
buffer_load_dwordx4 v10, s[36:39], s56 offen offset:0 lds
v_mfma_f32_16x16x32_bf16 v[56:59], a[140:143], a[32:35], v[56:59]
ds_read_b64_tr_b16 a[212:213], v19 offset:21504
ds_read_b64_tr_b16 a[214:215], v19 offset:23296
v_mfma_f32_16x16x32_bf16 v[60:63], a[140:143], a[36:39], v[60:63]
ds_read_b64_tr_b16 a[216:217], v19 offset:21536
ds_read_b64_tr_b16 a[218:219], v19 offset:23328
v_mfma_f32_16x16x32_bf16 v[112:115], a[168:171], a[32:35], v[112:115]
ds_read_b64_tr_b16 a[220:221], v19 offset:21568
v_mfma_f32_16x16x32_bf16 v[116:119], a[168:171], a[36:39], v[116:119]
buffer_load_dwordx4 v11, s[36:39], s56 offen offset:1024 lds
v_mfma_f32_16x16x32_bf16 v[64:67], a[144:147], a[32:35], v[64:67]
ds_read_b64_tr_b16 a[222:223], v19 offset:23360
ds_read_b64_tr_b16 a[224:225], v19 offset:21600
v_mfma_f32_16x16x32_bf16 v[68:71], a[144:147], a[36:39], v[68:71]
ds_read_b64_tr_b16 a[226:227], v19 offset:23392
v_mfma_f32_16x16x32_bf16 v[120:123], a[172:175], a[32:35], v[120:123]
ds_read_b64_tr_b16 a[228:229], v19 offset:21632
ds_read_b64_tr_b16 a[230:231], v19 offset:23424
v_mfma_f32_16x16x32_bf16 v[124:127], a[172:175], a[36:39], v[124:127]
buffer_load_dwordx4 v12, s[36:39], s56 offen offset:2048 lds
v_mfma_f32_16x16x32_bf16 v[72:75], a[148:151], a[32:35], v[72:75]
ds_read_b64_tr_b16 a[232:233], v19 offset:21664
ds_read_b64_tr_b16 a[234:235], v19 offset:23456
v_mfma_f32_16x16x32_bf16 v[76:79], a[148:151], a[36:39], v[76:79]
ds_read_b64_tr_b16 a[236:237], v19 offset:21696
v_mfma_f32_16x16x32_bf16 v[128:131], a[176:179], a[32:35], v[128:131]
ds_read_b64_tr_b16 a[238:239], v19 offset:23488
v_mfma_f32_16x16x32_bf16 v[132:135], a[176:179], a[36:39], v[132:135]
buffer_load_dwordx4 v13, s[36:39], s56 offen offset:3072 lds
v_mfma_f32_16x16x32_bf16 v[80:83], a[152:155], a[32:35], v[80:83]
v_mfma_f32_16x16x32_bf16 v[84:87], a[152:155], a[36:39], v[84:87]
v_mfma_f32_16x16x32_bf16 v[136:139], a[180:183], a[32:35], v[136:139]
v_mfma_f32_16x16x32_bf16 v[140:143], a[180:183], a[36:39], v[140:143]
s_waitcnt lgkmcnt(0)
s_waitcnt vmcnt(8)
s_barrier
v_mfma_f32_16x16x32_bf16 v[32:35], a[184:187], a[40:43], v[32:35]
ds_read_b64_tr_b16 a[128:129], v19 offset:28672
s_add_u32 m0, s34, 4096
v_mfma_f32_16x16x32_bf16 v[36:39], a[184:187], a[44:47], v[36:39]
ds_read_b64_tr_b16 a[130:131], v19 offset:30464
s_nop 0
v_mfma_f32_16x16x32_bf16 v[88:91], a[212:215], a[40:43], v[88:91]
ds_read_b64_tr_b16 a[132:133], v19 offset:28704
ds_read_b64_tr_b16 a[134:135], v19 offset:30496
v_mfma_f32_16x16x32_bf16 v[92:95], a[212:215], a[44:47], v[92:95]
buffer_load_dwordx4 v14, s[36:39], s56 offen offset:0 lds
v_mfma_f32_16x16x32_bf16 v[40:43], a[188:191], a[40:43], v[40:43]
ds_read_b64_tr_b16 a[136:137], v19 offset:28736
ds_read_b64_tr_b16 a[138:139], v19 offset:30528
v_mfma_f32_16x16x32_bf16 v[44:47], a[188:191], a[44:47], v[44:47]
ds_read_b64_tr_b16 a[140:141], v19 offset:28768
ds_read_b64_tr_b16 a[142:143], v19 offset:30560
v_mfma_f32_16x16x32_bf16 v[96:99], a[216:219], a[40:43], v[96:99]
buffer_load_dwordx4 v15, s[36:39], s56 offen offset:1024 lds
v_mfma_f32_16x16x32_bf16 v[100:103], a[216:219], a[44:47], v[100:103]
ds_read_b64_tr_b16 a[144:145], v19 offset:28800
ds_read_b64_tr_b16 a[146:147], v19 offset:30592
v_mfma_f32_16x16x32_bf16 v[48:51], a[192:195], a[40:43], v[48:51]
ds_read_b64_tr_b16 a[148:149], v19 offset:28832
v_mfma_f32_16x16x32_bf16 v[52:55], a[192:195], a[44:47], v[52:55]
ds_read_b64_tr_b16 a[150:151], v19 offset:30624
ds_read_b64_tr_b16 a[152:153], v19 offset:28864
v_mfma_f32_16x16x32_bf16 v[104:107], a[220:223], a[40:43], v[104:107]
buffer_load_dwordx4 v16, s[36:39], s56 offen offset:2048 lds
v_mfma_f32_16x16x32_bf16 v[108:111], a[220:223], a[44:47], v[108:111]
ds_read_b64_tr_b16 a[154:155], v19 offset:30656
ds_read_b64_tr_b16 a[156:157], v19 offset:43008
v_mfma_f32_16x16x32_bf16 v[56:59], a[196:199], a[40:43], v[56:59]
ds_read_b64_tr_b16 a[158:159], v19 offset:44800
v_mfma_f32_16x16x32_bf16 v[60:63], a[196:199], a[44:47], v[60:63]
ds_read_b64_tr_b16 a[160:161], v19 offset:43040
ds_read_b64_tr_b16 a[162:163], v19 offset:44832
v_mfma_f32_16x16x32_bf16 v[112:115], a[224:227], a[40:43], v[112:115]
s_add_u32 s57, s40, 8192
ds_read_b64_tr_b16 a[164:165], v19 offset:43072
v_mfma_f32_16x16x32_bf16 v[116:119], a[224:227], a[44:47], v[116:119]
s_add_u32 s58, s41, 8192
ds_read_b64_tr_b16 a[166:167], v19 offset:44864
v_mfma_f32_16x16x32_bf16 v[64:67], a[200:203], a[40:43], v[64:67]
buffer_load_dwordx4 a[64:67], v17, s[16:19], s57 offen offset:0
v_mfma_f32_16x16x32_bf16 v[68:71], a[200:203], a[44:47], v[68:71]
ds_read_b64_tr_b16 a[168:169], v19 offset:43104
ds_read_b64_tr_b16 a[170:171], v19 offset:44896
v_mfma_f32_16x16x32_bf16 v[120:123], a[228:231], a[40:43], v[120:123]
ds_read_b64_tr_b16 a[172:173], v19 offset:43136
ds_read_b64_tr_b16 a[174:175], v19 offset:44928
v_mfma_f32_16x16x32_bf16 v[124:127], a[228:231], a[44:47], v[124:127]
ds_read_b64_tr_b16 a[176:177], v19 offset:43168
v_mfma_f32_16x16x32_bf16 v[72:75], a[204:207], a[40:43], v[72:75]
buffer_load_dwordx4 a[68:71], v17, s[16:19], s58 offen offset:0
v_mfma_f32_16x16x32_bf16 v[76:79], a[204:207], a[44:47], v[76:79]
ds_read_b64_tr_b16 a[178:179], v19 offset:44960
ds_read_b64_tr_b16 a[180:181], v19 offset:43200
v_mfma_f32_16x16x32_bf16 v[128:131], a[232:235], a[40:43], v[128:131]
ds_read_b64_tr_b16 a[182:183], v19 offset:44992
v_mfma_f32_16x16x32_bf16 v[132:135], a[232:235], a[44:47], v[132:135]
v_mfma_f32_16x16x32_bf16 v[80:83], a[208:211], a[40:43], v[80:83]
buffer_load_dwordx4 a[72:75], v17, s[16:19], s57 offen offset:1024
v_mfma_f32_16x16x32_bf16 v[84:87], a[208:211], a[44:47], v[84:87]
v_mfma_f32_16x16x32_bf16 v[136:139], a[236:239], a[40:43], v[136:139]
v_mfma_f32_16x16x32_bf16 v[140:143], a[236:239], a[44:47], v[140:143]
s_waitcnt vmcnt(10)
s_waitcnt lgkmcnt(0)
v_mfma_f32_16x16x32_bf16 v[32:35], a[128:131], a[48:51], v[32:35]
ds_read_b64_tr_b16 a[184:185], v19 offset:35840
ds_read_b64_tr_b16 a[186:187], v19 offset:37632
v_mfma_f32_16x16x32_bf16 v[36:39], a[128:131], a[52:55], v[36:39]
buffer_load_dwordx4 a[76:79], v17, s[16:19], s58 offen offset:1024
v_mfma_f32_16x16x32_bf16 v[88:91], a[156:159], a[48:51], v[88:91]
ds_read_b64_tr_b16 a[188:189], v19 offset:35872
ds_read_b64_tr_b16 a[190:191], v19 offset:37664
v_mfma_f32_16x16x32_bf16 v[92:95], a[156:159], a[52:55], v[92:95]
ds_read_b64_tr_b16 a[192:193], v19 offset:35904
v_mfma_f32_16x16x32_bf16 v[40:43], a[132:135], a[48:51], v[40:43]
ds_read_b64_tr_b16 a[194:195], v19 offset:37696
s_add_u32 m0, s34, 28672
v_mfma_f32_16x16x32_bf16 v[44:47], a[132:135], a[52:55], v[44:47]
ds_read_b64_tr_b16 a[196:197], v19 offset:35936
s_mov_b32 s56, 1146880
v_mfma_f32_16x16x32_bf16 v[96:99], a[160:163], a[48:51], v[96:99]
ds_read_b64_tr_b16 a[198:199], v19 offset:37728
ds_read_b64_tr_b16 a[200:201], v19 offset:35968
v_mfma_f32_16x16x32_bf16 v[100:103], a[160:163], a[52:55], v[100:103]
buffer_load_dwordx4 v10, s[36:39], s56 offen offset:0 lds
v_mfma_f32_16x16x32_bf16 v[48:51], a[136:139], a[48:51], v[48:51]
ds_read_b64_tr_b16 a[202:203], v19 offset:37760
ds_read_b64_tr_b16 a[204:205], v19 offset:36000
v_mfma_f32_16x16x32_bf16 v[52:55], a[136:139], a[52:55], v[52:55]
ds_read_b64_tr_b16 a[206:207], v19 offset:37792
ds_read_b64_tr_b16 a[208:209], v19 offset:36032
v_mfma_f32_16x16x32_bf16 v[104:107], a[164:167], a[48:51], v[104:107]
buffer_load_dwordx4 v11, s[36:39], s56 offen offset:1024 lds
v_mfma_f32_16x16x32_bf16 v[108:111], a[164:167], a[52:55], v[108:111]
ds_read_b64_tr_b16 a[210:211], v19 offset:37824
ds_read_b64_tr_b16 a[212:213], v19 offset:50176
v_mfma_f32_16x16x32_bf16 v[56:59], a[140:143], a[48:51], v[56:59]
ds_read_b64_tr_b16 a[214:215], v19 offset:51968
v_mfma_f32_16x16x32_bf16 v[60:63], a[140:143], a[52:55], v[60:63]
ds_read_b64_tr_b16 a[216:217], v19 offset:50208
ds_read_b64_tr_b16 a[218:219], v19 offset:52000
v_mfma_f32_16x16x32_bf16 v[112:115], a[168:171], a[48:51], v[112:115]
buffer_load_dwordx4 v12, s[36:39], s56 offen offset:2048 lds
v_mfma_f32_16x16x32_bf16 v[116:119], a[168:171], a[52:55], v[116:119]
ds_read_b64_tr_b16 a[220:221], v19 offset:50240
ds_read_b64_tr_b16 a[222:223], v19 offset:52032
v_mfma_f32_16x16x32_bf16 v[64:67], a[144:147], a[48:51], v[64:67]
ds_read_b64_tr_b16 a[224:225], v19 offset:50272
v_mfma_f32_16x16x32_bf16 v[68:71], a[144:147], a[52:55], v[68:71]
ds_read_b64_tr_b16 a[226:227], v19 offset:52064
v_mfma_f32_16x16x32_bf16 v[120:123], a[172:175], a[48:51], v[120:123]
ds_read_b64_tr_b16 a[228:229], v19 offset:50304
ds_read_b64_tr_b16 a[230:231], v19 offset:52096
v_mfma_f32_16x16x32_bf16 v[124:127], a[172:175], a[52:55], v[124:127]
buffer_load_dwordx4 v13, s[36:39], s56 offen offset:3072 lds
v_mfma_f32_16x16x32_bf16 v[72:75], a[148:151], a[48:51], v[72:75]
ds_read_b64_tr_b16 a[232:233], v19 offset:50336
ds_read_b64_tr_b16 a[234:235], v19 offset:52128
v_mfma_f32_16x16x32_bf16 v[76:79], a[148:151], a[52:55], v[76:79]
ds_read_b64_tr_b16 a[236:237], v19 offset:50368
v_mfma_f32_16x16x32_bf16 v[128:131], a[176:179], a[48:51], v[128:131]
ds_read_b64_tr_b16 a[238:239], v19 offset:52160
s_add_u32 m0, s34, 32768
v_mfma_f32_16x16x32_bf16 v[132:135], a[176:179], a[52:55], v[132:135]
s_nop 0
v_mfma_f32_16x16x32_bf16 v[80:83], a[152:155], a[48:51], v[80:83]
buffer_load_dwordx4 v14, s[36:39], s56 offen offset:0 lds
v_mfma_f32_16x16x32_bf16 v[84:87], a[152:155], a[52:55], v[84:87]
v_mfma_f32_16x16x32_bf16 v[136:139], a[180:183], a[48:51], v[136:139]
v_mfma_f32_16x16x32_bf16 v[140:143], a[180:183], a[52:55], v[140:143]
s_waitcnt lgkmcnt(0)
s_waitcnt vmcnt(9)
s_barrier
v_mfma_f32_16x16x32_bf16 v[32:35], a[184:187], a[56:59], v[32:35]
ds_read_b64_tr_b16 a[128:129], v18 offset:0
ds_read_b64_tr_b16 a[130:131], v18 offset:1792
v_mfma_f32_16x16x32_bf16 v[36:39], a[184:187], a[60:63], v[36:39]
buffer_load_dwordx4 v15, s[36:39], s56 offen offset:1024 lds
v_mfma_f32_16x16x32_bf16 v[88:91], a[212:215], a[56:59], v[88:91]
ds_read_b64_tr_b16 a[132:133], v18 offset:32
ds_read_b64_tr_b16 a[134:135], v18 offset:1824
v_mfma_f32_16x16x32_bf16 v[92:95], a[212:215], a[60:63], v[92:95]
ds_read_b64_tr_b16 a[136:137], v18 offset:64
v_mfma_f32_16x16x32_bf16 v[40:43], a[188:191], a[56:59], v[40:43]
ds_read_b64_tr_b16 a[138:139], v18 offset:1856
ds_read_b64_tr_b16 a[140:141], v18 offset:96
v_mfma_f32_16x16x32_bf16 v[44:47], a[188:191], a[60:63], v[44:47]
buffer_load_dwordx4 v16, s[36:39], s56 offen offset:2048 lds
v_mfma_f32_16x16x32_bf16 v[96:99], a[216:219], a[56:59], v[96:99]
ds_read_b64_tr_b16 a[142:143], v18 offset:1888
ds_read_b64_tr_b16 a[144:145], v18 offset:128
v_mfma_f32_16x16x32_bf16 v[100:103], a[216:219], a[60:63], v[100:103]
ds_read_b64_tr_b16 a[146:147], v18 offset:1920
v_mfma_f32_16x16x32_bf16 v[48:51], a[192:195], a[56:59], v[48:51]
ds_read_b64_tr_b16 a[148:149], v18 offset:160
v_mfma_f32_16x16x32_bf16 v[52:55], a[192:195], a[60:63], v[52:55]
ds_read_b64_tr_b16 a[150:151], v18 offset:1952
ds_read_b64_tr_b16 a[152:153], v18 offset:192
v_mfma_f32_16x16x32_bf16 v[104:107], a[220:223], a[56:59], v[104:107]
buffer_load_dwordx4 a[80:83], v17, s[16:19], s57 offen offset:2048
v_mfma_f32_16x16x32_bf16 v[108:111], a[220:223], a[60:63], v[108:111]
ds_read_b64_tr_b16 a[154:155], v18 offset:1984
ds_read_b64_tr_b16 a[156:157], v18 offset:14336
v_mfma_f32_16x16x32_bf16 v[56:59], a[196:199], a[56:59], v[56:59]
ds_read_b64_tr_b16 a[158:159], v18 offset:16128
v_mfma_f32_16x16x32_bf16 v[60:63], a[196:199], a[60:63], v[60:63]
ds_read_b64_tr_b16 a[160:161], v18 offset:14368
ds_read_b64_tr_b16 a[162:163], v18 offset:16160
v_mfma_f32_16x16x32_bf16 v[112:115], a[224:227], a[56:59], v[112:115]
buffer_load_dwordx4 a[84:87], v17, s[16:19], s58 offen offset:2048
v_mfma_f32_16x16x32_bf16 v[116:119], a[224:227], a[60:63], v[116:119]
ds_read_b64_tr_b16 a[164:165], v18 offset:14400
ds_read_b64_tr_b16 a[166:167], v18 offset:16192
v_mfma_f32_16x16x32_bf16 v[64:67], a[200:203], a[56:59], v[64:67]
ds_read_b64_tr_b16 a[168:169], v18 offset:14432
v_mfma_f32_16x16x32_bf16 v[68:71], a[200:203], a[60:63], v[68:71]
ds_read_b64_tr_b16 a[170:171], v18 offset:16224
v_mfma_f32_16x16x32_bf16 v[120:123], a[228:231], a[56:59], v[120:123]
ds_read_b64_tr_b16 a[172:173], v18 offset:14464
ds_read_b64_tr_b16 a[174:175], v18 offset:16256
v_mfma_f32_16x16x32_bf16 v[124:127], a[228:231], a[60:63], v[124:127]
buffer_load_dwordx4 a[88:91], v17, s[16:19], s57 offen offset:3072
v_mfma_f32_16x16x32_bf16 v[72:75], a[204:207], a[56:59], v[72:75]
ds_read_b64_tr_b16 a[176:177], v18 offset:14496
ds_read_b64_tr_b16 a[178:179], v18 offset:16288
v_mfma_f32_16x16x32_bf16 v[76:79], a[204:207], a[60:63], v[76:79]
ds_read_b64_tr_b16 a[180:181], v18 offset:14528
v_mfma_f32_16x16x32_bf16 v[128:131], a[232:235], a[56:59], v[128:131]
ds_read_b64_tr_b16 a[182:183], v18 offset:16320
v_mfma_f32_16x16x32_bf16 v[132:135], a[232:235], a[60:63], v[132:135]
buffer_load_dwordx4 a[92:95], v17, s[16:19], s58 offen offset:3072
v_mfma_f32_16x16x32_bf16 v[80:83], a[208:211], a[56:59], v[80:83]
v_mfma_f32_16x16x32_bf16 v[84:87], a[208:211], a[60:63], v[84:87]
v_mfma_f32_16x16x32_bf16 v[136:139], a[236:239], a[56:59], v[136:139]
v_mfma_f32_16x16x32_bf16 v[140:143], a[236:239], a[60:63], v[140:143]
s_waitcnt vmcnt(11)
s_waitcnt lgkmcnt(0)
v_mfma_f32_16x16x32_bf16 v[32:35], a[128:131], a[64:67], v[32:35]
ds_read_b64_tr_b16 a[184:185], v18 offset:7168
s_add_u32 m0, s34, 57344
v_mfma_f32_16x16x32_bf16 v[36:39], a[128:131], a[68:71], v[36:39]
ds_read_b64_tr_b16 a[186:187], v18 offset:8960
s_mov_b32 s56, 1376256
v_mfma_f32_16x16x32_bf16 v[88:91], a[156:159], a[64:67], v[88:91]
ds_read_b64_tr_b16 a[188:189], v18 offset:7200
ds_read_b64_tr_b16 a[190:191], v18 offset:8992
v_mfma_f32_16x16x32_bf16 v[92:95], a[156:159], a[68:71], v[92:95]
buffer_load_dwordx4 v10, s[36:39], s56 offen offset:0 lds
v_mfma_f32_16x16x32_bf16 v[40:43], a[132:135], a[64:67], v[40:43]
ds_read_b64_tr_b16 a[192:193], v18 offset:7232
ds_read_b64_tr_b16 a[194:195], v18 offset:9024
v_mfma_f32_16x16x32_bf16 v[44:47], a[132:135], a[68:71], v[44:47]
ds_read_b64_tr_b16 a[196:197], v18 offset:7264
ds_read_b64_tr_b16 a[198:199], v18 offset:9056
v_mfma_f32_16x16x32_bf16 v[96:99], a[160:163], a[64:67], v[96:99]
buffer_load_dwordx4 v11, s[36:39], s56 offen offset:1024 lds
v_mfma_f32_16x16x32_bf16 v[100:103], a[160:163], a[68:71], v[100:103]
ds_read_b64_tr_b16 a[200:201], v18 offset:7296
ds_read_b64_tr_b16 a[202:203], v18 offset:9088
v_mfma_f32_16x16x32_bf16 v[48:51], a[136:139], a[64:67], v[48:51]
ds_read_b64_tr_b16 a[204:205], v18 offset:7328
v_mfma_f32_16x16x32_bf16 v[52:55], a[136:139], a[68:71], v[52:55]
ds_read_b64_tr_b16 a[206:207], v18 offset:9120
ds_read_b64_tr_b16 a[208:209], v18 offset:7360
v_mfma_f32_16x16x32_bf16 v[104:107], a[164:167], a[64:67], v[104:107]
buffer_load_dwordx4 v12, s[36:39], s56 offen offset:2048 lds
v_mfma_f32_16x16x32_bf16 v[108:111], a[164:167], a[68:71], v[108:111]
ds_read_b64_tr_b16 a[210:211], v18 offset:9152
ds_read_b64_tr_b16 a[212:213], v18 offset:21504
v_mfma_f32_16x16x32_bf16 v[56:59], a[140:143], a[64:67], v[56:59]
ds_read_b64_tr_b16 a[214:215], v18 offset:23296
v_mfma_f32_16x16x32_bf16 v[60:63], a[140:143], a[68:71], v[60:63]
ds_read_b64_tr_b16 a[216:217], v18 offset:21536
ds_read_b64_tr_b16 a[218:219], v18 offset:23328
v_mfma_f32_16x16x32_bf16 v[112:115], a[168:171], a[64:67], v[112:115]
buffer_load_dwordx4 v13, s[36:39], s56 offen offset:3072 lds
v_mfma_f32_16x16x32_bf16 v[116:119], a[168:171], a[68:71], v[116:119]
ds_read_b64_tr_b16 a[220:221], v18 offset:21568
ds_read_b64_tr_b16 a[222:223], v18 offset:23360
v_mfma_f32_16x16x32_bf16 v[64:67], a[144:147], a[64:67], v[64:67]
ds_read_b64_tr_b16 a[224:225], v18 offset:21600
v_mfma_f32_16x16x32_bf16 v[68:71], a[144:147], a[68:71], v[68:71]
ds_read_b64_tr_b16 a[226:227], v18 offset:23392
v_mfma_f32_16x16x32_bf16 v[120:123], a[172:175], a[64:67], v[120:123]
ds_read_b64_tr_b16 a[228:229], v18 offset:21632
s_add_u32 m0, s34, 61440
v_mfma_f32_16x16x32_bf16 v[124:127], a[172:175], a[68:71], v[124:127]
ds_read_b64_tr_b16 a[230:231], v18 offset:23424
s_nop 0
v_mfma_f32_16x16x32_bf16 v[72:75], a[148:151], a[64:67], v[72:75]
ds_read_b64_tr_b16 a[232:233], v18 offset:21664
ds_read_b64_tr_b16 a[234:235], v18 offset:23456
v_mfma_f32_16x16x32_bf16 v[76:79], a[148:151], a[68:71], v[76:79]
buffer_load_dwordx4 v14, s[36:39], s56 offen offset:0 lds
v_mfma_f32_16x16x32_bf16 v[128:131], a[176:179], a[64:67], v[128:131]
ds_read_b64_tr_b16 a[236:237], v18 offset:21696
ds_read_b64_tr_b16 a[238:239], v18 offset:23488
v_mfma_f32_16x16x32_bf16 v[132:135], a[176:179], a[68:71], v[132:135]
v_mfma_f32_16x16x32_bf16 v[80:83], a[152:155], a[64:67], v[80:83]
buffer_load_dwordx4 v15, s[36:39], s56 offen offset:1024 lds
v_mfma_f32_16x16x32_bf16 v[84:87], a[152:155], a[68:71], v[84:87]
v_mfma_f32_16x16x32_bf16 v[136:139], a[180:183], a[64:67], v[136:139]
v_mfma_f32_16x16x32_bf16 v[140:143], a[180:183], a[68:71], v[140:143]
s_waitcnt lgkmcnt(0)
s_waitcnt vmcnt(10)
s_barrier
v_mfma_f32_16x16x32_bf16 v[32:35], a[184:187], a[72:75], v[32:35]
ds_read_b64_tr_b16 a[128:129], v18 offset:28672
ds_read_b64_tr_b16 a[130:131], v18 offset:30464
v_mfma_f32_16x16x32_bf16 v[36:39], a[184:187], a[76:79], v[36:39]
buffer_load_dwordx4 v16, s[36:39], s56 offen offset:2048 lds
v_mfma_f32_16x16x32_bf16 v[88:91], a[212:215], a[72:75], v[88:91]
ds_read_b64_tr_b16 a[132:133], v18 offset:28704
ds_read_b64_tr_b16 a[134:135], v18 offset:30496
v_mfma_f32_16x16x32_bf16 v[92:95], a[212:215], a[76:79], v[92:95]
ds_read_b64_tr_b16 a[136:137], v18 offset:28736
v_mfma_f32_16x16x32_bf16 v[40:43], a[188:191], a[72:75], v[40:43]
ds_read_b64_tr_b16 a[138:139], v18 offset:30528
s_add_u32 s57, s40, 12288
v_mfma_f32_16x16x32_bf16 v[44:47], a[188:191], a[76:79], v[44:47]
ds_read_b64_tr_b16 a[140:141], v18 offset:28768
s_add_u32 s58, s41, 12288
v_mfma_f32_16x16x32_bf16 v[96:99], a[216:219], a[72:75], v[96:99]
ds_read_b64_tr_b16 a[142:143], v18 offset:30560
ds_read_b64_tr_b16 a[144:145], v18 offset:28800
v_mfma_f32_16x16x32_bf16 v[100:103], a[216:219], a[76:79], v[100:103]
buffer_load_dwordx4 a[96:99], v17, s[16:19], s57 offen offset:0
v_mfma_f32_16x16x32_bf16 v[48:51], a[192:195], a[72:75], v[48:51]
ds_read_b64_tr_b16 a[146:147], v18 offset:30592
ds_read_b64_tr_b16 a[148:149], v18 offset:28832
v_mfma_f32_16x16x32_bf16 v[52:55], a[192:195], a[76:79], v[52:55]
ds_read_b64_tr_b16 a[150:151], v18 offset:30624
ds_read_b64_tr_b16 a[152:153], v18 offset:28864
v_mfma_f32_16x16x32_bf16 v[104:107], a[220:223], a[72:75], v[104:107]
buffer_load_dwordx4 a[100:103], v17, s[16:19], s58 offen offset:0
v_mfma_f32_16x16x32_bf16 v[108:111], a[220:223], a[76:79], v[108:111]
ds_read_b64_tr_b16 a[154:155], v18 offset:30656
ds_read_b64_tr_b16 a[156:157], v18 offset:43008
v_mfma_f32_16x16x32_bf16 v[56:59], a[196:199], a[72:75], v[56:59]
ds_read_b64_tr_b16 a[158:159], v18 offset:44800
v_mfma_f32_16x16x32_bf16 v[60:63], a[196:199], a[76:79], v[60:63]
ds_read_b64_tr_b16 a[160:161], v18 offset:43040
ds_read_b64_tr_b16 a[162:163], v18 offset:44832
v_mfma_f32_16x16x32_bf16 v[112:115], a[224:227], a[72:75], v[112:115]
buffer_load_dwordx4 a[104:107], v17, s[16:19], s57 offen offset:1024
v_mfma_f32_16x16x32_bf16 v[116:119], a[224:227], a[76:79], v[116:119]
ds_read_b64_tr_b16 a[164:165], v18 offset:43072
ds_read_b64_tr_b16 a[166:167], v18 offset:44864
v_mfma_f32_16x16x32_bf16 v[64:67], a[200:203], a[72:75], v[64:67]
ds_read_b64_tr_b16 a[168:169], v18 offset:43104
v_mfma_f32_16x16x32_bf16 v[68:71], a[200:203], a[76:79], v[68:71]
ds_read_b64_tr_b16 a[170:171], v18 offset:44896
v_mfma_f32_16x16x32_bf16 v[120:123], a[228:231], a[72:75], v[120:123]
ds_read_b64_tr_b16 a[172:173], v18 offset:43136
ds_read_b64_tr_b16 a[174:175], v18 offset:44928
v_mfma_f32_16x16x32_bf16 v[124:127], a[228:231], a[76:79], v[124:127]
buffer_load_dwordx4 a[108:111], v17, s[16:19], s58 offen offset:1024
v_mfma_f32_16x16x32_bf16 v[72:75], a[204:207], a[72:75], v[72:75]
ds_read_b64_tr_b16 a[176:177], v18 offset:43168
ds_read_b64_tr_b16 a[178:179], v18 offset:44960
v_mfma_f32_16x16x32_bf16 v[76:79], a[204:207], a[76:79], v[76:79]
ds_read_b64_tr_b16 a[180:181], v18 offset:43200
v_mfma_f32_16x16x32_bf16 v[128:131], a[232:235], a[72:75], v[128:131]
ds_read_b64_tr_b16 a[182:183], v18 offset:44992
s_add_u32 m0, s34, 86016
v_mfma_f32_16x16x32_bf16 v[132:135], a[232:235], a[76:79], v[132:135]
s_mov_b32 s56, 1605632
v_mfma_f32_16x16x32_bf16 v[80:83], a[208:211], a[72:75], v[80:83]
buffer_load_dwordx4 v10, s[36:39], s56 offen offset:0 lds
v_mfma_f32_16x16x32_bf16 v[84:87], a[208:211], a[76:79], v[84:87]
v_mfma_f32_16x16x32_bf16 v[136:139], a[236:239], a[72:75], v[136:139]
v_mfma_f32_16x16x32_bf16 v[140:143], a[236:239], a[76:79], v[140:143]
s_waitcnt vmcnt(12)
s_waitcnt lgkmcnt(0)
v_mfma_f32_16x16x32_bf16 v[32:35], a[128:131], a[80:83], v[32:35]
ds_read_b64_tr_b16 a[184:185], v18 offset:35840
ds_read_b64_tr_b16 a[186:187], v18 offset:37632
v_mfma_f32_16x16x32_bf16 v[36:39], a[128:131], a[84:87], v[36:39]
buffer_load_dwordx4 v11, s[36:39], s56 offen offset:1024 lds
v_mfma_f32_16x16x32_bf16 v[88:91], a[156:159], a[80:83], v[88:91]
ds_read_b64_tr_b16 a[188:189], v18 offset:35872
ds_read_b64_tr_b16 a[190:191], v18 offset:37664
v_mfma_f32_16x16x32_bf16 v[92:95], a[156:159], a[84:87], v[92:95]
ds_read_b64_tr_b16 a[192:193], v18 offset:35904
v_mfma_f32_16x16x32_bf16 v[40:43], a[132:135], a[80:83], v[40:43]
ds_read_b64_tr_b16 a[194:195], v18 offset:37696
ds_read_b64_tr_b16 a[196:197], v18 offset:35936
v_mfma_f32_16x16x32_bf16 v[44:47], a[132:135], a[84:87], v[44:47]
buffer_load_dwordx4 v12, s[36:39], s56 offen offset:2048 lds
v_mfma_f32_16x16x32_bf16 v[96:99], a[160:163], a[80:83], v[96:99]
ds_read_b64_tr_b16 a[198:199], v18 offset:37728
ds_read_b64_tr_b16 a[200:201], v18 offset:35968
v_mfma_f32_16x16x32_bf16 v[100:103], a[160:163], a[84:87], v[100:103]
ds_read_b64_tr_b16 a[202:203], v18 offset:37760
v_mfma_f32_16x16x32_bf16 v[48:51], a[136:139], a[80:83], v[48:51]
ds_read_b64_tr_b16 a[204:205], v18 offset:36000
v_mfma_f32_16x16x32_bf16 v[52:55], a[136:139], a[84:87], v[52:55]
buffer_load_dwordx4 v13, s[36:39], s56 offen offset:3072 lds
v_mfma_f32_16x16x32_bf16 v[104:107], a[164:167], a[80:83], v[104:107]
ds_read_b64_tr_b16 a[206:207], v18 offset:37792
ds_read_b64_tr_b16 a[208:209], v18 offset:36032
v_mfma_f32_16x16x32_bf16 v[108:111], a[164:167], a[84:87], v[108:111]
ds_read_b64_tr_b16 a[210:211], v18 offset:37824
ds_read_b64_tr_b16 a[212:213], v18 offset:50176
v_mfma_f32_16x16x32_bf16 v[56:59], a[140:143], a[80:83], v[56:59]
ds_read_b64_tr_b16 a[214:215], v18 offset:51968
s_add_u32 m0, s34, 90112
v_mfma_f32_16x16x32_bf16 v[60:63], a[140:143], a[84:87], v[60:63]
ds_read_b64_tr_b16 a[216:217], v18 offset:50208
ds_read_b64_tr_b16 a[218:219], v18 offset:52000
v_mfma_f32_16x16x32_bf16 v[112:115], a[168:171], a[80:83], v[112:115]
s_nop 0
ds_read_b64_tr_b16 a[220:221], v18 offset:50240
v_mfma_f32_16x16x32_bf16 v[116:119], a[168:171], a[84:87], v[116:119]
buffer_load_dwordx4 v14, s[36:39], s56 offen offset:0 lds
v_mfma_f32_16x16x32_bf16 v[64:67], a[144:147], a[80:83], v[64:67]
ds_read_b64_tr_b16 a[222:223], v18 offset:52032
ds_read_b64_tr_b16 a[224:225], v18 offset:50272
v_mfma_f32_16x16x32_bf16 v[68:71], a[144:147], a[84:87], v[68:71]
ds_read_b64_tr_b16 a[226:227], v18 offset:52064
v_mfma_f32_16x16x32_bf16 v[120:123], a[172:175], a[80:83], v[120:123]
ds_read_b64_tr_b16 a[228:229], v18 offset:50304
ds_read_b64_tr_b16 a[230:231], v18 offset:52096
v_mfma_f32_16x16x32_bf16 v[124:127], a[172:175], a[84:87], v[124:127]
buffer_load_dwordx4 v15, s[36:39], s56 offen offset:1024 lds
v_mfma_f32_16x16x32_bf16 v[72:75], a[148:151], a[80:83], v[72:75]
ds_read_b64_tr_b16 a[232:233], v18 offset:50336
ds_read_b64_tr_b16 a[234:235], v18 offset:52128
v_mfma_f32_16x16x32_bf16 v[76:79], a[148:151], a[84:87], v[76:79]
ds_read_b64_tr_b16 a[236:237], v18 offset:50368
v_mfma_f32_16x16x32_bf16 v[128:131], a[176:179], a[80:83], v[128:131]
ds_read_b64_tr_b16 a[238:239], v18 offset:52160
v_mfma_f32_16x16x32_bf16 v[132:135], a[176:179], a[84:87], v[132:135]
buffer_load_dwordx4 v16, s[36:39], s56 offen offset:2048 lds
v_mfma_f32_16x16x32_bf16 v[80:83], a[152:155], a[80:83], v[80:83]
v_mfma_f32_16x16x32_bf16 v[84:87], a[152:155], a[84:87], v[84:87]
v_mfma_f32_16x16x32_bf16 v[136:139], a[180:183], a[80:83], v[136:139]
v_mfma_f32_16x16x32_bf16 v[140:143], a[180:183], a[84:87], v[140:143]
s_waitcnt lgkmcnt(0)
s_waitcnt vmcnt(11)
s_barrier
v_mfma_f32_16x16x32_bf16 v[32:35], a[184:187], a[88:91], v[32:35]
ds_read_b64_tr_b16 a[128:129], v19 offset:0
ds_read_b64_tr_b16 a[130:131], v19 offset:1792
v_mfma_f32_16x16x32_bf16 v[36:39], a[184:187], a[92:95], v[36:39]
buffer_load_dwordx4 a[112:115], v17, s[16:19], s57 offen offset:2048
v_mfma_f32_16x16x32_bf16 v[88:91], a[212:215], a[88:91], v[88:91]
ds_read_b64_tr_b16 a[132:133], v19 offset:32
ds_read_b64_tr_b16 a[134:135], v19 offset:1824
v_mfma_f32_16x16x32_bf16 v[92:95], a[212:215], a[92:95], v[92:95]
ds_read_b64_tr_b16 a[136:137], v19 offset:64
v_mfma_f32_16x16x32_bf16 v[40:43], a[188:191], a[88:91], v[40:43]
ds_read_b64_tr_b16 a[138:139], v19 offset:1856
ds_read_b64_tr_b16 a[140:141], v19 offset:96
v_mfma_f32_16x16x32_bf16 v[44:47], a[188:191], a[92:95], v[44:47]
ds_read_b64_tr_b16 a[142:143], v19 offset:1888
v_mfma_f32_16x16x32_bf16 v[96:99], a[216:219], a[88:91], v[96:99]
ds_read_b64_tr_b16 a[144:145], v19 offset:128
v_mfma_f32_16x16x32_bf16 v[100:103], a[216:219], a[92:95], v[100:103]
buffer_load_dwordx4 a[116:119], v17, s[16:19], s58 offen offset:2048
v_mfma_f32_16x16x32_bf16 v[48:51], a[192:195], a[88:91], v[48:51]
ds_read_b64_tr_b16 a[146:147], v19 offset:1920
ds_read_b64_tr_b16 a[148:149], v19 offset:160
v_mfma_f32_16x16x32_bf16 v[52:55], a[192:195], a[92:95], v[52:55]
ds_read_b64_tr_b16 a[150:151], v19 offset:1952
ds_read_b64_tr_b16 a[152:153], v19 offset:192
v_mfma_f32_16x16x32_bf16 v[104:107], a[220:223], a[88:91], v[104:107]
ds_read_b64_tr_b16 a[154:155], v19 offset:1984
v_mfma_f32_16x16x32_bf16 v[108:111], a[220:223], a[92:95], v[108:111]
ds_read_b64_tr_b16 a[156:157], v19 offset:14336
v_mfma_f32_16x16x32_bf16 v[56:59], a[196:199], a[88:91], v[56:59]
ds_read_b64_tr_b16 a[158:159], v19 offset:16128
v_mfma_f32_16x16x32_bf16 v[60:63], a[196:199], a[92:95], v[60:63]
ds_read_b64_tr_b16 a[160:161], v19 offset:14368
ds_read_b64_tr_b16 a[162:163], v19 offset:16160
v_mfma_f32_16x16x32_bf16 v[112:115], a[224:227], a[88:91], v[112:115]
buffer_load_dwordx4 a[120:123], v17, s[16:19], s57 offen offset:3072
v_mfma_f32_16x16x32_bf16 v[116:119], a[224:227], a[92:95], v[116:119]
ds_read_b64_tr_b16 a[164:165], v19 offset:14400
ds_read_b64_tr_b16 a[166:167], v19 offset:16192
v_mfma_f32_16x16x32_bf16 v[64:67], a[200:203], a[88:91], v[64:67]
ds_read_b64_tr_b16 a[168:169], v19 offset:14432
v_mfma_f32_16x16x32_bf16 v[68:71], a[200:203], a[92:95], v[68:71]
ds_read_b64_tr_b16 a[170:171], v19 offset:16224
v_mfma_f32_16x16x32_bf16 v[120:123], a[228:231], a[88:91], v[120:123]
ds_read_b64_tr_b16 a[172:173], v19 offset:14464
ds_read_b64_tr_b16 a[174:175], v19 offset:16256
v_mfma_f32_16x16x32_bf16 v[124:127], a[228:231], a[92:95], v[124:127]
ds_read_b64_tr_b16 a[176:177], v19 offset:14496
v_mfma_f32_16x16x32_bf16 v[72:75], a[204:207], a[88:91], v[72:75]
ds_read_b64_tr_b16 a[178:179], v19 offset:16288
v_mfma_f32_16x16x32_bf16 v[76:79], a[204:207], a[92:95], v[76:79]
buffer_load_dwordx4 a[124:127], v17, s[16:19], s58 offen offset:3072
v_mfma_f32_16x16x32_bf16 v[128:131], a[232:235], a[88:91], v[128:131]
ds_read_b64_tr_b16 a[180:181], v19 offset:14528
ds_read_b64_tr_b16 a[182:183], v19 offset:16320
v_mfma_f32_16x16x32_bf16 v[132:135], a[232:235], a[92:95], v[132:135]
v_mfma_f32_16x16x32_bf16 v[80:83], a[208:211], a[88:91], v[80:83]
v_mfma_f32_16x16x32_bf16 v[84:87], a[208:211], a[92:95], v[84:87]
v_mfma_f32_16x16x32_bf16 v[136:139], a[236:239], a[88:91], v[136:139]
v_mfma_f32_16x16x32_bf16 v[140:143], a[236:239], a[92:95], v[140:143]
s_waitcnt vmcnt(11)
s_waitcnt lgkmcnt(0)
v_mfma_f32_16x16x32_bf16 v[32:35], a[128:131], a[96:99], v[32:35]
ds_read_b64_tr_b16 a[184:185], v19 offset:7168
ds_read_b64_tr_b16 a[186:187], v19 offset:8960
v_mfma_f32_16x16x32_bf16 v[36:39], a[128:131], a[100:103], v[36:39]
ds_read_b64_tr_b16 a[188:189], v19 offset:7200
v_mfma_f32_16x16x32_bf16 v[88:91], a[156:159], a[96:99], v[88:91]
ds_read_b64_tr_b16 a[190:191], v19 offset:8992
v_mfma_f32_16x16x32_bf16 v[92:95], a[156:159], a[100:103], v[92:95]
ds_read_b64_tr_b16 a[192:193], v19 offset:7232
v_mfma_f32_16x16x32_bf16 v[40:43], a[132:135], a[96:99], v[40:43]
ds_read_b64_tr_b16 a[194:195], v19 offset:9024
ds_read_b64_tr_b16 a[196:197], v19 offset:7264
v_mfma_f32_16x16x32_bf16 v[44:47], a[132:135], a[100:103], v[44:47]
ds_read_b64_tr_b16 a[198:199], v19 offset:9056
v_mfma_f32_16x16x32_bf16 v[96:99], a[160:163], a[96:99], v[96:99]
ds_read_b64_tr_b16 a[200:201], v19 offset:7296
v_mfma_f32_16x16x32_bf16 v[100:103], a[160:163], a[100:103], v[100:103]
ds_read_b64_tr_b16 a[202:203], v19 offset:9088
v_mfma_f32_16x16x32_bf16 v[48:51], a[136:139], a[96:99], v[48:51]
ds_read_b64_tr_b16 a[204:205], v19 offset:7328
v_mfma_f32_16x16x32_bf16 v[52:55], a[136:139], a[100:103], v[52:55]
ds_read_b64_tr_b16 a[206:207], v19 offset:9120
ds_read_b64_tr_b16 a[208:209], v19 offset:7360
v_mfma_f32_16x16x32_bf16 v[104:107], a[164:167], a[96:99], v[104:107]
ds_read_b64_tr_b16 a[210:211], v19 offset:9152
v_mfma_f32_16x16x32_bf16 v[108:111], a[164:167], a[100:103], v[108:111]
ds_read_b64_tr_b16 a[212:213], v19 offset:21504
v_mfma_f32_16x16x32_bf16 v[56:59], a[140:143], a[96:99], v[56:59]
ds_read_b64_tr_b16 a[214:215], v19 offset:23296
v_mfma_f32_16x16x32_bf16 v[60:63], a[140:143], a[100:103], v[60:63]
ds_read_b64_tr_b16 a[216:217], v19 offset:21536
ds_read_b64_tr_b16 a[218:219], v19 offset:23328
v_mfma_f32_16x16x32_bf16 v[112:115], a[168:171], a[96:99], v[112:115]
ds_read_b64_tr_b16 a[220:221], v19 offset:21568
v_mfma_f32_16x16x32_bf16 v[116:119], a[168:171], a[100:103], v[116:119]
ds_read_b64_tr_b16 a[222:223], v19 offset:23360
v_mfma_f32_16x16x32_bf16 v[64:67], a[144:147], a[96:99], v[64:67]
ds_read_b64_tr_b16 a[224:225], v19 offset:21600
v_mfma_f32_16x16x32_bf16 v[68:71], a[144:147], a[100:103], v[68:71]
ds_read_b64_tr_b16 a[226:227], v19 offset:23392
v_mfma_f32_16x16x32_bf16 v[120:123], a[172:175], a[96:99], v[120:123]
ds_read_b64_tr_b16 a[228:229], v19 offset:21632
ds_read_b64_tr_b16 a[230:231], v19 offset:23424
v_mfma_f32_16x16x32_bf16 v[124:127], a[172:175], a[100:103], v[124:127]
ds_read_b64_tr_b16 a[232:233], v19 offset:21664
v_mfma_f32_16x16x32_bf16 v[72:75], a[148:151], a[96:99], v[72:75]
ds_read_b64_tr_b16 a[234:235], v19 offset:23456
v_mfma_f32_16x16x32_bf16 v[76:79], a[148:151], a[100:103], v[76:79]
ds_read_b64_tr_b16 a[236:237], v19 offset:21696
v_mfma_f32_16x16x32_bf16 v[128:131], a[176:179], a[96:99], v[128:131]
ds_read_b64_tr_b16 a[238:239], v19 offset:23488
v_mfma_f32_16x16x32_bf16 v[132:135], a[176:179], a[100:103], v[132:135]
v_mfma_f32_16x16x32_bf16 v[80:83], a[152:155], a[96:99], v[80:83]
v_mfma_f32_16x16x32_bf16 v[84:87], a[152:155], a[100:103], v[84:87]
v_mfma_f32_16x16x32_bf16 v[136:139], a[180:183], a[96:99], v[136:139]
v_mfma_f32_16x16x32_bf16 v[140:143], a[180:183], a[100:103], v[140:143]
s_waitcnt lgkmcnt(0)
s_waitcnt vmcnt(4)
s_barrier
v_mfma_f32_16x16x32_bf16 v[32:35], a[184:187], a[104:107], v[32:35]
ds_read_b64_tr_b16 a[128:129], v19 offset:28672
ds_read_b64_tr_b16 a[130:131], v19 offset:30464
v_mfma_f32_16x16x32_bf16 v[36:39], a[184:187], a[108:111], v[36:39]
ds_read_b64_tr_b16 a[132:133], v19 offset:28704
v_mfma_f32_16x16x32_bf16 v[88:91], a[212:215], a[104:107], v[88:91]
ds_read_b64_tr_b16 a[134:135], v19 offset:30496
v_mfma_f32_16x16x32_bf16 v[92:95], a[212:215], a[108:111], v[92:95]
ds_read_b64_tr_b16 a[136:137], v19 offset:28736
v_mfma_f32_16x16x32_bf16 v[40:43], a[188:191], a[104:107], v[40:43]
ds_read_b64_tr_b16 a[138:139], v19 offset:30528
ds_read_b64_tr_b16 a[140:141], v19 offset:28768
v_mfma_f32_16x16x32_bf16 v[44:47], a[188:191], a[108:111], v[44:47]
ds_read_b64_tr_b16 a[142:143], v19 offset:30560
v_mfma_f32_16x16x32_bf16 v[96:99], a[216:219], a[104:107], v[96:99]
ds_read_b64_tr_b16 a[144:145], v19 offset:28800
v_mfma_f32_16x16x32_bf16 v[100:103], a[216:219], a[108:111], v[100:103]
ds_read_b64_tr_b16 a[146:147], v19 offset:30592
v_mfma_f32_16x16x32_bf16 v[48:51], a[192:195], a[104:107], v[48:51]
ds_read_b64_tr_b16 a[148:149], v19 offset:28832
v_mfma_f32_16x16x32_bf16 v[52:55], a[192:195], a[108:111], v[52:55]
ds_read_b64_tr_b16 a[150:151], v19 offset:30624
ds_read_b64_tr_b16 a[152:153], v19 offset:28864
v_mfma_f32_16x16x32_bf16 v[104:107], a[220:223], a[104:107], v[104:107]
ds_read_b64_tr_b16 a[154:155], v19 offset:30656
v_mfma_f32_16x16x32_bf16 v[108:111], a[220:223], a[108:111], v[108:111]
ds_read_b64_tr_b16 a[156:157], v19 offset:43008
v_mfma_f32_16x16x32_bf16 v[56:59], a[196:199], a[104:107], v[56:59]
ds_read_b64_tr_b16 a[158:159], v19 offset:44800
v_mfma_f32_16x16x32_bf16 v[60:63], a[196:199], a[108:111], v[60:63]
ds_read_b64_tr_b16 a[160:161], v19 offset:43040
ds_read_b64_tr_b16 a[162:163], v19 offset:44832
v_mfma_f32_16x16x32_bf16 v[112:115], a[224:227], a[104:107], v[112:115]
ds_read_b64_tr_b16 a[164:165], v19 offset:43072
v_mfma_f32_16x16x32_bf16 v[116:119], a[224:227], a[108:111], v[116:119]
ds_read_b64_tr_b16 a[166:167], v19 offset:44864
v_mfma_f32_16x16x32_bf16 v[64:67], a[200:203], a[104:107], v[64:67]
ds_read_b64_tr_b16 a[168:169], v19 offset:43104
v_mfma_f32_16x16x32_bf16 v[68:71], a[200:203], a[108:111], v[68:71]
ds_read_b64_tr_b16 a[170:171], v19 offset:44896
v_mfma_f32_16x16x32_bf16 v[120:123], a[228:231], a[104:107], v[120:123]
ds_read_b64_tr_b16 a[172:173], v19 offset:43136
ds_read_b64_tr_b16 a[174:175], v19 offset:44928
v_mfma_f32_16x16x32_bf16 v[124:127], a[228:231], a[108:111], v[124:127]
ds_read_b64_tr_b16 a[176:177], v19 offset:43168
v_mfma_f32_16x16x32_bf16 v[72:75], a[204:207], a[104:107], v[72:75]
ds_read_b64_tr_b16 a[178:179], v19 offset:44960
v_mfma_f32_16x16x32_bf16 v[76:79], a[204:207], a[108:111], v[76:79]
ds_read_b64_tr_b16 a[180:181], v19 offset:43200
v_mfma_f32_16x16x32_bf16 v[128:131], a[232:235], a[104:107], v[128:131]
ds_read_b64_tr_b16 a[182:183], v19 offset:44992
v_mfma_f32_16x16x32_bf16 v[132:135], a[232:235], a[108:111], v[132:135]
v_mfma_f32_16x16x32_bf16 v[80:83], a[208:211], a[104:107], v[80:83]
v_mfma_f32_16x16x32_bf16 v[84:87], a[208:211], a[108:111], v[84:87]
v_mfma_f32_16x16x32_bf16 v[136:139], a[236:239], a[104:107], v[136:139]
v_mfma_f32_16x16x32_bf16 v[140:143], a[236:239], a[108:111], v[140:143]
s_waitcnt vmcnt(0)
s_waitcnt lgkmcnt(0)
v_mfma_f32_16x16x32_bf16 v[32:35], a[128:131], a[112:115], v[32:35]
ds_read_b64_tr_b16 a[184:185], v19 offset:35840
ds_read_b64_tr_b16 a[186:187], v19 offset:37632
v_mfma_f32_16x16x32_bf16 v[36:39], a[128:131], a[116:119], v[36:39]
ds_read_b64_tr_b16 a[188:189], v19 offset:35872
v_mfma_f32_16x16x32_bf16 v[88:91], a[156:159], a[112:115], v[88:91]
ds_read_b64_tr_b16 a[190:191], v19 offset:37664
v_mfma_f32_16x16x32_bf16 v[92:95], a[156:159], a[116:119], v[92:95]
ds_read_b64_tr_b16 a[192:193], v19 offset:35904
v_mfma_f32_16x16x32_bf16 v[40:43], a[132:135], a[112:115], v[40:43]
ds_read_b64_tr_b16 a[194:195], v19 offset:37696
ds_read_b64_tr_b16 a[196:197], v19 offset:35936
v_mfma_f32_16x16x32_bf16 v[44:47], a[132:135], a[116:119], v[44:47]
ds_read_b64_tr_b16 a[198:199], v19 offset:37728
v_mfma_f32_16x16x32_bf16 v[96:99], a[160:163], a[112:115], v[96:99]
ds_read_b64_tr_b16 a[200:201], v19 offset:35968
v_mfma_f32_16x16x32_bf16 v[100:103], a[160:163], a[116:119], v[100:103]
ds_read_b64_tr_b16 a[202:203], v19 offset:37760
v_mfma_f32_16x16x32_bf16 v[48:51], a[136:139], a[112:115], v[48:51]
ds_read_b64_tr_b16 a[204:205], v19 offset:36000
v_mfma_f32_16x16x32_bf16 v[52:55], a[136:139], a[116:119], v[52:55]
ds_read_b64_tr_b16 a[206:207], v19 offset:37792
ds_read_b64_tr_b16 a[208:209], v19 offset:36032
v_mfma_f32_16x16x32_bf16 v[104:107], a[164:167], a[112:115], v[104:107]
ds_read_b64_tr_b16 a[210:211], v19 offset:37824
v_mfma_f32_16x16x32_bf16 v[108:111], a[164:167], a[116:119], v[108:111]
ds_read_b64_tr_b16 a[212:213], v19 offset:50176
v_mfma_f32_16x16x32_bf16 v[56:59], a[140:143], a[112:115], v[56:59]
ds_read_b64_tr_b16 a[214:215], v19 offset:51968
v_mfma_f32_16x16x32_bf16 v[60:63], a[140:143], a[116:119], v[60:63]
ds_read_b64_tr_b16 a[216:217], v19 offset:50208
ds_read_b64_tr_b16 a[218:219], v19 offset:52000
v_mfma_f32_16x16x32_bf16 v[112:115], a[168:171], a[112:115], v[112:115]
ds_read_b64_tr_b16 a[220:221], v19 offset:50240
v_mfma_f32_16x16x32_bf16 v[116:119], a[168:171], a[116:119], v[116:119]
ds_read_b64_tr_b16 a[222:223], v19 offset:52032
v_mfma_f32_16x16x32_bf16 v[64:67], a[144:147], a[112:115], v[64:67]
ds_read_b64_tr_b16 a[224:225], v19 offset:50272
v_mfma_f32_16x16x32_bf16 v[68:71], a[144:147], a[116:119], v[68:71]
ds_read_b64_tr_b16 a[226:227], v19 offset:52064
v_mfma_f32_16x16x32_bf16 v[120:123], a[172:175], a[112:115], v[120:123]
ds_read_b64_tr_b16 a[228:229], v19 offset:50304
ds_read_b64_tr_b16 a[230:231], v19 offset:52096
v_mfma_f32_16x16x32_bf16 v[124:127], a[172:175], a[116:119], v[124:127]
ds_read_b64_tr_b16 a[232:233], v19 offset:50336
v_mfma_f32_16x16x32_bf16 v[72:75], a[148:151], a[112:115], v[72:75]
ds_read_b64_tr_b16 a[234:235], v19 offset:52128
v_mfma_f32_16x16x32_bf16 v[76:79], a[148:151], a[116:119], v[76:79]
ds_read_b64_tr_b16 a[236:237], v19 offset:50368
v_mfma_f32_16x16x32_bf16 v[128:131], a[176:179], a[112:115], v[128:131]
ds_read_b64_tr_b16 a[238:239], v19 offset:52160
v_mfma_f32_16x16x32_bf16 v[132:135], a[176:179], a[116:119], v[132:135]
v_mfma_f32_16x16x32_bf16 v[80:83], a[152:155], a[112:115], v[80:83]
v_mfma_f32_16x16x32_bf16 v[84:87], a[152:155], a[116:119], v[84:87]
v_mfma_f32_16x16x32_bf16 v[136:139], a[180:183], a[112:115], v[136:139]
v_mfma_f32_16x16x32_bf16 v[140:143], a[180:183], a[116:119], v[140:143]
s_waitcnt lgkmcnt(0)
v_mfma_f32_16x16x32_bf16 v[32:35], a[184:187], a[120:123], v[32:35]
v_mfma_f32_16x16x32_bf16 v[36:39], a[184:187], a[124:127], v[36:39]
v_mfma_f32_16x16x32_bf16 v[88:91], a[212:215], a[120:123], v[88:91]
v_mfma_f32_16x16x32_bf16 v[92:95], a[212:215], a[124:127], v[92:95]
v_mfma_f32_16x16x32_bf16 v[40:43], a[188:191], a[120:123], v[40:43]
v_mfma_f32_16x16x32_bf16 v[44:47], a[188:191], a[124:127], v[44:47]
v_mfma_f32_16x16x32_bf16 v[96:99], a[216:219], a[120:123], v[96:99]
v_mfma_f32_16x16x32_bf16 v[100:103], a[216:219], a[124:127], v[100:103]
v_mfma_f32_16x16x32_bf16 v[48:51], a[192:195], a[120:123], v[48:51]
v_mfma_f32_16x16x32_bf16 v[52:55], a[192:195], a[124:127], v[52:55]
v_mfma_f32_16x16x32_bf16 v[104:107], a[220:223], a[120:123], v[104:107]
v_mfma_f32_16x16x32_bf16 v[108:111], a[220:223], a[124:127], v[108:111]
v_mfma_f32_16x16x32_bf16 v[56:59], a[196:199], a[120:123], v[56:59]
v_mfma_f32_16x16x32_bf16 v[60:63], a[196:199], a[124:127], v[60:63]
v_mfma_f32_16x16x32_bf16 v[112:115], a[224:227], a[120:123], v[112:115]
v_mfma_f32_16x16x32_bf16 v[116:119], a[224:227], a[124:127], v[116:119]
v_mfma_f32_16x16x32_bf16 v[64:67], a[200:203], a[120:123], v[64:67]
v_mfma_f32_16x16x32_bf16 v[68:71], a[200:203], a[124:127], v[68:71]
v_mfma_f32_16x16x32_bf16 v[120:123], a[228:231], a[120:123], v[120:123]
v_mfma_f32_16x16x32_bf16 v[124:127], a[228:231], a[124:127], v[124:127]
v_mfma_f32_16x16x32_bf16 v[72:75], a[204:207], a[120:123], v[72:75]
v_mfma_f32_16x16x32_bf16 v[76:79], a[204:207], a[124:127], v[76:79]
v_mfma_f32_16x16x32_bf16 v[128:131], a[232:235], a[120:123], v[128:131]
v_mfma_f32_16x16x32_bf16 v[132:135], a[232:235], a[124:127], v[132:135]
v_mfma_f32_16x16x32_bf16 v[80:83], a[208:211], a[120:123], v[80:83]
v_mfma_f32_16x16x32_bf16 v[84:87], a[208:211], a[124:127], v[84:87]
v_mfma_f32_16x16x32_bf16 v[136:139], a[236:239], a[120:123], v[136:139]
v_mfma_f32_16x16x32_bf16 v[140:143], a[236:239], a[124:127], v[140:143]
s_load_dwordx2 s[54:55], s[0:1], 64
v_lshrrev_b32 v3, 5, v2
v_and_b32 v4, 31, v2
v_lshlrev_b32 v4, 4, v4
v_lshl_add_u32 v3, v3, 10, v4
s_lshr_b32 s31, s2, 3
s_mul_i32 s31, s31, 56
s_mul_i32 s32, s28, 14
s_add_u32 s31, s31, s32
s_lshl_b32 s31, s31, 10
s_bfe_u32 s32, s2, 0x10001
s_lshl_b32 s32, s32, 9
s_add_u32 s31, s31, s32
s_waitcnt lgkmcnt(0)
s_mov_b32 s60, s54
s_and_b32 s61, s55, 0xffff
s_mov_b32 s62, 1835008
s_mov_b32 s63, 0x00020000
buffer_load_dwordx4 v[4:7], v3, s[60:63], s31 offen
s_add_u32 s31, s31, 2048
buffer_load_dwordx4 v[4:7], v3, s[60:63], s31 offen
s_add_u32 s31, s31, 2048
buffer_load_dwordx4 v[4:7], v3, s[60:63], s31 offen
s_add_u32 s31, s31, 2048
buffer_load_dwordx4 v[4:7], v3, s[60:63], s31 offen
s_add_u32 s31, s31, 2048
buffer_load_dwordx4 v[4:7], v3, s[60:63], s31 offen
s_add_u32 s31, s31, 2048
buffer_load_dwordx4 v[4:7], v3, s[60:63], s31 offen
s_add_u32 s31, s31, 2048
buffer_load_dwordx4 v[4:7], v3, s[60:63], s31 offen
s_add_u32 s31, s31, 2048
s_getpc_b64 s[48:49]
cpf_ffn1:
s_add_u32 s48, s48, down_kernel-cpf_ffn1
s_addc_u32 s49, s49, (down_kernel-cpf_ffn1)>>31
s_lshr_b32 s50, s2, 3
s_mul_i32 s50, s50, 4096
v_lshrrev_b32 v8, 6, v0
v_mul_u32_u24 v8, 0, v8
v_lshl_add_u32 v8, v0, 4, v8
v_add_u32 v8, s50, v8
v_min_u32 v9, code_end-down_kernel-16, v8
global_load_dwordx4 v[4:7], v9, s[48:49]
s_nop 7
s_mov_b32 s44, 0xc0135761
s_mov_b32 s45, 0xbdd2d3e8
s_lshl_b32 s31, s29, 3
s_lshl_b32 s32, s28, 1
s_add_u32 s31, s31, s32
s_mul_i32 s40, s31, 57344
s_mul_i32 s32, s30, 3584
s_and_b32 s46, s30, 1
s_lshl_b32 s47, s46, 9
s_sub_u32 s32, s32, s47
s_add_u32 s40, s40, s32
s_add_u32 s41, s40, 57344
v_mov_b32 v199, s44
v_mul_f32 v200, v32, v32
v_mul_f32 v201, v33, v33
v_mul_f32 v202, v34, v34
v_mul_f32 v203, v35, v35
v_fma_f32 v200, s45, v200, v199
v_fma_f32 v201, s45, v201, v199
v_fma_f32 v202, s45, v202, v199
v_fma_f32 v203, s45, v203, v199
v_mul_f32 v200, v200, v32
v_mul_f32 v201, v201, v33
v_mul_f32 v202, v202, v34
v_mul_f32 v203, v203, v35
v_exp_f32 v200, v200
v_exp_f32 v201, v201
v_exp_f32 v202, v202
v_exp_f32 v203, v203
v_mul_f32 v32, v32, v88
v_mul_f32 v33, v33, v89
v_mul_f32 v34, v34, v90
v_mul_f32 v35, v35, v91
v_add_f32 v200, 1.0, v200
v_add_f32 v201, 1.0, v201
v_add_f32 v202, 1.0, v202
v_add_f32 v203, 1.0, v203
v_rcp_f32 v200, v200
v_rcp_f32 v201, v201
v_rcp_f32 v202, v202
v_rcp_f32 v203, v203
s_nop 0
v_mul_f32 v32, v32, v200
v_mul_f32 v33, v33, v201
v_mul_f32 v34, v34, v202
v_mul_f32 v35, v35, v203
v_cvt_pk_bf16_f32 v150, v32, v33
v_cvt_pk_bf16_f32 v151, v34, v35
v_mul_f32 v208, v36, v36
v_mul_f32 v209, v37, v37
v_mul_f32 v210, v38, v38
v_mul_f32 v211, v39, v39
v_fma_f32 v208, s45, v208, v199
v_fma_f32 v209, s45, v209, v199
v_fma_f32 v210, s45, v210, v199
v_fma_f32 v211, s45, v211, v199
v_mul_f32 v208, v208, v36
v_mul_f32 v209, v209, v37
v_mul_f32 v210, v210, v38
v_mul_f32 v211, v211, v39
v_exp_f32 v208, v208
v_exp_f32 v209, v209
v_exp_f32 v210, v210
v_exp_f32 v211, v211
v_mul_f32 v36, v36, v92
v_mul_f32 v37, v37, v93
v_mul_f32 v38, v38, v94
v_mul_f32 v39, v39, v95
v_add_f32 v208, 1.0, v208
v_add_f32 v209, 1.0, v209
v_add_f32 v210, 1.0, v210
v_add_f32 v211, 1.0, v211
v_rcp_f32 v208, v208
v_rcp_f32 v209, v209
v_rcp_f32 v210, v210
v_rcp_f32 v211, v211
s_nop 0
v_mul_f32 v36, v36, v208
v_mul_f32 v37, v37, v209
v_mul_f32 v38, v38, v210
v_mul_f32 v39, v39, v211
v_cvt_pk_bf16_f32 v164, v36, v37
v_cvt_pk_bf16_f32 v165, v38, v39
v_mul_f32 v200, v40, v40
v_mul_f32 v201, v41, v41
v_mul_f32 v202, v42, v42
v_mul_f32 v203, v43, v43
v_fma_f32 v200, s45, v200, v199
v_fma_f32 v201, s45, v201, v199
v_fma_f32 v202, s45, v202, v199
v_fma_f32 v203, s45, v203, v199
v_mul_f32 v200, v200, v40
v_mul_f32 v201, v201, v41
v_mul_f32 v202, v202, v42
v_mul_f32 v203, v203, v43
v_exp_f32 v200, v200
v_exp_f32 v201, v201
v_exp_f32 v202, v202
v_exp_f32 v203, v203
v_mul_f32 v40, v40, v96
v_mul_f32 v41, v41, v97
v_mul_f32 v42, v42, v98
v_mul_f32 v43, v43, v99
v_add_f32 v200, 1.0, v200
v_add_f32 v201, 1.0, v201
v_add_f32 v202, 1.0, v202
v_add_f32 v203, 1.0, v203
v_rcp_f32 v200, v200
v_rcp_f32 v201, v201
v_rcp_f32 v202, v202
v_rcp_f32 v203, v203
s_nop 0
v_mul_f32 v40, v40, v200
v_mul_f32 v41, v41, v201
v_mul_f32 v42, v42, v202
v_mul_f32 v43, v43, v203
v_cvt_pk_bf16_f32 v152, v40, v41
v_cvt_pk_bf16_f32 v153, v42, v43
v_mul_f32 v208, v44, v44
v_mul_f32 v209, v45, v45
v_mul_f32 v210, v46, v46
v_mul_f32 v211, v47, v47
v_fma_f32 v208, s45, v208, v199
v_fma_f32 v209, s45, v209, v199
v_fma_f32 v210, s45, v210, v199
v_fma_f32 v211, s45, v211, v199
v_mul_f32 v208, v208, v44
v_mul_f32 v209, v209, v45
v_mul_f32 v210, v210, v46
v_mul_f32 v211, v211, v47
v_exp_f32 v208, v208
v_exp_f32 v209, v209
v_exp_f32 v210, v210
v_exp_f32 v211, v211
v_mul_f32 v44, v44, v100
v_mul_f32 v45, v45, v101
v_mul_f32 v46, v46, v102
v_mul_f32 v47, v47, v103
v_add_f32 v208, 1.0, v208
v_add_f32 v209, 1.0, v209
v_add_f32 v210, 1.0, v210
v_add_f32 v211, 1.0, v211
v_rcp_f32 v208, v208
v_rcp_f32 v209, v209
v_rcp_f32 v210, v210
v_rcp_f32 v211, v211
s_nop 0
v_mul_f32 v44, v44, v208
v_mul_f32 v45, v45, v209
v_mul_f32 v46, v46, v210
v_mul_f32 v47, v47, v211
v_cvt_pk_bf16_f32 v166, v44, v45
v_cvt_pk_bf16_f32 v167, v46, v47
v_mul_f32 v200, v48, v48
v_mul_f32 v201, v49, v49
v_mul_f32 v202, v50, v50
v_mul_f32 v203, v51, v51
v_fma_f32 v200, s45, v200, v199
v_fma_f32 v201, s45, v201, v199
v_fma_f32 v202, s45, v202, v199
v_fma_f32 v203, s45, v203, v199
v_mul_f32 v200, v200, v48
v_mul_f32 v201, v201, v49
v_mul_f32 v202, v202, v50
v_mul_f32 v203, v203, v51
v_exp_f32 v200, v200
v_exp_f32 v201, v201
v_exp_f32 v202, v202
v_exp_f32 v203, v203
v_mul_f32 v48, v48, v104
v_mul_f32 v49, v49, v105
v_mul_f32 v50, v50, v106
v_mul_f32 v51, v51, v107
v_add_f32 v200, 1.0, v200
v_add_f32 v201, 1.0, v201
v_add_f32 v202, 1.0, v202
v_add_f32 v203, 1.0, v203
v_rcp_f32 v200, v200
v_rcp_f32 v201, v201
v_rcp_f32 v202, v202
v_rcp_f32 v203, v203
s_nop 0
v_mul_f32 v48, v48, v200
v_mul_f32 v49, v49, v201
v_mul_f32 v50, v50, v202
v_mul_f32 v51, v51, v203
v_cvt_pk_bf16_f32 v154, v48, v49
v_cvt_pk_bf16_f32 v155, v50, v51
v_mul_f32 v208, v52, v52
v_mul_f32 v209, v53, v53
v_mul_f32 v210, v54, v54
v_mul_f32 v211, v55, v55
v_fma_f32 v208, s45, v208, v199
v_fma_f32 v209, s45, v209, v199
v_fma_f32 v210, s45, v210, v199
v_fma_f32 v211, s45, v211, v199
v_mul_f32 v208, v208, v52
v_mul_f32 v209, v209, v53
v_mul_f32 v210, v210, v54
v_mul_f32 v211, v211, v55
v_exp_f32 v208, v208
v_exp_f32 v209, v209
v_exp_f32 v210, v210
v_exp_f32 v211, v211
v_mul_f32 v52, v52, v108
v_mul_f32 v53, v53, v109
v_mul_f32 v54, v54, v110
v_mul_f32 v55, v55, v111
v_add_f32 v208, 1.0, v208
v_add_f32 v209, 1.0, v209
v_add_f32 v210, 1.0, v210
v_add_f32 v211, 1.0, v211
v_rcp_f32 v208, v208
v_rcp_f32 v209, v209
v_rcp_f32 v210, v210
v_rcp_f32 v211, v211
s_nop 0
v_mul_f32 v52, v52, v208
v_mul_f32 v53, v53, v209
v_mul_f32 v54, v54, v210
v_mul_f32 v55, v55, v211
v_cvt_pk_bf16_f32 v168, v52, v53
v_cvt_pk_bf16_f32 v169, v54, v55
v_mul_f32 v200, v56, v56
v_mul_f32 v201, v57, v57
v_mul_f32 v202, v58, v58
v_mul_f32 v203, v59, v59
v_fma_f32 v200, s45, v200, v199
v_fma_f32 v201, s45, v201, v199
v_fma_f32 v202, s45, v202, v199
v_fma_f32 v203, s45, v203, v199
v_mul_f32 v200, v200, v56
v_mul_f32 v201, v201, v57
v_mul_f32 v202, v202, v58
v_mul_f32 v203, v203, v59
v_exp_f32 v200, v200
v_exp_f32 v201, v201
v_exp_f32 v202, v202
v_exp_f32 v203, v203
v_mul_f32 v56, v56, v112
v_mul_f32 v57, v57, v113
v_mul_f32 v58, v58, v114
v_mul_f32 v59, v59, v115
v_add_f32 v200, 1.0, v200
v_add_f32 v201, 1.0, v201
v_add_f32 v202, 1.0, v202
v_add_f32 v203, 1.0, v203
v_rcp_f32 v200, v200
v_rcp_f32 v201, v201
v_rcp_f32 v202, v202
v_rcp_f32 v203, v203
s_nop 0
v_mul_f32 v56, v56, v200
v_mul_f32 v57, v57, v201
v_mul_f32 v58, v58, v202
v_mul_f32 v59, v59, v203
v_cvt_pk_bf16_f32 v156, v56, v57
v_cvt_pk_bf16_f32 v157, v58, v59
v_mul_f32 v208, v60, v60
v_mul_f32 v209, v61, v61
v_mul_f32 v210, v62, v62
v_mul_f32 v211, v63, v63
v_fma_f32 v208, s45, v208, v199
v_fma_f32 v209, s45, v209, v199
v_fma_f32 v210, s45, v210, v199
v_fma_f32 v211, s45, v211, v199
v_mul_f32 v208, v208, v60
v_mul_f32 v209, v209, v61
v_mul_f32 v210, v210, v62
v_mul_f32 v211, v211, v63
v_exp_f32 v208, v208
v_exp_f32 v209, v209
v_exp_f32 v210, v210
v_exp_f32 v211, v211
v_mul_f32 v60, v60, v116
v_mul_f32 v61, v61, v117
v_mul_f32 v62, v62, v118
v_mul_f32 v63, v63, v119
v_add_f32 v208, 1.0, v208
v_add_f32 v209, 1.0, v209
v_add_f32 v210, 1.0, v210
v_add_f32 v211, 1.0, v211
v_rcp_f32 v208, v208
v_rcp_f32 v209, v209
v_rcp_f32 v210, v210
v_rcp_f32 v211, v211
s_nop 0
v_mul_f32 v60, v60, v208
v_mul_f32 v61, v61, v209
v_mul_f32 v62, v62, v210
v_mul_f32 v63, v63, v211
v_cvt_pk_bf16_f32 v170, v60, v61
v_cvt_pk_bf16_f32 v171, v62, v63
v_mul_f32 v200, v64, v64
v_mul_f32 v201, v65, v65
v_mul_f32 v202, v66, v66
v_mul_f32 v203, v67, v67
v_fma_f32 v200, s45, v200, v199
v_fma_f32 v201, s45, v201, v199
v_fma_f32 v202, s45, v202, v199
v_fma_f32 v203, s45, v203, v199
v_mul_f32 v200, v200, v64
v_mul_f32 v201, v201, v65
v_mul_f32 v202, v202, v66
v_mul_f32 v203, v203, v67
v_exp_f32 v200, v200
v_exp_f32 v201, v201
v_exp_f32 v202, v202
v_exp_f32 v203, v203
v_mul_f32 v64, v64, v120
v_mul_f32 v65, v65, v121
v_mul_f32 v66, v66, v122
v_mul_f32 v67, v67, v123
v_add_f32 v200, 1.0, v200
v_add_f32 v201, 1.0, v201
v_add_f32 v202, 1.0, v202
v_add_f32 v203, 1.0, v203
v_rcp_f32 v200, v200
v_rcp_f32 v201, v201
v_rcp_f32 v202, v202
v_rcp_f32 v203, v203
s_nop 0
v_mul_f32 v64, v64, v200
v_mul_f32 v65, v65, v201
v_mul_f32 v66, v66, v202
v_mul_f32 v67, v67, v203
v_cvt_pk_bf16_f32 v158, v64, v65
v_cvt_pk_bf16_f32 v159, v66, v67
v_mul_f32 v208, v68, v68
v_mul_f32 v209, v69, v69
v_mul_f32 v210, v70, v70
v_mul_f32 v211, v71, v71
v_fma_f32 v208, s45, v208, v199
v_fma_f32 v209, s45, v209, v199
v_fma_f32 v210, s45, v210, v199
v_fma_f32 v211, s45, v211, v199
v_mul_f32 v208, v208, v68
v_mul_f32 v209, v209, v69
v_mul_f32 v210, v210, v70
v_mul_f32 v211, v211, v71
v_exp_f32 v208, v208
v_exp_f32 v209, v209
v_exp_f32 v210, v210
v_exp_f32 v211, v211
v_mul_f32 v68, v68, v124
v_mul_f32 v69, v69, v125
v_mul_f32 v70, v70, v126
v_mul_f32 v71, v71, v127
v_add_f32 v208, 1.0, v208
v_add_f32 v209, 1.0, v209
v_add_f32 v210, 1.0, v210
v_add_f32 v211, 1.0, v211
v_rcp_f32 v208, v208
v_rcp_f32 v209, v209
v_rcp_f32 v210, v210
v_rcp_f32 v211, v211
s_nop 0
v_mul_f32 v68, v68, v208
v_mul_f32 v69, v69, v209
v_mul_f32 v70, v70, v210
v_mul_f32 v71, v71, v211
v_cvt_pk_bf16_f32 v172, v68, v69
v_cvt_pk_bf16_f32 v173, v70, v71
v_mul_f32 v200, v72, v72
v_mul_f32 v201, v73, v73
v_mul_f32 v202, v74, v74
v_mul_f32 v203, v75, v75
v_fma_f32 v200, s45, v200, v199
v_fma_f32 v201, s45, v201, v199
v_fma_f32 v202, s45, v202, v199
v_fma_f32 v203, s45, v203, v199
v_mul_f32 v200, v200, v72
v_mul_f32 v201, v201, v73
v_mul_f32 v202, v202, v74
v_mul_f32 v203, v203, v75
v_exp_f32 v200, v200
v_exp_f32 v201, v201
v_exp_f32 v202, v202
v_exp_f32 v203, v203
v_mul_f32 v72, v72, v128
v_mul_f32 v73, v73, v129
v_mul_f32 v74, v74, v130
v_mul_f32 v75, v75, v131
v_add_f32 v200, 1.0, v200
v_add_f32 v201, 1.0, v201
v_add_f32 v202, 1.0, v202
v_add_f32 v203, 1.0, v203
v_rcp_f32 v200, v200
v_rcp_f32 v201, v201
v_rcp_f32 v202, v202
v_rcp_f32 v203, v203
s_nop 0
v_mul_f32 v72, v72, v200
v_mul_f32 v73, v73, v201
v_mul_f32 v74, v74, v202
v_mul_f32 v75, v75, v203
v_cvt_pk_bf16_f32 v160, v72, v73
v_cvt_pk_bf16_f32 v161, v74, v75
v_mul_f32 v208, v76, v76
v_mul_f32 v209, v77, v77
v_mul_f32 v210, v78, v78
v_mul_f32 v211, v79, v79
v_fma_f32 v208, s45, v208, v199
v_fma_f32 v209, s45, v209, v199
v_fma_f32 v210, s45, v210, v199
v_fma_f32 v211, s45, v211, v199
v_mul_f32 v208, v208, v76
v_mul_f32 v209, v209, v77
v_mul_f32 v210, v210, v78
v_mul_f32 v211, v211, v79
v_exp_f32 v208, v208
v_exp_f32 v209, v209
v_exp_f32 v210, v210
v_exp_f32 v211, v211
v_mul_f32 v76, v76, v132
v_mul_f32 v77, v77, v133
v_mul_f32 v78, v78, v134
v_mul_f32 v79, v79, v135
v_add_f32 v208, 1.0, v208
v_add_f32 v209, 1.0, v209
v_add_f32 v210, 1.0, v210
v_add_f32 v211, 1.0, v211
v_rcp_f32 v208, v208
v_rcp_f32 v209, v209
v_rcp_f32 v210, v210
v_rcp_f32 v211, v211
s_nop 0
v_mul_f32 v76, v76, v208
v_mul_f32 v77, v77, v209
v_mul_f32 v78, v78, v210
v_mul_f32 v79, v79, v211
v_cvt_pk_bf16_f32 v174, v76, v77
v_cvt_pk_bf16_f32 v175, v78, v79
v_mul_f32 v200, v80, v80
v_mul_f32 v201, v81, v81
v_mul_f32 v202, v82, v82
v_mul_f32 v203, v83, v83
v_fma_f32 v200, s45, v200, v199
v_fma_f32 v201, s45, v201, v199
v_fma_f32 v202, s45, v202, v199
v_fma_f32 v203, s45, v203, v199
v_mul_f32 v200, v200, v80
v_mul_f32 v201, v201, v81
v_mul_f32 v202, v202, v82
v_mul_f32 v203, v203, v83
v_exp_f32 v200, v200
v_exp_f32 v201, v201
v_exp_f32 v202, v202
v_exp_f32 v203, v203
v_mul_f32 v80, v80, v136
v_mul_f32 v81, v81, v137
v_mul_f32 v82, v82, v138
v_mul_f32 v83, v83, v139
v_add_f32 v200, 1.0, v200
v_add_f32 v201, 1.0, v201
v_add_f32 v202, 1.0, v202
v_add_f32 v203, 1.0, v203
v_rcp_f32 v200, v200
v_rcp_f32 v201, v201
v_rcp_f32 v202, v202
v_rcp_f32 v203, v203
s_nop 0
v_mul_f32 v80, v80, v200
v_mul_f32 v81, v81, v201
v_mul_f32 v82, v82, v202
v_mul_f32 v83, v83, v203
v_cvt_pk_bf16_f32 v162, v80, v81
v_cvt_pk_bf16_f32 v163, v82, v83
v_mul_f32 v208, v84, v84
v_mul_f32 v209, v85, v85
v_mul_f32 v210, v86, v86
v_mul_f32 v211, v87, v87
v_fma_f32 v208, s45, v208, v199
v_fma_f32 v209, s45, v209, v199
v_fma_f32 v210, s45, v210, v199
v_fma_f32 v211, s45, v211, v199
v_mul_f32 v208, v208, v84
v_mul_f32 v209, v209, v85
v_mul_f32 v210, v210, v86
v_mul_f32 v211, v211, v87
v_exp_f32 v208, v208
v_exp_f32 v209, v209
v_exp_f32 v210, v210
v_exp_f32 v211, v211
v_mul_f32 v84, v84, v140
v_mul_f32 v85, v85, v141
v_mul_f32 v86, v86, v142
v_mul_f32 v87, v87, v143
v_add_f32 v208, 1.0, v208
v_add_f32 v209, 1.0, v209
v_add_f32 v210, 1.0, v210
v_add_f32 v211, 1.0, v211
v_rcp_f32 v208, v208
v_rcp_f32 v209, v209
v_rcp_f32 v210, v210
v_rcp_f32 v211, v211
s_nop 0
v_mul_f32 v84, v84, v208
v_mul_f32 v85, v85, v209
v_mul_f32 v86, v86, v210
v_mul_f32 v87, v87, v211
v_cvt_pk_bf16_f32 v176, v84, v85
v_cvt_pk_bf16_f32 v177, v86, v87
s_cmp_eq_u32 s46, 0
s_cbranch_scc0 ffn1_kernel_odd
buffer_store_dwordx4 v[150:153], v17, s[20:23], s40 offen offset:0
buffer_store_dwordx4 v[154:157], v17, s[20:23], s40 offen offset:1024
buffer_store_dwordx4 v[158:161], v17, s[20:23], s40 offen offset:2048
buffer_store_dwordx2 v[162:163], v17, s[20:23], s40 offen offset:3072
buffer_store_dwordx4 v[164:167], v17, s[20:23], s41 offen offset:0
buffer_store_dwordx4 v[168:171], v17, s[20:23], s41 offen offset:1024
buffer_store_dwordx4 v[172:175], v17, s[20:23], s41 offen offset:2048
buffer_store_dwordx2 v[176:177], v17, s[20:23], s41 offen offset:3072
s_branch ffn1_kernel_fin
ffn1_kernel_odd:
buffer_store_dwordx2 v[150:151], v17, s[20:23], s40 offen offset:8
buffer_store_dwordx4 v[152:155], v17, s[20:23], s40 offen offset:1024
buffer_store_dwordx4 v[156:159], v17, s[20:23], s40 offen offset:2048
buffer_store_dwordx4 v[160:163], v17, s[20:23], s40 offen offset:3072
buffer_store_dwordx2 v[164:165], v17, s[20:23], s41 offen offset:8
buffer_store_dwordx4 v[166:169], v17, s[20:23], s41 offen offset:1024
buffer_store_dwordx4 v[170:173], v17, s[20:23], s41 offen offset:2048
buffer_store_dwordx4 v[174:177], v17, s[20:23], s41 offen offset:3072
ffn1_kernel_fin:
ffn1_kernel_done:
s_endpgm
.globl down_kernel
.p2align 8
.type down_kernel,@function
down_kernel:
s_cmp_ge_u32 s2, 256
s_cbranch_scc1 down_kernel_done
s_load_dwordx2 s[48:49], s[0:1], 64
s_load_dwordx2 s[50:51], s[0:1], 104
s_load_dwordx2 s[54:55], s[0:1], 88
v_lshrrev_b32 v1, 6, v0
v_and_b32 v2, 63, v0
v_readfirstlane_b32 s28, v1
s_and_b32 s31, s2, 1
s_lshl_b32 s29, s31, 4
s_bfe_u32 s31, s2, 0x10002
s_lshl_b32 s31, s31, 3
s_add_u32 s29, s29, s31
s_lshr_b32 s32, s2, 3
s_and_b32 s31, s32, 7
s_add_u32 s29, s29, s31
s_lshr_b32 s30, s32, 3
s_bfe_u32 s31, s2, 0x10001
s_lshl_b32 s31, s31, 2
s_add_u32 s30, s30, s31
s_lshl_b32 s33, s28, 15
v_lshrrev_b32 v3, 3, v2
v_and_b32 v4, 7, v2
v_lshrrev_b32 v5, 1, v3
v_and_b32 v5, 3, v5
v_lshlrev_b32 v5, 1, v5
v_xor_b32 v4, v4, v5
v_lshlrev_b32 v3, 10, v3
v_lshl_add_u32 v10, v4, 4, v3
s_lshl_b32 s31, s30, 7
v_add_u32 v10, s31, v10
v_lshlrev_b32 v11, 4, v2
s_mul_i32 s38, s28, 458752
s_mul_i32 s31, s29, 229376
s_mul_i32 s32, s28, 14336
s_add_u32 s34, s31, s32
s_add_u32 s35, s34, 57344
s_add_u32 s36, s35, 57344
s_add_u32 s37, s36, 57344
v_lshrrev_b32 v3, 4, v2
v_and_b32 v4, 15, v2
v_lshrrev_b32 v5, 2, v4
v_and_b32 v6, 3, v2
v_lshl_add_u32 v7, v3, 2, v5
v_lshrrev_b32 v8, 1, v7
v_and_b32 v8, 3, v8
v_lshlrev_b32 v7, 7, v7
v_lshl_add_u32 v7, v6, 3, v7
v_add_u32 v7, s33, v7
v_xor_b32 v9, 0, v8
v_lshl_add_u32 v12, v9, 5, v7
v_xor_b32 v9, 1, v8
v_lshl_add_u32 v13, v9, 5, v7
v_xor_b32 v9, 2, v8
v_lshl_add_u32 v14, v9, 5, v7
v_xor_b32 v9, 3, v8
v_lshl_add_u32 v15, v9, 5, v7
s_waitcnt lgkmcnt(0)
s_mov_b32 s8, s48
s_and_b32 s9, s49, 0xffff
s_mov_b32 s10, 1835008
s_mov_b32 s11, 0x00020000
s_add_u32 s12, s50, 25165824
s_addc_u32 s13, s51, 0
s_and_b32 s13, s13, 0xffff
s_mov_b32 s14, 7340032
s_mov_b32 s15, 0x00020000
s_add_u32 s16, s50, 20971520
s_addc_u32 s17, s51, 0
s_and_b32 s17, s17, 0xffff
s_mov_b32 s18, 2097152
s_mov_b32 s19, 0x00020000
s_add_u32 s20, s50, 5120
s_addc_u32 s21, s51, 0
s_and_b32 s21, s21, 0xffff
s_mov_b32 s22, 1024
s_mov_b32 s23, 0x00020000
s_mov_b32 s24, s54
s_and_b32 s25, s55, 0xffff
s_mov_b32 s26, 2097152
s_mov_b32 s27, 0x00020000
s_add_u32 m0, s33, 0
s_add_u32 s31, s38, 0
buffer_load_dwordx4 v10, s[8:11], s31 offen lds
s_add_u32 m0, s33, 1024
s_add_u32 s31, s38, 8192
buffer_load_dwordx4 v10, s[8:11], s31 offen lds
s_add_u32 m0, s33, 2048
s_add_u32 s31, s38, 16384
buffer_load_dwordx4 v10, s[8:11], s31 offen lds
s_add_u32 m0, s33, 3072
s_add_u32 s31, s38, 24576
buffer_load_dwordx4 v10, s[8:11], s31 offen lds
s_add_u32 s32, s34, 0
buffer_load_dwordx4 a[0:3], v11, s[12:15], s32 offen
s_add_u32 s32, s35, 0
buffer_load_dwordx4 a[4:7], v11, s[12:15], s32 offen
s_add_u32 s32, s36, 0
buffer_load_dwordx4 a[8:11], v11, s[12:15], s32 offen
s_add_u32 s32, s37, 0
buffer_load_dwordx4 a[12:15], v11, s[12:15], s32 offen
s_add_u32 m0, s33, 4096
s_add_u32 s31, s38, 32768
buffer_load_dwordx4 v10, s[8:11], s31 offen lds
s_add_u32 m0, s33, 5120
s_add_u32 s31, s38, 40960
buffer_load_dwordx4 v10, s[8:11], s31 offen lds
s_add_u32 m0, s33, 6144
s_add_u32 s31, s38, 49152
buffer_load_dwordx4 v10, s[8:11], s31 offen lds
s_add_u32 m0, s33, 7168
s_add_u32 s31, s38, 57344
buffer_load_dwordx4 v10, s[8:11], s31 offen lds
s_add_u32 s32, s34, 1024
buffer_load_dwordx4 a[16:19], v11, s[12:15], s32 offen
s_add_u32 s32, s35, 1024
buffer_load_dwordx4 a[20:23], v11, s[12:15], s32 offen
s_add_u32 s32, s36, 1024
buffer_load_dwordx4 a[24:27], v11, s[12:15], s32 offen
s_add_u32 s32, s37, 1024
buffer_load_dwordx4 a[28:31], v11, s[12:15], s32 offen
v_lshrrev_b32 v16, 2, v0
v_and_b32 v17, 3, v0
v_lshlrev_b32 v18, 5, v17
s_lshl_b32 s31, s30, 7
v_add_u32 v18, s31, v18
v_lshl_add_u32 v19, v16, 10, v18
s_waitcnt vmcnt(12)
ds_read_b64_tr_b16 a[128:129], v12 offset:0
ds_read_b64_tr_b16 a[130:131], v12 offset:2048
ds_read_b64_tr_b16 a[132:133], v13 offset:0
ds_read_b64_tr_b16 a[134:135], v13 offset:2048
ds_read_b64_tr_b16 a[136:137], v14 offset:0
ds_read_b64_tr_b16 a[138:139], v14 offset:2048
ds_read_b64_tr_b16 a[140:141], v15 offset:0
ds_read_b64_tr_b16 a[142:143], v15 offset:2048
s_waitcnt vmcnt(4)
s_waitcnt lgkmcnt(0)
v_mfma_f32_16x16x32_bf16 v[32:35], a[128:131], a[0:3], 0
ds_read_b64_tr_b16 a[144:145], v12 offset:4096
s_add_u32 m0, s33, 8192
s_add_u32 s31, s38, 65536
v_mfma_f32_16x16x32_bf16 v[36:39], a[128:131], a[4:7], 0
buffer_load_dwordx4 v10, s[8:11], s31 offen lds
v_mfma_f32_16x16x32_bf16 v[40:43], a[128:131], a[8:11], 0
ds_read_b64_tr_b16 a[146:147], v12 offset:6144
s_add_u32 m0, s33, 9216
s_add_u32 s31, s38, 73728
v_mfma_f32_16x16x32_bf16 v[44:47], a[128:131], a[12:15], 0
ds_read_b64_tr_b16 a[148:149], v13 offset:4096
v_mfma_f32_16x16x32_bf16 v[48:51], a[132:135], a[0:3], 0
buffer_load_dwordx4 v10, s[8:11], s31 offen lds
v_mfma_f32_16x16x32_bf16 v[52:55], a[132:135], a[4:7], 0
ds_read_b64_tr_b16 a[150:151], v13 offset:6144
s_add_u32 m0, s33, 10240
s_add_u32 s31, s38, 81920
v_mfma_f32_16x16x32_bf16 v[56:59], a[132:135], a[8:11], 0
buffer_load_dwordx4 v10, s[8:11], s31 offen lds
v_mfma_f32_16x16x32_bf16 v[60:63], a[132:135], a[12:15], 0
ds_read_b64_tr_b16 a[152:153], v14 offset:4096
s_add_u32 m0, s33, 11264
s_add_u32 s31, s38, 90112
v_mfma_f32_16x16x32_bf16 v[64:67], a[136:139], a[0:3], 0
buffer_load_dwordx4 v10, s[8:11], s31 offen lds
v_mfma_f32_16x16x32_bf16 v[68:71], a[136:139], a[4:7], 0
ds_read_b64_tr_b16 a[154:155], v14 offset:6144
s_add_u32 s32, s34, 2048
v_mfma_f32_16x16x32_bf16 v[72:75], a[136:139], a[8:11], 0
ds_read_b64_tr_b16 a[156:157], v15 offset:4096
ds_read_b64_tr_b16 a[158:159], v15 offset:6144
v_mfma_f32_16x16x32_bf16 v[76:79], a[136:139], a[12:15], 0
buffer_load_dwordx4 a[32:35], v11, s[12:15], s32 offen
v_mfma_f32_16x16x32_bf16 v[80:83], a[140:143], a[0:3], 0
s_add_u32 s32, s35, 2048
v_mfma_f32_16x16x32_bf16 v[84:87], a[140:143], a[4:7], 0
buffer_load_dwordx4 a[36:39], v11, s[12:15], s32 offen
v_mfma_f32_16x16x32_bf16 v[88:91], a[140:143], a[8:11], 0
s_add_u32 s32, s36, 2048
v_mfma_f32_16x16x32_bf16 v[92:95], a[140:143], a[12:15], 0
buffer_load_dwordx4 a[40:43], v11, s[12:15], s32 offen
s_add_u32 s32, s37, 2048
buffer_load_dwordx4 a[44:47], v11, s[12:15], s32 offen
s_add_u32 m0, s33, 12288
s_add_u32 s31, s38, 98304
buffer_load_dwordx4 v10, s[8:11], s31 offen lds
s_add_u32 m0, s33, 13312
s_add_u32 s31, s38, 106496
buffer_load_dwordx4 v10, s[8:11], s31 offen lds
s_waitcnt vmcnt(6)
s_waitcnt lgkmcnt(0)
v_mfma_f32_16x16x32_bf16 v[32:35], a[144:147], a[16:19], v[32:35]
ds_read_b64_tr_b16 a[128:129], v12 offset:8192
s_add_u32 m0, s33, 14336
s_add_u32 s31, s38, 114688
v_mfma_f32_16x16x32_bf16 v[36:39], a[144:147], a[20:23], v[36:39]
buffer_load_dwordx4 v10, s[8:11], s31 offen lds
v_mfma_f32_16x16x32_bf16 v[40:43], a[144:147], a[24:27], v[40:43]
ds_read_b64_tr_b16 a[130:131], v12 offset:10240
s_add_u32 m0, s33, 15360
s_add_u32 s31, s38, 122880
v_mfma_f32_16x16x32_bf16 v[44:47], a[144:147], a[28:31], v[44:47]
ds_read_b64_tr_b16 a[132:133], v13 offset:8192
v_mfma_f32_16x16x32_bf16 v[48:51], a[148:151], a[16:19], v[48:51]
buffer_load_dwordx4 v10, s[8:11], s31 offen lds
v_mfma_f32_16x16x32_bf16 v[52:55], a[148:151], a[20:23], v[52:55]
ds_read_b64_tr_b16 a[134:135], v13 offset:10240
s_add_u32 s32, s34, 3072
v_mfma_f32_16x16x32_bf16 v[56:59], a[148:151], a[24:27], v[56:59]
buffer_load_dwordx4 a[48:51], v11, s[12:15], s32 offen
v_mfma_f32_16x16x32_bf16 v[60:63], a[148:151], a[28:31], v[60:63]
ds_read_b64_tr_b16 a[136:137], v14 offset:8192
s_add_u32 s32, s35, 3072
v_mfma_f32_16x16x32_bf16 v[64:67], a[152:155], a[16:19], v[64:67]
buffer_load_dwordx4 a[52:55], v11, s[12:15], s32 offen
v_mfma_f32_16x16x32_bf16 v[68:71], a[152:155], a[20:23], v[68:71]
ds_read_b64_tr_b16 a[138:139], v14 offset:10240
s_add_u32 s32, s36, 3072
v_mfma_f32_16x16x32_bf16 v[72:75], a[152:155], a[24:27], v[72:75]
ds_read_b64_tr_b16 a[140:141], v15 offset:8192
ds_read_b64_tr_b16 a[142:143], v15 offset:10240
v_mfma_f32_16x16x32_bf16 v[76:79], a[152:155], a[28:31], v[76:79]
buffer_load_dwordx4 a[56:59], v11, s[12:15], s32 offen
v_mfma_f32_16x16x32_bf16 v[80:83], a[156:159], a[16:19], v[80:83]
s_add_u32 s32, s37, 3072
v_mfma_f32_16x16x32_bf16 v[84:87], a[156:159], a[20:23], v[84:87]
buffer_load_dwordx4 a[60:63], v11, s[12:15], s32 offen
v_mfma_f32_16x16x32_bf16 v[88:91], a[156:159], a[24:27], v[88:91]
s_add_u32 m0, s33, 16384
s_add_u32 s31, s38, 131072
v_mfma_f32_16x16x32_bf16 v[92:95], a[156:159], a[28:31], v[92:95]
buffer_load_dwordx4 v10, s[8:11], s31 offen lds
s_add_u32 m0, s33, 17408
s_add_u32 s31, s38, 139264
buffer_load_dwordx4 v10, s[8:11], s31 offen lds
s_add_u32 m0, s33, 18432
s_add_u32 s31, s38, 147456
buffer_load_dwordx4 v10, s[8:11], s31 offen lds
s_add_u32 m0, s33, 19456
s_add_u32 s31, s38, 155648
buffer_load_dwordx4 v10, s[8:11], s31 offen lds
s_waitcnt vmcnt(8)
s_waitcnt lgkmcnt(0)
v_mfma_f32_16x16x32_bf16 v[32:35], a[128:131], a[32:35], v[32:35]
ds_read_b64_tr_b16 a[144:145], v12 offset:12288
s_add_u32 s32, s34, 4096
v_mfma_f32_16x16x32_bf16 v[36:39], a[128:131], a[36:39], v[36:39]
buffer_load_dwordx4 a[64:67], v11, s[12:15], s32 offen
v_mfma_f32_16x16x32_bf16 v[40:43], a[128:131], a[40:43], v[40:43]
ds_read_b64_tr_b16 a[146:147], v12 offset:14336
s_add_u32 s32, s35, 4096
v_mfma_f32_16x16x32_bf16 v[44:47], a[128:131], a[44:47], v[44:47]
buffer_load_dwordx4 a[68:71], v11, s[12:15], s32 offen
v_mfma_f32_16x16x32_bf16 v[48:51], a[132:135], a[32:35], v[48:51]
ds_read_b64_tr_b16 a[148:149], v13 offset:12288
s_add_u32 s32, s36, 4096
v_mfma_f32_16x16x32_bf16 v[52:55], a[132:135], a[36:39], v[52:55]
buffer_load_dwordx4 a[72:75], v11, s[12:15], s32 offen
v_mfma_f32_16x16x32_bf16 v[56:59], a[132:135], a[40:43], v[56:59]
ds_read_b64_tr_b16 a[150:151], v13 offset:14336
s_add_u32 s32, s37, 4096
v_mfma_f32_16x16x32_bf16 v[60:63], a[132:135], a[44:47], v[60:63]
ds_read_b64_tr_b16 a[152:153], v14 offset:12288
ds_read_b64_tr_b16 a[154:155], v14 offset:14336
v_mfma_f32_16x16x32_bf16 v[64:67], a[136:139], a[32:35], v[64:67]
buffer_load_dwordx4 a[76:79], v11, s[12:15], s32 offen
v_mfma_f32_16x16x32_bf16 v[68:71], a[136:139], a[36:39], v[68:71]
s_add_u32 m0, s33, 20480
s_add_u32 s31, s38, 163840
ds_read_b64_tr_b16 a[156:157], v15 offset:12288
v_mfma_f32_16x16x32_bf16 v[72:75], a[136:139], a[40:43], v[72:75]
ds_read_b64_tr_b16 a[158:159], v15 offset:14336
v_mfma_f32_16x16x32_bf16 v[76:79], a[136:139], a[44:47], v[76:79]
buffer_load_dwordx4 v10, s[8:11], s31 offen lds
v_mfma_f32_16x16x32_bf16 v[80:83], a[140:143], a[32:35], v[80:83]
s_add_u32 m0, s33, 21504
s_add_u32 s31, s38, 172032
v_mfma_f32_16x16x32_bf16 v[84:87], a[140:143], a[36:39], v[84:87]
buffer_load_dwordx4 v10, s[8:11], s31 offen lds
v_mfma_f32_16x16x32_bf16 v[88:91], a[140:143], a[40:43], v[88:91]
s_add_u32 m0, s33, 22528
s_add_u32 s31, s38, 180224
v_mfma_f32_16x16x32_bf16 v[92:95], a[140:143], a[44:47], v[92:95]
buffer_load_dwordx4 v10, s[8:11], s31 offen lds
s_add_u32 m0, s33, 23552
s_add_u32 s31, s38, 188416
buffer_load_dwordx4 v10, s[8:11], s31 offen lds
s_add_u32 s32, s34, 5120
buffer_load_dwordx4 a[80:83], v11, s[12:15], s32 offen
s_add_u32 s32, s35, 5120
buffer_load_dwordx4 a[84:87], v11, s[12:15], s32 offen
s_waitcnt vmcnt(10)
s_waitcnt lgkmcnt(0)
v_mfma_f32_16x16x32_bf16 v[32:35], a[144:147], a[48:51], v[32:35]
ds_read_b64_tr_b16 a[128:129], v12 offset:16384
s_add_u32 s32, s36, 5120
v_mfma_f32_16x16x32_bf16 v[36:39], a[144:147], a[52:55], v[36:39]
buffer_load_dwordx4 a[88:91], v11, s[12:15], s32 offen
v_mfma_f32_16x16x32_bf16 v[40:43], a[144:147], a[56:59], v[40:43]
ds_read_b64_tr_b16 a[130:131], v12 offset:18432
s_add_u32 s32, s37, 5120
v_mfma_f32_16x16x32_bf16 v[44:47], a[144:147], a[60:63], v[44:47]
buffer_load_dwordx4 a[92:95], v11, s[12:15], s32 offen
v_mfma_f32_16x16x32_bf16 v[48:51], a[148:151], a[48:51], v[48:51]
ds_read_b64_tr_b16 a[132:133], v13 offset:16384
s_add_u32 m0, s33, 24576
s_add_u32 s31, s38, 196608
v_mfma_f32_16x16x32_bf16 v[52:55], a[148:151], a[52:55], v[52:55]
ds_read_b64_tr_b16 a[134:135], v13 offset:18432
ds_read_b64_tr_b16 a[136:137], v14 offset:16384
v_mfma_f32_16x16x32_bf16 v[56:59], a[148:151], a[56:59], v[56:59]
buffer_load_dwordx4 v10, s[8:11], s31 offen lds
v_mfma_f32_16x16x32_bf16 v[60:63], a[148:151], a[60:63], v[60:63]
s_add_u32 m0, s33, 25600
s_add_u32 s31, s38, 204800
ds_read_b64_tr_b16 a[138:139], v14 offset:18432
v_mfma_f32_16x16x32_bf16 v[64:67], a[152:155], a[48:51], v[64:67]
buffer_load_dwordx4 v10, s[8:11], s31 offen lds
v_mfma_f32_16x16x32_bf16 v[68:71], a[152:155], a[52:55], v[68:71]
s_add_u32 m0, s33, 26624
s_add_u32 s31, s38, 212992
ds_read_b64_tr_b16 a[140:141], v15 offset:16384
v_mfma_f32_16x16x32_bf16 v[72:75], a[152:155], a[56:59], v[72:75]
ds_read_b64_tr_b16 a[142:143], v15 offset:18432
v_mfma_f32_16x16x32_bf16 v[76:79], a[152:155], a[60:63], v[76:79]
buffer_load_dwordx4 v10, s[8:11], s31 offen lds
v_mfma_f32_16x16x32_bf16 v[80:83], a[156:159], a[48:51], v[80:83]
s_add_u32 m0, s33, 27648
s_add_u32 s31, s38, 221184
v_mfma_f32_16x16x32_bf16 v[84:87], a[156:159], a[52:55], v[84:87]
buffer_load_dwordx4 v10, s[8:11], s31 offen lds
v_mfma_f32_16x16x32_bf16 v[88:91], a[156:159], a[56:59], v[88:91]
s_add_u32 s32, s34, 6144
v_mfma_f32_16x16x32_bf16 v[92:95], a[156:159], a[60:63], v[92:95]
buffer_load_dwordx4 a[96:99], v11, s[12:15], s32 offen
s_add_u32 s32, s35, 6144
buffer_load_dwordx4 a[100:103], v11, s[12:15], s32 offen
s_add_u32 s32, s36, 6144
buffer_load_dwordx4 a[104:107], v11, s[12:15], s32 offen
s_add_u32 s32, s37, 6144
buffer_load_dwordx4 a[108:111], v11, s[12:15], s32 offen
s_waitcnt vmcnt(12)
s_waitcnt lgkmcnt(0)
v_mfma_f32_16x16x32_bf16 v[32:35], a[128:131], a[64:67], v[32:35]
ds_read_b64_tr_b16 a[144:145], v12 offset:20480
s_add_u32 m0, s33, 28672
s_add_u32 s31, s38, 229376
v_mfma_f32_16x16x32_bf16 v[36:39], a[128:131], a[68:71], v[36:39]
buffer_load_dwordx4 v10, s[8:11], s31 offen lds
v_mfma_f32_16x16x32_bf16 v[40:43], a[128:131], a[72:75], v[40:43]
ds_read_b64_tr_b16 a[146:147], v12 offset:22528
s_add_u32 m0, s33, 29696
s_add_u32 s31, s38, 237568
v_mfma_f32_16x16x32_bf16 v[44:47], a[128:131], a[76:79], v[44:47]
ds_read_b64_tr_b16 a[148:149], v13 offset:20480
v_mfma_f32_16x16x32_bf16 v[48:51], a[132:135], a[64:67], v[48:51]
buffer_load_dwordx4 v10, s[8:11], s31 offen lds
v_mfma_f32_16x16x32_bf16 v[52:55], a[132:135], a[68:71], v[52:55]
ds_read_b64_tr_b16 a[150:151], v13 offset:22528
s_add_u32 m0, s33, 30720
s_add_u32 s31, s38, 245760
v_mfma_f32_16x16x32_bf16 v[56:59], a[132:135], a[72:75], v[56:59]
buffer_load_dwordx4 v10, s[8:11], s31 offen lds
v_mfma_f32_16x16x32_bf16 v[60:63], a[132:135], a[76:79], v[60:63]
ds_read_b64_tr_b16 a[152:153], v14 offset:20480
s_add_u32 m0, s33, 31744
s_add_u32 s31, s38, 253952
v_mfma_f32_16x16x32_bf16 v[64:67], a[136:139], a[64:67], v[64:67]
buffer_load_dwordx4 v10, s[8:11], s31 offen lds
v_mfma_f32_16x16x32_bf16 v[68:71], a[136:139], a[68:71], v[68:71]
ds_read_b64_tr_b16 a[154:155], v14 offset:22528
s_add_u32 s32, s34, 7168
v_mfma_f32_16x16x32_bf16 v[72:75], a[136:139], a[72:75], v[72:75]
ds_read_b64_tr_b16 a[156:157], v15 offset:20480
ds_read_b64_tr_b16 a[158:159], v15 offset:22528
v_mfma_f32_16x16x32_bf16 v[76:79], a[136:139], a[76:79], v[76:79]
buffer_load_dwordx4 a[112:115], v11, s[12:15], s32 offen
v_mfma_f32_16x16x32_bf16 v[80:83], a[140:143], a[64:67], v[80:83]
s_add_u32 s32, s35, 7168
v_mfma_f32_16x16x32_bf16 v[84:87], a[140:143], a[68:71], v[84:87]
buffer_load_dwordx4 a[116:119], v11, s[12:15], s32 offen
v_mfma_f32_16x16x32_bf16 v[88:91], a[140:143], a[72:75], v[88:91]
s_add_u32 s32, s36, 7168
v_mfma_f32_16x16x32_bf16 v[92:95], a[140:143], a[76:79], v[92:95]
buffer_load_dwordx4 a[120:123], v11, s[12:15], s32 offen
s_add_u32 s32, s37, 7168
buffer_load_dwordx4 a[124:127], v11, s[12:15], s32 offen
s_add_u32 m0, s33, 0
s_add_u32 s31, s38, 262144
buffer_load_dwordx4 v10, s[8:11], s31 offen lds
s_add_u32 m0, s33, 1024
s_add_u32 s31, s38, 270336
buffer_load_dwordx4 v10, s[8:11], s31 offen lds
s_waitcnt vmcnt(14)
s_waitcnt lgkmcnt(0)
v_mfma_f32_16x16x32_bf16 v[32:35], a[144:147], a[80:83], v[32:35]
ds_read_b64_tr_b16 a[128:129], v12 offset:24576
s_add_u32 m0, s33, 2048
s_add_u32 s31, s38, 278528
v_mfma_f32_16x16x32_bf16 v[36:39], a[144:147], a[84:87], v[36:39]
buffer_load_dwordx4 v10, s[8:11], s31 offen lds
v_mfma_f32_16x16x32_bf16 v[40:43], a[144:147], a[88:91], v[40:43]
ds_read_b64_tr_b16 a[130:131], v12 offset:26624
s_add_u32 m0, s33, 3072
s_add_u32 s31, s38, 286720
v_mfma_f32_16x16x32_bf16 v[44:47], a[144:147], a[92:95], v[44:47]
ds_read_b64_tr_b16 a[132:133], v13 offset:24576
v_mfma_f32_16x16x32_bf16 v[48:51], a[148:151], a[80:83], v[48:51]
buffer_load_dwordx4 v10, s[8:11], s31 offen lds
v_mfma_f32_16x16x32_bf16 v[52:55], a[148:151], a[84:87], v[52:55]
ds_read_b64_tr_b16 a[134:135], v13 offset:26624
s_add_u32 s32, s34, 8192
v_mfma_f32_16x16x32_bf16 v[56:59], a[148:151], a[88:91], v[56:59]
buffer_load_dwordx4 a[0:3], v11, s[12:15], s32 offen
v_mfma_f32_16x16x32_bf16 v[60:63], a[148:151], a[92:95], v[60:63]
ds_read_b64_tr_b16 a[136:137], v14 offset:24576
s_add_u32 s32, s35, 8192
v_mfma_f32_16x16x32_bf16 v[64:67], a[152:155], a[80:83], v[64:67]
buffer_load_dwordx4 a[4:7], v11, s[12:15], s32 offen
v_mfma_f32_16x16x32_bf16 v[68:71], a[152:155], a[84:87], v[68:71]
ds_read_b64_tr_b16 a[138:139], v14 offset:26624
s_add_u32 s32, s36, 8192
v_mfma_f32_16x16x32_bf16 v[72:75], a[152:155], a[88:91], v[72:75]
ds_read_b64_tr_b16 a[140:141], v15 offset:24576
ds_read_b64_tr_b16 a[142:143], v15 offset:26624
v_mfma_f32_16x16x32_bf16 v[76:79], a[152:155], a[92:95], v[76:79]
buffer_load_dwordx4 a[8:11], v11, s[12:15], s32 offen
v_mfma_f32_16x16x32_bf16 v[80:83], a[156:159], a[80:83], v[80:83]
s_add_u32 s32, s37, 8192
v_mfma_f32_16x16x32_bf16 v[84:87], a[156:159], a[84:87], v[84:87]
buffer_load_dwordx4 a[12:15], v11, s[12:15], s32 offen
v_mfma_f32_16x16x32_bf16 v[88:91], a[156:159], a[88:91], v[88:91]
s_add_u32 m0, s33, 4096
s_add_u32 s31, s38, 294912
v_mfma_f32_16x16x32_bf16 v[92:95], a[156:159], a[92:95], v[92:95]
buffer_load_dwordx4 v10, s[8:11], s31 offen lds
s_add_u32 m0, s33, 5120
s_add_u32 s31, s38, 303104
buffer_load_dwordx4 v10, s[8:11], s31 offen lds
s_add_u32 m0, s33, 6144
s_add_u32 s31, s38, 311296
buffer_load_dwordx4 v10, s[8:11], s31 offen lds
s_add_u32 m0, s33, 7168
s_add_u32 s31, s38, 319488
buffer_load_dwordx4 v10, s[8:11], s31 offen lds
s_waitcnt vmcnt(16)
s_waitcnt lgkmcnt(0)
v_mfma_f32_16x16x32_bf16 v[32:35], a[128:131], a[96:99], v[32:35]
ds_read_b64_tr_b16 a[144:145], v12 offset:28672
s_add_u32 s32, s34, 9216
v_mfma_f32_16x16x32_bf16 v[36:39], a[128:131], a[100:103], v[36:39]
buffer_load_dwordx4 a[16:19], v11, s[12:15], s32 offen
v_mfma_f32_16x16x32_bf16 v[40:43], a[128:131], a[104:107], v[40:43]
ds_read_b64_tr_b16 a[146:147], v12 offset:30720
s_add_u32 s32, s35, 9216
v_mfma_f32_16x16x32_bf16 v[44:47], a[128:131], a[108:111], v[44:47]
buffer_load_dwordx4 a[20:23], v11, s[12:15], s32 offen
v_mfma_f32_16x16x32_bf16 v[48:51], a[132:135], a[96:99], v[48:51]
ds_read_b64_tr_b16 a[148:149], v13 offset:28672
s_add_u32 s32, s36, 9216
v_mfma_f32_16x16x32_bf16 v[52:55], a[132:135], a[100:103], v[52:55]
buffer_load_dwordx4 a[24:27], v11, s[12:15], s32 offen
v_mfma_f32_16x16x32_bf16 v[56:59], a[132:135], a[104:107], v[56:59]
ds_read_b64_tr_b16 a[150:151], v13 offset:30720
s_add_u32 s32, s37, 9216
v_mfma_f32_16x16x32_bf16 v[60:63], a[132:135], a[108:111], v[60:63]
ds_read_b64_tr_b16 a[152:153], v14 offset:28672
ds_read_b64_tr_b16 a[154:155], v14 offset:30720
v_mfma_f32_16x16x32_bf16 v[64:67], a[136:139], a[96:99], v[64:67]
buffer_load_dwordx4 a[28:31], v11, s[12:15], s32 offen
v_mfma_f32_16x16x32_bf16 v[68:71], a[136:139], a[100:103], v[68:71]
s_add_u32 m0, s33, 8192
s_add_u32 s31, s38, 327680
ds_read_b64_tr_b16 a[156:157], v15 offset:28672
v_mfma_f32_16x16x32_bf16 v[72:75], a[136:139], a[104:107], v[72:75]
ds_read_b64_tr_b16 a[158:159], v15 offset:30720
v_mfma_f32_16x16x32_bf16 v[76:79], a[136:139], a[108:111], v[76:79]
buffer_load_dwordx4 v10, s[8:11], s31 offen lds
v_mfma_f32_16x16x32_bf16 v[80:83], a[140:143], a[96:99], v[80:83]
s_add_u32 m0, s33, 9216
s_add_u32 s31, s38, 335872
v_mfma_f32_16x16x32_bf16 v[84:87], a[140:143], a[100:103], v[84:87]
buffer_load_dwordx4 v10, s[8:11], s31 offen lds
v_mfma_f32_16x16x32_bf16 v[88:91], a[140:143], a[104:107], v[88:91]
s_add_u32 m0, s33, 10240
s_add_u32 s31, s38, 344064
v_mfma_f32_16x16x32_bf16 v[92:95], a[140:143], a[108:111], v[92:95]
buffer_load_dwordx4 v10, s[8:11], s31 offen lds
s_add_u32 m0, s33, 11264
s_add_u32 s31, s38, 352256
buffer_load_dwordx4 v10, s[8:11], s31 offen lds
s_add_u32 s32, s34, 10240
buffer_load_dwordx4 a[32:35], v11, s[12:15], s32 offen
s_add_u32 s32, s35, 10240
buffer_load_dwordx4 a[36:39], v11, s[12:15], s32 offen
s_waitcnt vmcnt(18)
s_waitcnt lgkmcnt(0)
v_mfma_f32_16x16x32_bf16 v[32:35], a[144:147], a[112:115], v[32:35]
ds_read_b64_tr_b16 a[128:129], v12 offset:0
s_add_u32 s32, s36, 10240
v_mfma_f32_16x16x32_bf16 v[36:39], a[144:147], a[116:119], v[36:39]
buffer_load_dwordx4 a[40:43], v11, s[12:15], s32 offen
v_mfma_f32_16x16x32_bf16 v[40:43], a[144:147], a[120:123], v[40:43]
ds_read_b64_tr_b16 a[130:131], v12 offset:2048
s_add_u32 s32, s37, 10240
v_mfma_f32_16x16x32_bf16 v[44:47], a[144:147], a[124:127], v[44:47]
buffer_load_dwordx4 a[44:47], v11, s[12:15], s32 offen
v_mfma_f32_16x16x32_bf16 v[48:51], a[148:151], a[112:115], v[48:51]
ds_read_b64_tr_b16 a[132:133], v13 offset:0
s_add_u32 m0, s33, 12288
s_add_u32 s31, s38, 360448
v_mfma_f32_16x16x32_bf16 v[52:55], a[148:151], a[116:119], v[52:55]
ds_read_b64_tr_b16 a[134:135], v13 offset:2048
ds_read_b64_tr_b16 a[136:137], v14 offset:0
v_mfma_f32_16x16x32_bf16 v[56:59], a[148:151], a[120:123], v[56:59]
buffer_load_dwordx4 v10, s[8:11], s31 offen lds
v_mfma_f32_16x16x32_bf16 v[60:63], a[148:151], a[124:127], v[60:63]
s_add_u32 m0, s33, 13312
s_add_u32 s31, s38, 368640
ds_read_b64_tr_b16 a[138:139], v14 offset:2048
v_mfma_f32_16x16x32_bf16 v[64:67], a[152:155], a[112:115], v[64:67]
buffer_load_dwordx4 v10, s[8:11], s31 offen lds
v_mfma_f32_16x16x32_bf16 v[68:71], a[152:155], a[116:119], v[68:71]
s_add_u32 m0, s33, 14336
s_add_u32 s31, s38, 376832
ds_read_b64_tr_b16 a[140:141], v15 offset:0
v_mfma_f32_16x16x32_bf16 v[72:75], a[152:155], a[120:123], v[72:75]
ds_read_b64_tr_b16 a[142:143], v15 offset:2048
v_mfma_f32_16x16x32_bf16 v[76:79], a[152:155], a[124:127], v[76:79]
buffer_load_dwordx4 v10, s[8:11], s31 offen lds
v_mfma_f32_16x16x32_bf16 v[80:83], a[156:159], a[112:115], v[80:83]
s_add_u32 m0, s33, 15360
s_add_u32 s31, s38, 385024
v_mfma_f32_16x16x32_bf16 v[84:87], a[156:159], a[116:119], v[84:87]
buffer_load_dwordx4 v10, s[8:11], s31 offen lds
v_mfma_f32_16x16x32_bf16 v[88:91], a[156:159], a[120:123], v[88:91]
s_add_u32 s32, s34, 11264
v_mfma_f32_16x16x32_bf16 v[92:95], a[156:159], a[124:127], v[92:95]
buffer_load_dwordx4 a[48:51], v11, s[12:15], s32 offen
s_add_u32 s32, s35, 11264
buffer_load_dwordx4 a[52:55], v11, s[12:15], s32 offen
s_add_u32 s32, s36, 11264
buffer_load_dwordx4 a[56:59], v11, s[12:15], s32 offen
s_add_u32 s32, s37, 11264
buffer_load_dwordx4 a[60:63], v11, s[12:15], s32 offen
s_waitcnt vmcnt(20)
s_waitcnt lgkmcnt(0)
v_mfma_f32_16x16x32_bf16 v[32:35], a[128:131], a[0:3], v[32:35]
ds_read_b64_tr_b16 a[144:145], v12 offset:4096
s_add_u32 m0, s33, 16384
s_add_u32 s31, s38, 393216
v_mfma_f32_16x16x32_bf16 v[36:39], a[128:131], a[4:7], v[36:39]
buffer_load_dwordx4 v10, s[8:11], s31 offen lds
v_mfma_f32_16x16x32_bf16 v[40:43], a[128:131], a[8:11], v[40:43]
ds_read_b64_tr_b16 a[146:147], v12 offset:6144
s_add_u32 m0, s33, 17408
s_add_u32 s31, s38, 401408
v_mfma_f32_16x16x32_bf16 v[44:47], a[128:131], a[12:15], v[44:47]
ds_read_b64_tr_b16 a[148:149], v13 offset:4096
v_mfma_f32_16x16x32_bf16 v[48:51], a[132:135], a[0:3], v[48:51]
buffer_load_dwordx4 v10, s[8:11], s31 offen lds
v_mfma_f32_16x16x32_bf16 v[52:55], a[132:135], a[4:7], v[52:55]
ds_read_b64_tr_b16 a[150:151], v13 offset:6144
s_add_u32 m0, s33, 18432
s_add_u32 s31, s38, 409600
v_mfma_f32_16x16x32_bf16 v[56:59], a[132:135], a[8:11], v[56:59]
buffer_load_dwordx4 v10, s[8:11], s31 offen lds
v_mfma_f32_16x16x32_bf16 v[60:63], a[132:135], a[12:15], v[60:63]
ds_read_b64_tr_b16 a[152:153], v14 offset:4096
s_add_u32 m0, s33, 19456
s_add_u32 s31, s38, 417792
v_mfma_f32_16x16x32_bf16 v[64:67], a[136:139], a[0:3], v[64:67]
buffer_load_dwordx4 v10, s[8:11], s31 offen lds
v_mfma_f32_16x16x32_bf16 v[68:71], a[136:139], a[4:7], v[68:71]
ds_read_b64_tr_b16 a[154:155], v14 offset:6144
s_add_u32 s32, s34, 12288
v_mfma_f32_16x16x32_bf16 v[72:75], a[136:139], a[8:11], v[72:75]
ds_read_b64_tr_b16 a[156:157], v15 offset:4096
ds_read_b64_tr_b16 a[158:159], v15 offset:6144
v_mfma_f32_16x16x32_bf16 v[76:79], a[136:139], a[12:15], v[76:79]
buffer_load_dwordx4 a[64:67], v11, s[12:15], s32 offen
v_mfma_f32_16x16x32_bf16 v[80:83], a[140:143], a[0:3], v[80:83]
s_add_u32 s32, s35, 12288
v_mfma_f32_16x16x32_bf16 v[84:87], a[140:143], a[4:7], v[84:87]
buffer_load_dwordx4 a[68:71], v11, s[12:15], s32 offen
v_mfma_f32_16x16x32_bf16 v[88:91], a[140:143], a[8:11], v[88:91]
s_add_u32 s32, s36, 12288
v_mfma_f32_16x16x32_bf16 v[92:95], a[140:143], a[12:15], v[92:95]
buffer_load_dwordx4 a[72:75], v11, s[12:15], s32 offen
s_add_u32 s32, s37, 12288
buffer_load_dwordx4 a[76:79], v11, s[12:15], s32 offen
s_add_u32 m0, s33, 20480
s_add_u32 s31, s38, 425984
buffer_load_dwordx4 v10, s[8:11], s31 offen lds
s_add_u32 m0, s33, 21504
s_add_u32 s31, s38, 434176
buffer_load_dwordx4 v10, s[8:11], s31 offen lds
s_waitcnt vmcnt(22)
s_waitcnt lgkmcnt(0)
v_mfma_f32_16x16x32_bf16 v[32:35], a[144:147], a[16:19], v[32:35]
ds_read_b64_tr_b16 a[128:129], v12 offset:8192
s_add_u32 m0, s33, 22528
s_add_u32 s31, s38, 442368
v_mfma_f32_16x16x32_bf16 v[36:39], a[144:147], a[20:23], v[36:39]
buffer_load_dwordx4 v10, s[8:11], s31 offen lds
v_mfma_f32_16x16x32_bf16 v[40:43], a[144:147], a[24:27], v[40:43]
ds_read_b64_tr_b16 a[130:131], v12 offset:10240
ds_read_b64_tr_b16 a[132:133], v13 offset:8192
v_mfma_f32_16x16x32_bf16 v[44:47], a[144:147], a[28:31], v[44:47]
s_add_u32 m0, s33, 23552
s_add_u32 s31, s38, 450560
v_mfma_f32_16x16x32_bf16 v[48:51], a[148:151], a[16:19], v[48:51]
ds_read_b64_tr_b16 a[134:135], v13 offset:10240
v_mfma_f32_16x16x32_bf16 v[52:55], a[148:151], a[20:23], v[52:55]
buffer_load_dwordx4 v10, s[8:11], s31 offen lds
v_mfma_f32_16x16x32_bf16 v[56:59], a[148:151], a[24:27], v[56:59]
ds_read_b64_tr_b16 a[136:137], v14 offset:8192
s_add_u32 s32, s34, 13312
v_mfma_f32_16x16x32_bf16 v[60:63], a[148:151], a[28:31], v[60:63]
ds_read_b64_tr_b16 a[138:139], v14 offset:10240
v_mfma_f32_16x16x32_bf16 v[64:67], a[152:155], a[16:19], v[64:67]
buffer_load_dwordx4 a[80:83], v11, s[12:15], s32 offen
v_mfma_f32_16x16x32_bf16 v[68:71], a[152:155], a[20:23], v[68:71]
ds_read_b64_tr_b16 a[140:141], v15 offset:8192
s_add_u32 s32, s35, 13312
v_mfma_f32_16x16x32_bf16 v[72:75], a[152:155], a[24:27], v[72:75]
ds_read_b64_tr_b16 a[142:143], v15 offset:10240
v_mfma_f32_16x16x32_bf16 v[76:79], a[152:155], a[28:31], v[76:79]
buffer_load_dwordx4 a[84:87], v11, s[12:15], s32 offen
v_mfma_f32_16x16x32_bf16 v[80:83], a[156:159], a[16:19], v[80:83]
s_add_u32 s32, s36, 13312
v_mfma_f32_16x16x32_bf16 v[84:87], a[156:159], a[20:23], v[84:87]
buffer_load_dwordx4 a[88:91], v11, s[12:15], s32 offen
v_mfma_f32_16x16x32_bf16 v[88:91], a[156:159], a[24:27], v[88:91]
s_add_u32 s32, s37, 13312
v_mfma_f32_16x16x32_bf16 v[92:95], a[156:159], a[28:31], v[92:95]
buffer_load_dwordx4 a[92:95], v11, s[12:15], s32 offen
s_waitcnt vmcnt(20)
s_waitcnt lgkmcnt(0)
v_mfma_f32_16x16x32_bf16 v[32:35], a[128:131], a[32:35], v[32:35]
ds_read_b64_tr_b16 a[144:145], v12 offset:12288
v_mfma_f32_16x16x32_bf16 v[36:39], a[128:131], a[36:39], v[36:39]
ds_read_b64_tr_b16 a[146:147], v12 offset:14336
v_mfma_f32_16x16x32_bf16 v[40:43], a[128:131], a[40:43], v[40:43]
ds_read_b64_tr_b16 a[148:149], v13 offset:12288
v_mfma_f32_16x16x32_bf16 v[44:47], a[128:131], a[44:47], v[44:47]
v_mfma_f32_16x16x32_bf16 v[48:51], a[132:135], a[32:35], v[48:51]
ds_read_b64_tr_b16 a[150:151], v13 offset:14336
v_mfma_f32_16x16x32_bf16 v[52:55], a[132:135], a[36:39], v[52:55]
ds_read_b64_tr_b16 a[152:153], v14 offset:12288
v_mfma_f32_16x16x32_bf16 v[56:59], a[132:135], a[40:43], v[56:59]
ds_read_b64_tr_b16 a[154:155], v14 offset:14336
v_mfma_f32_16x16x32_bf16 v[60:63], a[132:135], a[44:47], v[60:63]
v_mfma_f32_16x16x32_bf16 v[64:67], a[136:139], a[32:35], v[64:67]
ds_read_b64_tr_b16 a[156:157], v15 offset:12288
v_mfma_f32_16x16x32_bf16 v[68:71], a[136:139], a[36:39], v[68:71]
ds_read_b64_tr_b16 a[158:159], v15 offset:14336
v_mfma_f32_16x16x32_bf16 v[72:75], a[136:139], a[40:43], v[72:75]
v_mfma_f32_16x16x32_bf16 v[76:79], a[136:139], a[44:47], v[76:79]
v_mfma_f32_16x16x32_bf16 v[80:83], a[140:143], a[32:35], v[80:83]
v_mfma_f32_16x16x32_bf16 v[84:87], a[140:143], a[36:39], v[84:87]
v_mfma_f32_16x16x32_bf16 v[88:91], a[140:143], a[40:43], v[88:91]
v_mfma_f32_16x16x32_bf16 v[92:95], a[140:143], a[44:47], v[92:95]
s_waitcnt vmcnt(12)
s_waitcnt lgkmcnt(0)
v_mfma_f32_16x16x32_bf16 v[32:35], a[144:147], a[48:51], v[32:35]
ds_read_b64_tr_b16 a[128:129], v12 offset:16384
v_mfma_f32_16x16x32_bf16 v[36:39], a[144:147], a[52:55], v[36:39]
ds_read_b64_tr_b16 a[130:131], v12 offset:18432
v_mfma_f32_16x16x32_bf16 v[40:43], a[144:147], a[56:59], v[40:43]
ds_read_b64_tr_b16 a[132:133], v13 offset:16384
v_mfma_f32_16x16x32_bf16 v[44:47], a[144:147], a[60:63], v[44:47]
v_mfma_f32_16x16x32_bf16 v[48:51], a[148:151], a[48:51], v[48:51]
ds_read_b64_tr_b16 a[134:135], v13 offset:18432
v_mfma_f32_16x16x32_bf16 v[52:55], a[148:151], a[52:55], v[52:55]
ds_read_b64_tr_b16 a[136:137], v14 offset:16384
v_mfma_f32_16x16x32_bf16 v[56:59], a[148:151], a[56:59], v[56:59]
ds_read_b64_tr_b16 a[138:139], v14 offset:18432
v_mfma_f32_16x16x32_bf16 v[60:63], a[148:151], a[60:63], v[60:63]
v_mfma_f32_16x16x32_bf16 v[64:67], a[152:155], a[48:51], v[64:67]
ds_read_b64_tr_b16 a[140:141], v15 offset:16384
v_mfma_f32_16x16x32_bf16 v[68:71], a[152:155], a[52:55], v[68:71]
ds_read_b64_tr_b16 a[142:143], v15 offset:18432
v_mfma_f32_16x16x32_bf16 v[72:75], a[152:155], a[56:59], v[72:75]
v_mfma_f32_16x16x32_bf16 v[76:79], a[152:155], a[60:63], v[76:79]
v_mfma_f32_16x16x32_bf16 v[80:83], a[156:159], a[48:51], v[80:83]
v_mfma_f32_16x16x32_bf16 v[84:87], a[156:159], a[52:55], v[84:87]
v_mfma_f32_16x16x32_bf16 v[88:91], a[156:159], a[56:59], v[88:91]
v_mfma_f32_16x16x32_bf16 v[92:95], a[156:159], a[60:63], v[92:95]
s_waitcnt vmcnt(4)
s_waitcnt lgkmcnt(0)
v_mfma_f32_16x16x32_bf16 v[32:35], a[128:131], a[64:67], v[32:35]
ds_read_b64_tr_b16 a[144:145], v12 offset:20480
v_mfma_f32_16x16x32_bf16 v[36:39], a[128:131], a[68:71], v[36:39]
ds_read_b64_tr_b16 a[146:147], v12 offset:22528
v_mfma_f32_16x16x32_bf16 v[40:43], a[128:131], a[72:75], v[40:43]
ds_read_b64_tr_b16 a[148:149], v13 offset:20480
v_mfma_f32_16x16x32_bf16 v[44:47], a[128:131], a[76:79], v[44:47]
v_mfma_f32_16x16x32_bf16 v[48:51], a[132:135], a[64:67], v[48:51]
ds_read_b64_tr_b16 a[150:151], v13 offset:22528
v_mfma_f32_16x16x32_bf16 v[52:55], a[132:135], a[68:71], v[52:55]
ds_read_b64_tr_b16 a[152:153], v14 offset:20480
v_mfma_f32_16x16x32_bf16 v[56:59], a[132:135], a[72:75], v[56:59]
ds_read_b64_tr_b16 a[154:155], v14 offset:22528
v_mfma_f32_16x16x32_bf16 v[60:63], a[132:135], a[76:79], v[60:63]
v_mfma_f32_16x16x32_bf16 v[64:67], a[136:139], a[64:67], v[64:67]
ds_read_b64_tr_b16 a[156:157], v15 offset:20480
v_mfma_f32_16x16x32_bf16 v[68:71], a[136:139], a[68:71], v[68:71]
ds_read_b64_tr_b16 a[158:159], v15 offset:22528
v_mfma_f32_16x16x32_bf16 v[72:75], a[136:139], a[72:75], v[72:75]
v_mfma_f32_16x16x32_bf16 v[76:79], a[136:139], a[76:79], v[76:79]
v_mfma_f32_16x16x32_bf16 v[80:83], a[140:143], a[64:67], v[80:83]
v_mfma_f32_16x16x32_bf16 v[84:87], a[140:143], a[68:71], v[84:87]
v_mfma_f32_16x16x32_bf16 v[88:91], a[140:143], a[72:75], v[88:91]
v_mfma_f32_16x16x32_bf16 v[92:95], a[140:143], a[76:79], v[92:95]
s_waitcnt vmcnt(0)
s_waitcnt lgkmcnt(0)
v_mfma_f32_16x16x32_bf16 v[32:35], a[144:147], a[80:83], v[32:35]
v_mfma_f32_16x16x32_bf16 v[36:39], a[144:147], a[84:87], v[36:39]
v_mfma_f32_16x16x32_bf16 v[40:43], a[144:147], a[88:91], v[40:43]
v_mfma_f32_16x16x32_bf16 v[44:47], a[144:147], a[92:95], v[44:47]
v_mfma_f32_16x16x32_bf16 v[48:51], a[148:151], a[80:83], v[48:51]
v_mfma_f32_16x16x32_bf16 v[52:55], a[148:151], a[84:87], v[52:55]
v_mfma_f32_16x16x32_bf16 v[56:59], a[148:151], a[88:91], v[56:59]
v_mfma_f32_16x16x32_bf16 v[60:63], a[148:151], a[92:95], v[60:63]
v_mfma_f32_16x16x32_bf16 v[64:67], a[152:155], a[80:83], v[64:67]
v_mfma_f32_16x16x32_bf16 v[68:71], a[152:155], a[84:87], v[68:71]
v_mfma_f32_16x16x32_bf16 v[72:75], a[152:155], a[88:91], v[72:75]
v_mfma_f32_16x16x32_bf16 v[76:79], a[152:155], a[92:95], v[76:79]
v_mfma_f32_16x16x32_bf16 v[80:83], a[156:159], a[80:83], v[80:83]
v_mfma_f32_16x16x32_bf16 v[84:87], a[156:159], a[84:87], v[84:87]
v_mfma_f32_16x16x32_bf16 v[88:91], a[156:159], a[88:91], v[88:91]
v_mfma_f32_16x16x32_bf16 v[92:95], a[156:159], a[92:95], v[92:95]
s_lshl_b32 s32, s29, 16
v_lshrrev_b32 v20, 4, v16
v_lshlrev_b32 v20, 14, v20
v_lshrrev_b32 v21, 1, v17
v_lshl_add_u32 v20, v21, 10, v20
v_and_b32 v21, 1, v17
v_lshl_add_u32 v20, v21, 9, v20
v_and_b32 v21, 15, v16
v_lshl_add_u32 v20, v21, 4, v20
s_lshl_b32 s31, s30, 11
s_add_u32 s31, s31, s32
buffer_load_dwordx4 v[124:127], v20, s[16:19], s31 offen
buffer_load_dwordx4 v[96:99], v20, s[16:19], s31 offen offset:256
buffer_load_dwordx4 v[108:111], v18, s[20:23], 0 offen
buffer_load_dwordx4 v[112:115], v18, s[20:23], 0 offen offset:16
s_barrier
v_and_b32 v3, 15, v2
v_lshrrev_b32 v4, 4, v2
v_mul_u32_u24 v3, 272, v3
v_lshl_add_u32 v3, v4, 4, v3
s_mul_i32 s31, s28, 17408
v_add_u32 v3, s31, v3
s_nop 7
ds_write_b128 v3, v[32:35] offset:0
ds_write_b128 v3, v[36:39] offset:4352
ds_write_b128 v3, v[40:43] offset:8704
ds_write_b128 v3, v[44:47] offset:13056
ds_write_b128 v3, v[48:51] offset:64
ds_write_b128 v3, v[52:55] offset:4416
ds_write_b128 v3, v[56:59] offset:8768
ds_write_b128 v3, v[60:63] offset:13120
ds_write_b128 v3, v[64:67] offset:128
ds_write_b128 v3, v[68:71] offset:4480
ds_write_b128 v3, v[72:75] offset:8832
ds_write_b128 v3, v[76:79] offset:13184
ds_write_b128 v3, v[80:83] offset:192
ds_write_b128 v3, v[84:87] offset:4544
ds_write_b128 v3, v[88:91] offset:8896
ds_write_b128 v3, v[92:95] offset:13248
s_waitcnt lgkmcnt(0)
s_barrier
v_mul_u32_u24 v3, 272, v16
v_lshl_add_u32 v3, v17, 6, v3
ds_read_b128 v[32:35], v3 offset:0
ds_read_b128 v[36:39], v3 offset:16
ds_read_b128 v[40:43], v3 offset:32
ds_read_b128 v[44:47], v3 offset:48
ds_read_b128 v[48:51], v3 offset:17408
ds_read_b128 v[52:55], v3 offset:17424
ds_read_b128 v[56:59], v3 offset:17440
ds_read_b128 v[60:63], v3 offset:17456
ds_read_b128 v[64:67], v3 offset:34816
ds_read_b128 v[68:71], v3 offset:34832
ds_read_b128 v[72:75], v3 offset:34848
ds_read_b128 v[76:79], v3 offset:34864
ds_read_b128 v[80:83], v3 offset:52224
ds_read_b128 v[84:87], v3 offset:52240
ds_read_b128 v[88:91], v3 offset:52256
ds_read_b128 v[92:95], v3 offset:52272
s_waitcnt lgkmcnt(0)
v_add_f32 v32, v32, v48
v_add_f32 v64, v64, v80
v_add_f32 v33, v33, v49
v_add_f32 v65, v65, v81
v_add_f32 v34, v34, v50
v_add_f32 v66, v66, v82
v_add_f32 v35, v35, v51
v_add_f32 v67, v67, v83
v_add_f32 v36, v36, v52
v_add_f32 v68, v68, v84
v_add_f32 v37, v37, v53
v_add_f32 v69, v69, v85
v_add_f32 v38, v38, v54
v_add_f32 v70, v70, v86
v_add_f32 v39, v39, v55
v_add_f32 v71, v71, v87
v_add_f32 v40, v40, v56
v_add_f32 v72, v72, v88
v_add_f32 v41, v41, v57
v_add_f32 v73, v73, v89
v_add_f32 v42, v42, v58
v_add_f32 v74, v74, v90
v_add_f32 v43, v43, v59
v_add_f32 v75, v75, v91
v_add_f32 v44, v44, v60
v_add_f32 v76, v76, v92
v_add_f32 v45, v45, v61
v_add_f32 v77, v77, v93
v_add_f32 v46, v46, v62
v_add_f32 v78, v78, v94
v_add_f32 v47, v47, v63
v_add_f32 v79, v79, v95
v_add_f32 v32, v32, v64
v_add_f32 v33, v33, v65
v_add_f32 v34, v34, v66
v_add_f32 v35, v35, v67
v_add_f32 v36, v36, v68
v_add_f32 v37, v37, v69
v_add_f32 v38, v38, v70
v_add_f32 v39, v39, v71
v_add_f32 v40, v40, v72
v_add_f32 v41, v41, v73
v_add_f32 v42, v42, v74
v_add_f32 v43, v43, v75
v_add_f32 v44, v44, v76
v_add_f32 v45, v45, v77
v_add_f32 v46, v46, v78
v_add_f32 v47, v47, v79
s_waitcnt vmcnt(0)
v_mov_b32 v100, v124
v_mov_b32 v101, v125
v_mov_b32 v102, v96
v_mov_b32 v103, v97
v_mov_b32 v104, v126
v_mov_b32 v105, v127
v_mov_b32 v106, v98
v_mov_b32 v107, v99
v_cvt_pk_bf16_f32 v20, v32, v33
v_lshlrev_b32 v32, 16, v20
v_and_b32 v33, 0xffff0000, v20
v_lshlrev_b32 v21, 16, v108
v_and_b32 v22, 0xffff0000, v108
v_mul_f32 v32, v32, v21
v_mul_f32 v33, v33, v22
v_cvt_pk_bf16_f32 v20, v32, v33
v_lshlrev_b32 v32, 16, v20
v_and_b32 v33, 0xffff0000, v20
v_lshlrev_b32 v21, 16, v100
v_and_b32 v22, 0xffff0000, v100
v_add_f32 v32, v32, v21
v_add_f32 v33, v33, v22
v_cvt_pk_bf16_f32 v116, v32, v33
v_cvt_pk_bf16_f32 v20, v34, v35
v_lshlrev_b32 v34, 16, v20
v_and_b32 v35, 0xffff0000, v20
v_lshlrev_b32 v21, 16, v109
v_and_b32 v22, 0xffff0000, v109
v_mul_f32 v34, v34, v21
v_mul_f32 v35, v35, v22
v_cvt_pk_bf16_f32 v20, v34, v35
v_lshlrev_b32 v34, 16, v20
v_and_b32 v35, 0xffff0000, v20
v_lshlrev_b32 v21, 16, v101
v_and_b32 v22, 0xffff0000, v101
v_add_f32 v34, v34, v21
v_add_f32 v35, v35, v22
v_cvt_pk_bf16_f32 v117, v34, v35
v_cvt_pk_bf16_f32 v20, v36, v37
v_lshlrev_b32 v36, 16, v20
v_and_b32 v37, 0xffff0000, v20
v_lshlrev_b32 v21, 16, v110
v_and_b32 v22, 0xffff0000, v110
v_mul_f32 v36, v36, v21
v_mul_f32 v37, v37, v22
v_cvt_pk_bf16_f32 v20, v36, v37
v_lshlrev_b32 v36, 16, v20
v_and_b32 v37, 0xffff0000, v20
v_lshlrev_b32 v21, 16, v102
v_and_b32 v22, 0xffff0000, v102
v_add_f32 v36, v36, v21
v_add_f32 v37, v37, v22
v_cvt_pk_bf16_f32 v118, v36, v37
v_cvt_pk_bf16_f32 v20, v38, v39
v_lshlrev_b32 v38, 16, v20
v_and_b32 v39, 0xffff0000, v20
v_lshlrev_b32 v21, 16, v111
v_and_b32 v22, 0xffff0000, v111
v_mul_f32 v38, v38, v21
v_mul_f32 v39, v39, v22
v_cvt_pk_bf16_f32 v20, v38, v39
v_lshlrev_b32 v38, 16, v20
v_and_b32 v39, 0xffff0000, v20
v_lshlrev_b32 v21, 16, v103
v_and_b32 v22, 0xffff0000, v103
v_add_f32 v38, v38, v21
v_add_f32 v39, v39, v22
v_cvt_pk_bf16_f32 v119, v38, v39
v_cvt_pk_bf16_f32 v20, v40, v41
v_lshlrev_b32 v40, 16, v20
v_and_b32 v41, 0xffff0000, v20
v_lshlrev_b32 v21, 16, v112
v_and_b32 v22, 0xffff0000, v112
v_mul_f32 v40, v40, v21
v_mul_f32 v41, v41, v22
v_cvt_pk_bf16_f32 v20, v40, v41
v_lshlrev_b32 v40, 16, v20
v_and_b32 v41, 0xffff0000, v20
v_lshlrev_b32 v21, 16, v104
v_and_b32 v22, 0xffff0000, v104
v_add_f32 v40, v40, v21
v_add_f32 v41, v41, v22
v_cvt_pk_bf16_f32 v120, v40, v41
v_cvt_pk_bf16_f32 v20, v42, v43
v_lshlrev_b32 v42, 16, v20
v_and_b32 v43, 0xffff0000, v20
v_lshlrev_b32 v21, 16, v113
v_and_b32 v22, 0xffff0000, v113
v_mul_f32 v42, v42, v21
v_mul_f32 v43, v43, v22
v_cvt_pk_bf16_f32 v20, v42, v43
v_lshlrev_b32 v42, 16, v20
v_and_b32 v43, 0xffff0000, v20
v_lshlrev_b32 v21, 16, v105
v_and_b32 v22, 0xffff0000, v105
v_add_f32 v42, v42, v21
v_add_f32 v43, v43, v22
v_cvt_pk_bf16_f32 v121, v42, v43
v_cvt_pk_bf16_f32 v20, v44, v45
v_lshlrev_b32 v44, 16, v20
v_and_b32 v45, 0xffff0000, v20
v_lshlrev_b32 v21, 16, v114
v_and_b32 v22, 0xffff0000, v114
v_mul_f32 v44, v44, v21
v_mul_f32 v45, v45, v22
v_cvt_pk_bf16_f32 v20, v44, v45
v_lshlrev_b32 v44, 16, v20
v_and_b32 v45, 0xffff0000, v20
v_lshlrev_b32 v21, 16, v106
v_and_b32 v22, 0xffff0000, v106
v_add_f32 v44, v44, v21
v_add_f32 v45, v45, v22
v_cvt_pk_bf16_f32 v122, v44, v45
v_cvt_pk_bf16_f32 v20, v46, v47
v_lshlrev_b32 v46, 16, v20
v_and_b32 v47, 0xffff0000, v20
v_lshlrev_b32 v21, 16, v115
v_and_b32 v22, 0xffff0000, v115
v_mul_f32 v46, v46, v21
v_mul_f32 v47, v47, v22
v_cvt_pk_bf16_f32 v20, v46, v47
v_lshlrev_b32 v46, 16, v20
v_and_b32 v47, 0xffff0000, v20
v_lshlrev_b32 v21, 16, v107
v_and_b32 v22, 0xffff0000, v107
v_add_f32 v46, v46, v21
v_add_f32 v47, v47, v22
v_cvt_pk_bf16_f32 v123, v46, v47
buffer_store_dwordx4 v[116:119], v19, s[24:27], s32 offen
buffer_store_dwordx4 v[120:123], v19, s[24:27], s32 offen offset:16
down_kernel_done:
s_endpgm
.p2align 4
code_end:
s_endpgm
.section .rodata,"a"
.p2align 6
.amdhsa_kernel pre_kernel
  .amdhsa_next_free_vgpr 176
  .amdhsa_next_free_sgpr 102
  .amdhsa_accum_offset 176
  .amdhsa_group_segment_fixed_size 0
  .amdhsa_kernarg_size 112
  .amdhsa_user_sgpr_count 2
  .amdhsa_user_sgpr_kernarg_segment_ptr 1
  .amdhsa_system_sgpr_workgroup_id_x 1
  .amdhsa_float_denorm_mode_32 3
.end_amdhsa_kernel
.p2align 6
.amdhsa_kernel attn_kernel
  .amdhsa_next_free_vgpr 512
  .amdhsa_next_free_sgpr 102
  .amdhsa_accum_offset 256
  .amdhsa_group_segment_fixed_size 0
  .amdhsa_kernarg_size 112
  .amdhsa_user_sgpr_count 2
  .amdhsa_user_sgpr_kernarg_segment_ptr 1
  .amdhsa_system_sgpr_workgroup_id_x 1
  .amdhsa_float_denorm_mode_32 3
.end_amdhsa_kernel
.p2align 6
.amdhsa_kernel wo_kernel
  .amdhsa_next_free_vgpr 144
  .amdhsa_next_free_sgpr 102
  .amdhsa_accum_offset 96
  .amdhsa_group_segment_fixed_size 0
  .amdhsa_kernarg_size 112
  .amdhsa_user_sgpr_count 2
  .amdhsa_user_sgpr_kernarg_segment_ptr 1
  .amdhsa_system_sgpr_workgroup_id_x 1
  .amdhsa_float_denorm_mode_32 3
.end_amdhsa_kernel
.p2align 6
.amdhsa_kernel ln2_kernel
  .amdhsa_next_free_vgpr 128
  .amdhsa_next_free_sgpr 102
  .amdhsa_accum_offset 128
  .amdhsa_group_segment_fixed_size 0
  .amdhsa_kernarg_size 112
  .amdhsa_user_sgpr_count 2
  .amdhsa_user_sgpr_kernarg_segment_ptr 1
  .amdhsa_system_sgpr_workgroup_id_x 1
  .amdhsa_float_denorm_mode_32 3
.end_amdhsa_kernel
.p2align 6
.amdhsa_kernel ffn1_kernel
  .amdhsa_next_free_vgpr 496
  .amdhsa_next_free_sgpr 102
  .amdhsa_accum_offset 256
  .amdhsa_group_segment_fixed_size 0
  .amdhsa_kernarg_size 112
  .amdhsa_user_sgpr_count 2
  .amdhsa_user_sgpr_kernarg_segment_ptr 1
  .amdhsa_system_sgpr_workgroup_id_x 1
  .amdhsa_float_denorm_mode_32 3
.end_amdhsa_kernel
.p2align 6
.amdhsa_kernel down_kernel
  .amdhsa_next_free_vgpr 288
  .amdhsa_next_free_sgpr 102
  .amdhsa_accum_offset 128
  .amdhsa_group_segment_fixed_size 0
  .amdhsa_kernarg_size 112
  .amdhsa_user_sgpr_count 2
  .amdhsa_user_sgpr_kernarg_segment_ptr 1
  .amdhsa_system_sgpr_workgroup_id_x 1
  .amdhsa_float_denorm_mode_32 3
.end_amdhsa_kernel
```
